```python
import torch

def _softmax(x, axis=-1):
    return torch.softmax(x, dim=axis)

def _gelu(x):
    return torch.nn.functional.gelu(x, approximate='tanh')

def _silu(x):
    return torch.nn.functional.silu(x)

def _sigmoid(x):
    return torch.sigmoid(x)

def _layernorm(x, axis=-1, eps=1e-05):
    m = x.mean(dim=axis, keepdim=True)
    v = x.var(dim=axis, keepdim=True, unbiased=False)
    return (x - m) / torch.sqrt(v + eps)

def _scatter_add(tgt, idx, src, axis=0):
    return tgt.clone().index_add_(axis, idx, src)

def _segment_sum(src, seg, n):
    out = torch.zeros((n,) + src.shape[1:], dtype=src.dtype)
    return out.index_add_(0, seg, src)

def _pad(x, pw):
    flat = tuple((v for pair in reversed(pw) for v in pair))
    return torch.nn.functional.pad(x, flat)
kernel_name = 'concat_heads__memory_aug_recurrent_mem_tr__compressed_kv_cla__prompt'

def setup_inputs():

    _w = lambda a: (lambda t: t.to(torch.bfloat16) if t.is_floating_point() else t)(torch.as_tensor(a))

    def _A_setup():
        B, S, Dm = (1, 2048, 448)
        H, Dh = (16, 256)
        M, seg = (8, 32)
        seg = min(seg, S)
        S = S // seg * seg
        return {'x': _w((lambda *s: torch.randn(*s, dtype=torch.bfloat16) * 0.05)(B, S, Dm)), 'mem0': _w((lambda *s: torch.randn(*s, dtype=torch.bfloat16) * 0.4)(B, M, Dm)), 'Wq': _w((lambda *s: torch.randn(*s, dtype=torch.bfloat16) * 6.4)(Dm, H, Dh) * Dm ** (-0.5)), 'Wk': _w((lambda *s: torch.randn(*s, dtype=torch.bfloat16) * 6.4)(Dm, H, Dh) * Dm ** (-0.5)), 'Wv': _w((lambda *s: torch.randn(*s, dtype=torch.bfloat16) * 0.4)(Dm, H, Dh) * Dm ** (-0.5)), 'Wo': _w((lambda *s: torch.randn(*s, dtype=torch.bfloat16) * 0.4)(H, Dh, Dm) * (H * Dh) ** (-0.5)), 'seg_len': seg}
    _A_in = _A_setup()

    def _B_setup():
        B, H, Sq, Sk, D, M = (1, 16, 2048, 2048, 256, 448)
        Dc = 4 * D
        return {'x': _w((lambda *s: torch.randn(*s, dtype=torch.bfloat16) * 1.6)(B, Sq, M)), 'c_kv': _w((lambda *s: torch.randn(*s, dtype=torch.bfloat16) * 0.2)(B, Sk, Dc)), 'w_q': _w((lambda *s: torch.randn(*s, dtype=torch.bfloat16) * 3.2)(M, H, D) * M ** (-0.5)), 'w_uk': _w((lambda *s: torch.randn(*s, dtype=torch.bfloat16) * 3.2)(Dc, H, D) * Dc ** (-0.5)), 'w_uv': _w((lambda *s: torch.randn(*s, dtype=torch.bfloat16) * 0.2)(Dc, H, D) * Dc ** (-0.5)), 'w_o': _w((lambda *s: torch.randn(*s, dtype=torch.bfloat16) * 0.2)(H, D, M) * (H * D) ** (-0.5))}
    _B_in = _B_setup()
    return {'A_x': _A_in['x'], 'A_mem0': _A_in['mem0'], 'A_Wq': _A_in['Wq'], 'A_Wk': _A_in['Wk'], 'A_Wv': _A_in['Wv'], 'A_Wo': _A_in['Wo'], 'A_seg_len': _A_in['seg_len'], 'B_x': _B_in['x'], 'B_c_kv': _B_in['c_kv'], 'B_w_q': _B_in['w_q'], 'B_w_uk': _B_in['w_uk'], 'B_w_uv': _B_in['w_uv'], 'B_w_o': _B_in['w_o']}

def reference(A_x, A_mem0, A_Wq, A_Wk, A_Wv, A_Wo, A_seg_len, B_x, B_c_kv, B_w_q, B_w_uk, B_w_uv, B_w_o):

    def _A_ref(x, mem0, Wq, Wk, Wv, Wo, seg_len):
        B, S, Dm = x.shape
        H, Dh = (Wq.shape[1], Wq.shape[2])
        M = mem0.shape[1]
        scale = Dh ** (-0.5)
        n_seg = S // seg_len
        L = M + seg_len
        idx = torch.arange(L)
        mask = (idx[:, None] < M) | (idx[:, None] >= idx[None, :])
        mem = mem0
        outs = []
        for s in range(n_seg):
            xs = x[:, s * seg_len:(s + 1) * seg_len, :].clone()
            h = torch.concatenate([mem, xs], axis=1)
            q = torch.einsum('btd,dhe->bhte', h, Wq)
            k = torch.einsum('btd,dhe->bhte', h, Wk)
            v = torch.einsum('btd,dhe->bhte', h, Wv)
            scores = torch.einsum('bhqe,bhke->bhqk', q, k) * scale
            scores = torch.where(mask[None, None], scores, -1000000000.0)
            p = _softmax(scores, axis=-1)
            o = torch.einsum('bhqk,bhke->bhqe', p, v)
            o = torch.einsum('bhte,hed->btd', o, Wo)
            mem = o[:, :M, :].clone()
            outs.append(o[:, M:, :])
        return torch.concatenate(outs, axis=1)

    def _B_ref(x, c_kv, w_q, w_uk, w_uv, w_o):
        B, Sq, M = (x.shape[0], x.shape[1], x.shape[2])
        Sk = c_kv.shape[1]
        H, D = (w_q.shape[1], w_q.shape[2])
        q = torch.einsum('bqm,mhd->bhqd', x, w_q)
        k = torch.einsum('bkc,chd->bhkd', c_kv, w_uk)
        v = torch.einsum('bkc,chd->bhkd', c_kv, w_uv)
        scores = torch.einsum('bhqd,bhkd->bhqk', q, k) * D ** (-0.5)
        off = Sk - Sq
        qi = torch.arange(Sq)[:, None]
        kj = torch.arange(Sk)[None, :]
        cmask = kj <= qi + off
        scores = torch.where(cmask[None, None], scores, -1000000000.0)
        p = _softmax(scores, axis=-1)
        ctx = torch.einsum('bhqk,bhkd->bhqd', p, v)
        return torch.einsum('bhqd,hdm->bqm', ctx, w_o)
    a = _A_ref(A_x, A_mem0, A_Wq, A_Wk, A_Wv, A_Wo, A_seg_len)
    b = _B_ref(B_x, B_c_kv, B_w_q, B_w_uk, B_w_uv, B_w_o)
    return torch.concatenate([a, b], axis=-1)
```

```asm
; @launch kernel=k1_prep_kernel grid=(1360,1,1) block=(256,1,1) lds=71680
; @launch kernel=k2_main_kernel grid=(256,1,1) block=(256,1,1) lds=163840
; @launch kernel=k3_kmvm_kernel grid=(256,1,1) block=(256,1,1) lds=71680
; @launch kernel=k4_xattn_kernel grid=(256,1,1) block=(256,1,1) lds=101376
; @launch kernel=k6_out_kernel grid=(224,1,1) block=(256,1,1) lds=36864
.amdgcn_target "amdgcn-amd-amdhsa--gfx950"
.text
    .globl k1_prep_kernel
    .p2align 8
    .type k1_prep_kernel,@function
k1_prep_kernel:
    s_load_dwordx16 s[16:31], s[0:1], 0
    s_load_dwordx16 s[32:47], s[0:1], 64
    s_waitcnt lgkmcnt(0)
    s_cmp_ge_u32 s2, 1360
    s_cbranch_scc1 L_k1_end
    s_cmp_ge_u32 s2, 1296
    s_cbranch_scc1 L_k1_zero
    s_cmp_ge_u32 s2, 512
    s_cbranch_scc1 L_k1_wvo
    s_lshr_b32 s3, s2, 9
    s_and_b32 s4, s2, 511
    s_lshr_b32 s5, s4, 5
    s_lshl_b32 s5, s5, 7
    s_and_b32 s6, s4, 31
    s_lshl_b32 s6, s6, 7
    s_mov_b32 s48, s16
    s_mov_b32 s49, s17
    s_mov_b32 s52, s20
    s_mov_b32 s53, s21
    s_mov_b32 s56, s46
    s_mov_b32 s57, s47
    s_mov_b32 s7, 896
    s_mov_b32 s8, 7
    s_cmp_lg_u32 s3, 0
    s_cbranch_scc1 sel_1
    s_mov_b32 s48, s16
    s_mov_b32 s49, s17
    s_mov_b32 s52, s22
    s_mov_b32 s53, s23
    s_add_u32 s56, s46, 16777216
    s_addc_u32 s57, s47, 0
    s_mov_b32 s7, 896
    s_mov_b32 s8, 7
sel_1:
    s_mov_b32 s50, 0x7fffffff
    s_mov_b32 s51, 0x00020000
    s_mov_b32 s54, 0x7fffffff
    s_mov_b32 s55, 0x00020000
    s_mov_b32 s58, 0x7fffffff
    s_mov_b32 s59, 0x00020000
    s_mov_b32 s9, 8192
    v_lshrrev_b32 v1, 3, v0
    v_and_b32 v2, 7, v0
    v_mul_lo_u32 v3, v1, s7
    v_lshlrev_b32 v4, 4, v2
    v_add_u32 v3, v3, v4
    v_mul_u32_u24 v5, 144, v1
    v_add_u32 v5, v5, v4
    v_add_u32 v5, 0, v5
    v_lshrrev_b32 v6, 4, v0
    v_and_b32 v7, 15, v0
    v_lshlrev_b32 v8, 4, v7
    v_mul_lo_u32 v9, v6, s9
    v_add_u32 v9, v9, v8
    v_mul_u32_u24 v10, 272, v6
    v_add_u32 v10, v10, v8
    v_add_u32 v10, 18432, v10
    s_mul_i32 s60, s5, s7
    s_lshl_b32 s65, s7, 5
    s_add_u32 s61, s60, s65
    s_add_u32 s62, s61, s65
    s_add_u32 s63, s62, s65
    s_lshl_b32 s66, s6, 1
    s_mov_b32 s68, s66
    s_mul_i32 s65, s9, 16
    s_add_u32 s69, s68, s65
    s_add_u32 s70, s69, s65
    s_add_u32 s71, s70, s65
    s_lshl_b32 s67, s9, 6
    v_and_b32 v11, 63, v0
    v_lshrrev_b32 v12, 6, v0
    v_and_b32 v13, 15, v11
    v_lshrrev_b32 v14, 4, v11
    v_and_b32 v15, 1, v12
    v_lshrrev_b32 v16, 1, v12
    v_mul_u32_u24 v17, 64, v15
    v_add_u32 v17, v17, v13
    v_mul_u32_u24 v17, 144, v17
    v_lshlrev_b32 v18, 4, v14
    v_add_u32 v17, v17, v18
    v_add_u32 v17, 0, v17
    v_lshrrev_b32 v18, 2, v13
    v_lshlrev_b32 v19, 3, v14
    v_add_u32 v18, v18, v19
    v_mul_u32_u24 v18, 272, v18
    v_and_b32 v19, 3, v13
    v_lshlrev_b32 v19, 3, v19
    v_add_u32 v18, v18, v19
    v_mul_u32_u24 v19, 128, v16
    v_add_u32 v18, v18, v19
    v_add_u32 v18, 18432, v18
    v_mov_b32 v64, 0
    v_mov_b32 v65, 0
    v_mov_b32 v66, 0
    v_mov_b32 v67, 0
    v_mov_b32 v68, 0
    v_mov_b32 v69, 0
    v_mov_b32 v70, 0
    v_mov_b32 v71, 0
    v_mov_b32 v72, 0
    v_mov_b32 v73, 0
    v_mov_b32 v74, 0
    v_mov_b32 v75, 0
    v_mov_b32 v76, 0
    v_mov_b32 v77, 0
    v_mov_b32 v78, 0
    v_mov_b32 v79, 0
    v_mov_b32 v80, 0
    v_mov_b32 v81, 0
    v_mov_b32 v82, 0
    v_mov_b32 v83, 0
    v_mov_b32 v84, 0
    v_mov_b32 v85, 0
    v_mov_b32 v86, 0
    v_mov_b32 v87, 0
    v_mov_b32 v88, 0
    v_mov_b32 v89, 0
    v_mov_b32 v90, 0
    v_mov_b32 v91, 0
    v_mov_b32 v92, 0
    v_mov_b32 v93, 0
    v_mov_b32 v94, 0
    v_mov_b32 v95, 0
    v_mov_b32 v96, 0
    v_mov_b32 v97, 0
    v_mov_b32 v98, 0
    v_mov_b32 v99, 0
    v_mov_b32 v100, 0
    v_mov_b32 v101, 0
    v_mov_b32 v102, 0
    v_mov_b32 v103, 0
    v_mov_b32 v104, 0
    v_mov_b32 v105, 0
    v_mov_b32 v106, 0
    v_mov_b32 v107, 0
    v_mov_b32 v108, 0
    v_mov_b32 v109, 0
    v_mov_b32 v110, 0
    v_mov_b32 v111, 0
    v_mov_b32 v112, 0
    v_mov_b32 v113, 0
    v_mov_b32 v114, 0
    v_mov_b32 v115, 0
    v_mov_b32 v116, 0
    v_mov_b32 v117, 0
    v_mov_b32 v118, 0
    v_mov_b32 v119, 0
    v_mov_b32 v120, 0
    v_mov_b32 v121, 0
    v_mov_b32 v122, 0
    v_mov_b32 v123, 0
    v_mov_b32 v124, 0
    v_mov_b32 v125, 0
    v_mov_b32 v126, 0
    v_mov_b32 v127, 0
    buffer_load_dwordx4 v[128:131], v3, s[48:51], s60 offen
    buffer_load_dwordx4 v[132:135], v3, s[48:51], s61 offen
    buffer_load_dwordx4 v[136:139], v3, s[48:51], s62 offen
    buffer_load_dwordx4 v[140:143], v3, s[48:51], s63 offen
    buffer_load_dwordx4 v[144:147], v9, s[52:55], s68 offen
    buffer_load_dwordx4 v[148:151], v9, s[52:55], s69 offen
    buffer_load_dwordx4 v[152:155], v9, s[52:55], s70 offen
    buffer_load_dwordx4 v[156:159], v9, s[52:55], s71 offen
    v_add_u32 v3, 128, v3
    v_add_u32 v9, s67, v9
    s_waitcnt vmcnt(0)
    ds_write_b128 v5, v[128:131] offset:0
    ds_write_b128 v5, v[132:135] offset:4608
    ds_write_b128 v5, v[136:139] offset:9216
    ds_write_b128 v5, v[140:143] offset:13824
    ds_write_b128 v10, v[144:147] offset:0
    ds_write_b128 v10, v[148:151] offset:4352
    ds_write_b128 v10, v[152:155] offset:8704
    ds_write_b128 v10, v[156:159] offset:13056
    s_waitcnt lgkmcnt(0)
    s_barrier
    s_mov_b32 s72, 0
gk_2:
    s_add_u32 s73, s72, 1
    s_cmp_ge_u32 s73, s8
    s_cbranch_scc1 noload_4
    buffer_load_dwordx4 v[128:131], v3, s[48:51], s60 offen
    buffer_load_dwordx4 v[132:135], v3, s[48:51], s61 offen
    buffer_load_dwordx4 v[136:139], v3, s[48:51], s62 offen
    buffer_load_dwordx4 v[140:143], v3, s[48:51], s63 offen
    buffer_load_dwordx4 v[144:147], v9, s[52:55], s68 offen
    buffer_load_dwordx4 v[148:151], v9, s[52:55], s69 offen
    buffer_load_dwordx4 v[152:155], v9, s[52:55], s70 offen
    buffer_load_dwordx4 v[156:159], v9, s[52:55], s71 offen
    v_add_u32 v3, 128, v3
    v_add_u32 v9, s67, v9
noload_4:
    ds_read_b128 v[32:35], v17 offset:0
    ds_read_b128 v[36:39], v17 offset:2304
    ds_read_b128 v[40:43], v17 offset:4608
    ds_read_b128 v[44:47], v17 offset:6912
    ds_read_b64_tr_b16 v[48:49], v18 offset:0
    ds_read_b64_tr_b16 v[50:51], v18 offset:1088
    ds_read_b64_tr_b16 v[52:53], v18 offset:32
    ds_read_b64_tr_b16 v[54:55], v18 offset:1120
    ds_read_b64_tr_b16 v[56:57], v18 offset:64
    ds_read_b64_tr_b16 v[58:59], v18 offset:1152
    ds_read_b64_tr_b16 v[60:61], v18 offset:96
    ds_read_b64_tr_b16 v[62:63], v18 offset:1184
    s_waitcnt lgkmcnt(0)
    v_mfma_f32_16x16x32_bf16 v[64:67], v[48:51], v[32:35], v[64:67]
    v_mfma_f32_16x16x32_bf16 v[68:71], v[48:51], v[36:39], v[68:71]
    v_mfma_f32_16x16x32_bf16 v[72:75], v[48:51], v[40:43], v[72:75]
    v_mfma_f32_16x16x32_bf16 v[76:79], v[48:51], v[44:47], v[76:79]
    v_mfma_f32_16x16x32_bf16 v[80:83], v[52:55], v[32:35], v[80:83]
    v_mfma_f32_16x16x32_bf16 v[84:87], v[52:55], v[36:39], v[84:87]
    v_mfma_f32_16x16x32_bf16 v[88:91], v[52:55], v[40:43], v[88:91]
    v_mfma_f32_16x16x32_bf16 v[92:95], v[52:55], v[44:47], v[92:95]
    v_mfma_f32_16x16x32_bf16 v[96:99], v[56:59], v[32:35], v[96:99]
    v_mfma_f32_16x16x32_bf16 v[100:103], v[56:59], v[36:39], v[100:103]
    v_mfma_f32_16x16x32_bf16 v[104:107], v[56:59], v[40:43], v[104:107]
    v_mfma_f32_16x16x32_bf16 v[108:111], v[56:59], v[44:47], v[108:111]
    v_mfma_f32_16x16x32_bf16 v[112:115], v[60:63], v[32:35], v[112:115]
    v_mfma_f32_16x16x32_bf16 v[116:119], v[60:63], v[36:39], v[116:119]
    v_mfma_f32_16x16x32_bf16 v[120:123], v[60:63], v[40:43], v[120:123]
    v_mfma_f32_16x16x32_bf16 v[124:127], v[60:63], v[44:47], v[124:127]
    ds_read_b128 v[32:35], v17 offset:64
    ds_read_b128 v[36:39], v17 offset:2368
    ds_read_b128 v[40:43], v17 offset:4672
    ds_read_b128 v[44:47], v17 offset:6976
    ds_read_b64_tr_b16 v[48:49], v18 offset:8704
    ds_read_b64_tr_b16 v[50:51], v18 offset:9792
    ds_read_b64_tr_b16 v[52:53], v18 offset:8736
    ds_read_b64_tr_b16 v[54:55], v18 offset:9824
    ds_read_b64_tr_b16 v[56:57], v18 offset:8768
    ds_read_b64_tr_b16 v[58:59], v18 offset:9856
    ds_read_b64_tr_b16 v[60:61], v18 offset:8800
    ds_read_b64_tr_b16 v[62:63], v18 offset:9888
    s_waitcnt lgkmcnt(0)
    v_mfma_f32_16x16x32_bf16 v[64:67], v[48:51], v[32:35], v[64:67]
    v_mfma_f32_16x16x32_bf16 v[68:71], v[48:51], v[36:39], v[68:71]
    v_mfma_f32_16x16x32_bf16 v[72:75], v[48:51], v[40:43], v[72:75]
    v_mfma_f32_16x16x32_bf16 v[76:79], v[48:51], v[44:47], v[76:79]
    v_mfma_f32_16x16x32_bf16 v[80:83], v[52:55], v[32:35], v[80:83]
    v_mfma_f32_16x16x32_bf16 v[84:87], v[52:55], v[36:39], v[84:87]
    v_mfma_f32_16x16x32_bf16 v[88:91], v[52:55], v[40:43], v[88:91]
    v_mfma_f32_16x16x32_bf16 v[92:95], v[52:55], v[44:47], v[92:95]
    v_mfma_f32_16x16x32_bf16 v[96:99], v[56:59], v[32:35], v[96:99]
    v_mfma_f32_16x16x32_bf16 v[100:103], v[56:59], v[36:39], v[100:103]
    v_mfma_f32_16x16x32_bf16 v[104:107], v[56:59], v[40:43], v[104:107]
    v_mfma_f32_16x16x32_bf16 v[108:111], v[56:59], v[44:47], v[108:111]
    v_mfma_f32_16x16x32_bf16 v[112:115], v[60:63], v[32:35], v[112:115]
    v_mfma_f32_16x16x32_bf16 v[116:119], v[60:63], v[36:39], v[116:119]
    v_mfma_f32_16x16x32_bf16 v[120:123], v[60:63], v[40:43], v[120:123]
    v_mfma_f32_16x16x32_bf16 v[124:127], v[60:63], v[44:47], v[124:127]
    s_waitcnt vmcnt(0)
    ds_write_b128 v5, v[128:131] offset:35840
    ds_write_b128 v5, v[132:135] offset:40448
    ds_write_b128 v5, v[136:139] offset:45056
    ds_write_b128 v5, v[140:143] offset:49664
    ds_write_b128 v10, v[144:147] offset:35840
    ds_write_b128 v10, v[148:151] offset:40192
    ds_write_b128 v10, v[152:155] offset:44544
    ds_write_b128 v10, v[156:159] offset:48896
    s_waitcnt lgkmcnt(0)
    s_barrier
    s_add_u32 s72, s72, 1
    s_cmp_ge_u32 s72, s8
    s_cbranch_scc1 gkdone_3
    s_add_u32 s73, s72, 1
    s_cmp_ge_u32 s73, s8
    s_cbranch_scc1 noload_5
    buffer_load_dwordx4 v[128:131], v3, s[48:51], s60 offen
    buffer_load_dwordx4 v[132:135], v3, s[48:51], s61 offen
    buffer_load_dwordx4 v[136:139], v3, s[48:51], s62 offen
    buffer_load_dwordx4 v[140:143], v3, s[48:51], s63 offen
    buffer_load_dwordx4 v[144:147], v9, s[52:55], s68 offen
    buffer_load_dwordx4 v[148:151], v9, s[52:55], s69 offen
    buffer_load_dwordx4 v[152:155], v9, s[52:55], s70 offen
    buffer_load_dwordx4 v[156:159], v9, s[52:55], s71 offen
    v_add_u32 v3, 128, v3
    v_add_u32 v9, s67, v9
noload_5:
    ds_read_b128 v[32:35], v17 offset:35840
    ds_read_b128 v[36:39], v17 offset:38144
    ds_read_b128 v[40:43], v17 offset:40448
    ds_read_b128 v[44:47], v17 offset:42752
    ds_read_b64_tr_b16 v[48:49], v18 offset:35840
    ds_read_b64_tr_b16 v[50:51], v18 offset:36928
    ds_read_b64_tr_b16 v[52:53], v18 offset:35872
    ds_read_b64_tr_b16 v[54:55], v18 offset:36960
    ds_read_b64_tr_b16 v[56:57], v18 offset:35904
    ds_read_b64_tr_b16 v[58:59], v18 offset:36992
    ds_read_b64_tr_b16 v[60:61], v18 offset:35936
    ds_read_b64_tr_b16 v[62:63], v18 offset:37024
    s_waitcnt lgkmcnt(0)
    v_mfma_f32_16x16x32_bf16 v[64:67], v[48:51], v[32:35], v[64:67]
    v_mfma_f32_16x16x32_bf16 v[68:71], v[48:51], v[36:39], v[68:71]
    v_mfma_f32_16x16x32_bf16 v[72:75], v[48:51], v[40:43], v[72:75]
    v_mfma_f32_16x16x32_bf16 v[76:79], v[48:51], v[44:47], v[76:79]
    v_mfma_f32_16x16x32_bf16 v[80:83], v[52:55], v[32:35], v[80:83]
    v_mfma_f32_16x16x32_bf16 v[84:87], v[52:55], v[36:39], v[84:87]
    v_mfma_f32_16x16x32_bf16 v[88:91], v[52:55], v[40:43], v[88:91]
    v_mfma_f32_16x16x32_bf16 v[92:95], v[52:55], v[44:47], v[92:95]
    v_mfma_f32_16x16x32_bf16 v[96:99], v[56:59], v[32:35], v[96:99]
    v_mfma_f32_16x16x32_bf16 v[100:103], v[56:59], v[36:39], v[100:103]
    v_mfma_f32_16x16x32_bf16 v[104:107], v[56:59], v[40:43], v[104:107]
    v_mfma_f32_16x16x32_bf16 v[108:111], v[56:59], v[44:47], v[108:111]
    v_mfma_f32_16x16x32_bf16 v[112:115], v[60:63], v[32:35], v[112:115]
    v_mfma_f32_16x16x32_bf16 v[116:119], v[60:63], v[36:39], v[116:119]
    v_mfma_f32_16x16x32_bf16 v[120:123], v[60:63], v[40:43], v[120:123]
    v_mfma_f32_16x16x32_bf16 v[124:127], v[60:63], v[44:47], v[124:127]
    ds_read_b128 v[32:35], v17 offset:35904
    ds_read_b128 v[36:39], v17 offset:38208
    ds_read_b128 v[40:43], v17 offset:40512
    ds_read_b128 v[44:47], v17 offset:42816
    ds_read_b64_tr_b16 v[48:49], v18 offset:44544
    ds_read_b64_tr_b16 v[50:51], v18 offset:45632
    ds_read_b64_tr_b16 v[52:53], v18 offset:44576
    ds_read_b64_tr_b16 v[54:55], v18 offset:45664
    ds_read_b64_tr_b16 v[56:57], v18 offset:44608
    ds_read_b64_tr_b16 v[58:59], v18 offset:45696
    ds_read_b64_tr_b16 v[60:61], v18 offset:44640
    ds_read_b64_tr_b16 v[62:63], v18 offset:45728
    s_waitcnt lgkmcnt(0)
    v_mfma_f32_16x16x32_bf16 v[64:67], v[48:51], v[32:35], v[64:67]
    v_mfma_f32_16x16x32_bf16 v[68:71], v[48:51], v[36:39], v[68:71]
    v_mfma_f32_16x16x32_bf16 v[72:75], v[48:51], v[40:43], v[72:75]
    v_mfma_f32_16x16x32_bf16 v[76:79], v[48:51], v[44:47], v[76:79]
    v_mfma_f32_16x16x32_bf16 v[80:83], v[52:55], v[32:35], v[80:83]
    v_mfma_f32_16x16x32_bf16 v[84:87], v[52:55], v[36:39], v[84:87]
    v_mfma_f32_16x16x32_bf16 v[88:91], v[52:55], v[40:43], v[88:91]
    v_mfma_f32_16x16x32_bf16 v[92:95], v[52:55], v[44:47], v[92:95]
    v_mfma_f32_16x16x32_bf16 v[96:99], v[56:59], v[32:35], v[96:99]
    v_mfma_f32_16x16x32_bf16 v[100:103], v[56:59], v[36:39], v[100:103]
    v_mfma_f32_16x16x32_bf16 v[104:107], v[56:59], v[40:43], v[104:107]
    v_mfma_f32_16x16x32_bf16 v[108:111], v[56:59], v[44:47], v[108:111]
    v_mfma_f32_16x16x32_bf16 v[112:115], v[60:63], v[32:35], v[112:115]
    v_mfma_f32_16x16x32_bf16 v[116:119], v[60:63], v[36:39], v[116:119]
    v_mfma_f32_16x16x32_bf16 v[120:123], v[60:63], v[40:43], v[120:123]
    v_mfma_f32_16x16x32_bf16 v[124:127], v[60:63], v[44:47], v[124:127]
    s_waitcnt vmcnt(0)
    ds_write_b128 v5, v[128:131] offset:0
    ds_write_b128 v5, v[132:135] offset:4608
    ds_write_b128 v5, v[136:139] offset:9216
    ds_write_b128 v5, v[140:143] offset:13824
    ds_write_b128 v10, v[144:147] offset:0
    ds_write_b128 v10, v[148:151] offset:4352
    ds_write_b128 v10, v[152:155] offset:8704
    ds_write_b128 v10, v[156:159] offset:13056
    s_waitcnt lgkmcnt(0)
    s_barrier
    s_add_u32 s72, s72, 1
    s_cmp_ge_u32 s72, s8
    s_cbranch_scc1 gkdone_3
    s_branch gk_2
gkdone_3:
    s_nop 7
    s_nop 7
    v_mul_u32_u24 v20, 64, v15
    v_add_u32 v20, v20, v13
    v_mul_lo_u32 v20, v20, s9
    v_mul_u32_u24 v21, 128, v16
    v_lshlrev_b32 v22, 3, v14
    v_add3_u32 v20, v20, v21, v22
    s_mul_i32 s74, s5, s9
    s_add_u32 s74, s74, s66
    s_lshl_b32 s76, s9, 4
    v_cvt_pk_bf16_f32 v24, v64, v65
    v_cvt_pk_bf16_f32 v25, v66, v67
    buffer_store_dwordx2 v[24:25], v20, s[56:59], s74 offen offset:0
    v_cvt_pk_bf16_f32 v24, v80, v81
    v_cvt_pk_bf16_f32 v25, v82, v83
    buffer_store_dwordx2 v[24:25], v20, s[56:59], s74 offen offset:32
    v_cvt_pk_bf16_f32 v24, v96, v97
    v_cvt_pk_bf16_f32 v25, v98, v99
    buffer_store_dwordx2 v[24:25], v20, s[56:59], s74 offen offset:64
    v_cvt_pk_bf16_f32 v24, v112, v113
    v_cvt_pk_bf16_f32 v25, v114, v115
    buffer_store_dwordx2 v[24:25], v20, s[56:59], s74 offen offset:96
    s_add_u32 s74, s74, s76
    v_cvt_pk_bf16_f32 v24, v68, v69
    v_cvt_pk_bf16_f32 v25, v70, v71
    buffer_store_dwordx2 v[24:25], v20, s[56:59], s74 offen offset:0
    v_cvt_pk_bf16_f32 v24, v84, v85
    v_cvt_pk_bf16_f32 v25, v86, v87
    buffer_store_dwordx2 v[24:25], v20, s[56:59], s74 offen offset:32
    v_cvt_pk_bf16_f32 v24, v100, v101
    v_cvt_pk_bf16_f32 v25, v102, v103
    buffer_store_dwordx2 v[24:25], v20, s[56:59], s74 offen offset:64
    v_cvt_pk_bf16_f32 v24, v116, v117
    v_cvt_pk_bf16_f32 v25, v118, v119
    buffer_store_dwordx2 v[24:25], v20, s[56:59], s74 offen offset:96
    s_add_u32 s74, s74, s76
    v_cvt_pk_bf16_f32 v24, v72, v73
    v_cvt_pk_bf16_f32 v25, v74, v75
    buffer_store_dwordx2 v[24:25], v20, s[56:59], s74 offen offset:0
    v_cvt_pk_bf16_f32 v24, v88, v89
    v_cvt_pk_bf16_f32 v25, v90, v91
    buffer_store_dwordx2 v[24:25], v20, s[56:59], s74 offen offset:32
    v_cvt_pk_bf16_f32 v24, v104, v105
    v_cvt_pk_bf16_f32 v25, v106, v107
    buffer_store_dwordx2 v[24:25], v20, s[56:59], s74 offen offset:64
    v_cvt_pk_bf16_f32 v24, v120, v121
    v_cvt_pk_bf16_f32 v25, v122, v123
    buffer_store_dwordx2 v[24:25], v20, s[56:59], s74 offen offset:96
    s_add_u32 s74, s74, s76
    v_cvt_pk_bf16_f32 v24, v76, v77
    v_cvt_pk_bf16_f32 v25, v78, v79
    buffer_store_dwordx2 v[24:25], v20, s[56:59], s74 offen offset:0
    v_cvt_pk_bf16_f32 v24, v92, v93
    v_cvt_pk_bf16_f32 v25, v94, v95
    buffer_store_dwordx2 v[24:25], v20, s[56:59], s74 offen offset:32
    v_cvt_pk_bf16_f32 v24, v108, v109
    v_cvt_pk_bf16_f32 v25, v110, v111
    buffer_store_dwordx2 v[24:25], v20, s[56:59], s74 offen offset:64
    v_cvt_pk_bf16_f32 v24, v124, v125
    v_cvt_pk_bf16_f32 v25, v126, v127
    buffer_store_dwordx2 v[24:25], v20, s[56:59], s74 offen offset:96
    s_branch L_k1_end
L_k1_wvo:
    s_sub_u32 s3, s2, 512
    s_mul_hi_u32 s4, s3, 0x539782a
    s_mul_i32 s5, s4, 49
    s_sub_u32 s5, s3, s5
    s_mul_hi_u32 s6, s5, 0x24924925
    s_mul_i32 s7, s6, 7
    s_sub_u32 s7, s5, s7
    s_lshl_b32 s10, s6, 6
    s_lshl_b32 s11, s7, 6
    s_lshl_b32 s12, s4, 9
    s_add_u32 s48, s24, s12
    s_addc_u32 s49, s25, 0
    s_mul_i32 s12, s4, 229376
    s_add_u32 s52, s26, s12
    s_addc_u32 s53, s27, 0
    s_mul_i32 s12, s4, 401408
    s_add_u32 s12, s12, 134217728
    s_add_u32 s56, s46, s12
    s_addc_u32 s57, s47, 0
    s_mov_b32 s50, 0x7fffffff
    s_mov_b32 s51, 0x00020000
    s_mov_b32 s54, 0x7fffffff
    s_mov_b32 s55, 0x00020000
    s_mov_b32 s58, 0x7fffffff
    s_mov_b32 s59, 0x00020000
    s_mov_b32 s7, 8192
    s_mov_b32 s9, 896
    s_mov_b32 s8, 4
    v_lshrrev_b32 v1, 3, v0
    v_and_b32 v2, 7, v0
    v_mul_lo_u32 v3, v1, s7
    v_lshlrev_b32 v4, 4, v2
    v_add_u32 v3, v3, v4
    v_mul_u32_u24 v5, 144, v1
    v_add_u32 v5, v5, v4
    v_add_u32 v5, 0, v5
    v_lshrrev_b32 v6, 3, v0
    v_and_b32 v7, 7, v0
    v_lshlrev_b32 v8, 4, v7
    v_mul_lo_u32 v9, v6, s9
    v_add_u32 v9, v9, v8
    v_mul_u32_u24 v10, 144, v6
    v_add_u32 v10, v10, v8
    v_add_u32 v10, 9216, v10
    s_mul_i32 s60, s10, s7
    s_lshl_b32 s65, s7, 5
    s_add_u32 s61, s60, s65
    s_lshl_b32 s66, s11, 1
    s_mov_b32 s68, s66
    s_mul_i32 s65, s9, 32
    s_add_u32 s69, s68, s65
    s_lshl_b32 s67, s9, 6
    v_and_b32 v11, 63, v0
    v_lshrrev_b32 v12, 6, v0
    v_and_b32 v13, 15, v11
    v_lshrrev_b32 v14, 4, v11
    v_and_b32 v15, 1, v12
    v_lshrrev_b32 v16, 1, v12
    v_mul_u32_u24 v17, 32, v15
    v_add_u32 v17, v17, v13
    v_mul_u32_u24 v17, 144, v17
    v_lshlrev_b32 v18, 4, v14
    v_add_u32 v17, v17, v18
    v_add_u32 v17, 0, v17
    v_lshrrev_b32 v18, 2, v13
    v_lshlrev_b32 v19, 3, v14
    v_add_u32 v18, v18, v19
    v_mul_u32_u24 v18, 144, v18
    v_and_b32 v19, 3, v13
    v_lshlrev_b32 v19, 3, v19
    v_add_u32 v18, v18, v19
    v_mul_u32_u24 v19, 64, v16
    v_add_u32 v18, v18, v19
    v_add_u32 v18, 9216, v18
    v_mov_b32 v64, 0
    v_mov_b32 v65, 0
    v_mov_b32 v66, 0
    v_mov_b32 v67, 0
    v_mov_b32 v68, 0
    v_mov_b32 v69, 0
    v_mov_b32 v70, 0
    v_mov_b32 v71, 0
    v_mov_b32 v72, 0
    v_mov_b32 v73, 0
    v_mov_b32 v74, 0
    v_mov_b32 v75, 0
    v_mov_b32 v76, 0
    v_mov_b32 v77, 0
    v_mov_b32 v78, 0
    v_mov_b32 v79, 0
    buffer_load_dwordx4 v[128:131], v3, s[48:51], s60 offen
    buffer_load_dwordx4 v[132:135], v3, s[48:51], s61 offen
    buffer_load_dwordx4 v[144:147], v9, s[52:55], s68 offen
    buffer_load_dwordx4 v[148:151], v9, s[52:55], s69 offen
    v_add_u32 v3, 128, v3
    v_add_u32 v9, s67, v9
    s_waitcnt vmcnt(0)
    ds_write_b128 v5, v[128:131] offset:0
    ds_write_b128 v5, v[132:135] offset:4608
    ds_write_b128 v10, v[144:147] offset:0
    ds_write_b128 v10, v[148:151] offset:4608
    s_waitcnt lgkmcnt(0)
    s_barrier
    s_mov_b32 s72, 0
gk_6:
    s_add_u32 s73, s72, 1
    s_cmp_ge_u32 s73, s8
    s_cbranch_scc1 noload_8
    buffer_load_dwordx4 v[128:131], v3, s[48:51], s60 offen
    buffer_load_dwordx4 v[132:135], v3, s[48:51], s61 offen
    buffer_load_dwordx4 v[144:147], v9, s[52:55], s68 offen
    buffer_load_dwordx4 v[148:151], v9, s[52:55], s69 offen
    v_add_u32 v3, 128, v3
    v_add_u32 v9, s67, v9
noload_8:
    ds_read_b128 v[32:35], v17 offset:0
    ds_read_b128 v[36:39], v17 offset:2304
    ds_read_b64_tr_b16 v[48:49], v18 offset:0
    ds_read_b64_tr_b16 v[50:51], v18 offset:576
    ds_read_b64_tr_b16 v[52:53], v18 offset:32
    ds_read_b64_tr_b16 v[54:55], v18 offset:608
    s_waitcnt lgkmcnt(0)
    v_mfma_f32_16x16x32_bf16 v[64:67], v[48:51], v[32:35], v[64:67]
    v_mfma_f32_16x16x32_bf16 v[68:71], v[48:51], v[36:39], v[68:71]
    v_mfma_f32_16x16x32_bf16 v[72:75], v[52:55], v[32:35], v[72:75]
    v_mfma_f32_16x16x32_bf16 v[76:79], v[52:55], v[36:39], v[76:79]
    ds_read_b128 v[32:35], v17 offset:64
    ds_read_b128 v[36:39], v17 offset:2368
    ds_read_b64_tr_b16 v[48:49], v18 offset:4608
    ds_read_b64_tr_b16 v[50:51], v18 offset:5184
    ds_read_b64_tr_b16 v[52:53], v18 offset:4640
    ds_read_b64_tr_b16 v[54:55], v18 offset:5216
    s_waitcnt lgkmcnt(0)
    v_mfma_f32_16x16x32_bf16 v[64:67], v[48:51], v[32:35], v[64:67]
    v_mfma_f32_16x16x32_bf16 v[68:71], v[48:51], v[36:39], v[68:71]
    v_mfma_f32_16x16x32_bf16 v[72:75], v[52:55], v[32:35], v[72:75]
    v_mfma_f32_16x16x32_bf16 v[76:79], v[52:55], v[36:39], v[76:79]
    s_waitcnt vmcnt(0)
    ds_write_b128 v5, v[128:131] offset:18432
    ds_write_b128 v5, v[132:135] offset:23040
    ds_write_b128 v10, v[144:147] offset:18432
    ds_write_b128 v10, v[148:151] offset:23040
    s_waitcnt lgkmcnt(0)
    s_barrier
    s_add_u32 s72, s72, 1
    s_cmp_ge_u32 s72, s8
    s_cbranch_scc1 gkdone_7
    s_add_u32 s73, s72, 1
    s_cmp_ge_u32 s73, s8
    s_cbranch_scc1 noload_9
    buffer_load_dwordx4 v[128:131], v3, s[48:51], s60 offen
    buffer_load_dwordx4 v[132:135], v3, s[48:51], s61 offen
    buffer_load_dwordx4 v[144:147], v9, s[52:55], s68 offen
    buffer_load_dwordx4 v[148:151], v9, s[52:55], s69 offen
    v_add_u32 v3, 128, v3
    v_add_u32 v9, s67, v9
noload_9:
    ds_read_b128 v[32:35], v17 offset:18432
    ds_read_b128 v[36:39], v17 offset:20736
    ds_read_b64_tr_b16 v[48:49], v18 offset:18432
    ds_read_b64_tr_b16 v[50:51], v18 offset:19008
    ds_read_b64_tr_b16 v[52:53], v18 offset:18464
    ds_read_b64_tr_b16 v[54:55], v18 offset:19040
    s_waitcnt lgkmcnt(0)
    v_mfma_f32_16x16x32_bf16 v[64:67], v[48:51], v[32:35], v[64:67]
    v_mfma_f32_16x16x32_bf16 v[68:71], v[48:51], v[36:39], v[68:71]
    v_mfma_f32_16x16x32_bf16 v[72:75], v[52:55], v[32:35], v[72:75]
    v_mfma_f32_16x16x32_bf16 v[76:79], v[52:55], v[36:39], v[76:79]
    ds_read_b128 v[32:35], v17 offset:18496
    ds_read_b128 v[36:39], v17 offset:20800
    ds_read_b64_tr_b16 v[48:49], v18 offset:23040
    ds_read_b64_tr_b16 v[50:51], v18 offset:23616
    ds_read_b64_tr_b16 v[52:53], v18 offset:23072
    ds_read_b64_tr_b16 v[54:55], v18 offset:23648
    s_waitcnt lgkmcnt(0)
    v_mfma_f32_16x16x32_bf16 v[64:67], v[48:51], v[32:35], v[64:67]
    v_mfma_f32_16x16x32_bf16 v[68:71], v[48:51], v[36:39], v[68:71]
    v_mfma_f32_16x16x32_bf16 v[72:75], v[52:55], v[32:35], v[72:75]
    v_mfma_f32_16x16x32_bf16 v[76:79], v[52:55], v[36:39], v[76:79]
    s_waitcnt vmcnt(0)
    ds_write_b128 v5, v[128:131] offset:0
    ds_write_b128 v5, v[132:135] offset:4608
    ds_write_b128 v10, v[144:147] offset:0
    ds_write_b128 v10, v[148:151] offset:4608
    s_waitcnt lgkmcnt(0)
    s_barrier
    s_add_u32 s72, s72, 1
    s_cmp_ge_u32 s72, s8
    s_cbranch_scc1 gkdone_7
    s_branch gk_6
gkdone_7:
    s_nop 7
    s_nop 7
    v_mul_u32_u24 v20, 32, v15
    v_add_u32 v20, v20, v13
    v_mul_lo_u32 v20, v20, s9
    v_mul_u32_u24 v21, 64, v16
    v_lshlrev_b32 v22, 3, v14
    v_add3_u32 v20, v20, v21, v22
    s_mul_i32 s74, s10, s9
    s_add_u32 s74, s74, s66
    s_lshl_b32 s76, s9, 4
    v_cvt_pk_bf16_f32 v24, v64, v65
    v_cvt_pk_bf16_f32 v25, v66, v67
    buffer_store_dwordx2 v[24:25], v20, s[56:59], s74 offen offset:0
    v_cvt_pk_bf16_f32 v24, v72, v73
    v_cvt_pk_bf16_f32 v25, v74, v75
    buffer_store_dwordx2 v[24:25], v20, s[56:59], s74 offen offset:32
    s_add_u32 s74, s74, s76
    v_cvt_pk_bf16_f32 v24, v68, v69
    v_cvt_pk_bf16_f32 v25, v70, v71
    buffer_store_dwordx2 v[24:25], v20, s[56:59], s74 offen offset:0
    v_cvt_pk_bf16_f32 v24, v76, v77
    v_cvt_pk_bf16_f32 v25, v78, v79
    buffer_store_dwordx2 v[24:25], v20, s[56:59], s74 offen offset:32
    s_branch L_k1_end
L_k1_zero:
    s_sub_u32 s3, s2, 1296
    s_mov_b32 s48, s46
    s_mov_b32 s49, s47
    s_mov_b32 s50, 0x7fffffff
    s_mov_b32 s51, 0x00020000
    s_mov_b32 s52, s18
    s_mov_b32 s53, s19
    s_mov_b32 s54, 7168
    s_mov_b32 s55, 0x00020000
    v_mov_b32 v4, 0
    v_mov_b32 v5, 0
    v_mov_b32 v6, 0
    v_mov_b32 v7, 0
    v_lshlrev_b32 v1, 4, v0
    s_lshl_b32 s4, s3, 16
    s_add_u32 s4, s4, 153092096
    s_cmp_eq_u32 s3, 0
    s_cbranch_scc1 z_10
    s_add_u32 s5, s4, 0
    buffer_store_dwordx4 v[4:7], v1, s[48:51], s5 offen
z_10:
    s_cmp_eq_u32 s3, 0
    s_cbranch_scc1 z_11
    s_add_u32 s5, s4, 4096
    buffer_store_dwordx4 v[4:7], v1, s[48:51], s5 offen
z_11:
    s_cmp_eq_u32 s3, 0
    s_cbranch_scc1 z_12
    s_add_u32 s5, s4, 8192
    buffer_store_dwordx4 v[4:7], v1, s[48:51], s5 offen
z_12:
    s_cmp_eq_u32 s3, 0
    s_cbranch_scc1 z_13
    s_add_u32 s5, s4, 12288
    buffer_store_dwordx4 v[4:7], v1, s[48:51], s5 offen
z_13:
    s_add_u32 s5, s4, 16384
    buffer_store_dwordx4 v[4:7], v1, s[48:51], s5 offen
    s_add_u32 s5, s4, 20480
    buffer_store_dwordx4 v[4:7], v1, s[48:51], s5 offen
    s_add_u32 s5, s4, 24576
    buffer_store_dwordx4 v[4:7], v1, s[48:51], s5 offen
    s_add_u32 s5, s4, 28672
    buffer_store_dwordx4 v[4:7], v1, s[48:51], s5 offen
    s_add_u32 s5, s4, 32768
    buffer_store_dwordx4 v[4:7], v1, s[48:51], s5 offen
    s_add_u32 s5, s4, 36864
    buffer_store_dwordx4 v[4:7], v1, s[48:51], s5 offen
    s_add_u32 s5, s4, 40960
    buffer_store_dwordx4 v[4:7], v1, s[48:51], s5 offen
    s_add_u32 s5, s4, 45056
    buffer_store_dwordx4 v[4:7], v1, s[48:51], s5 offen
    s_add_u32 s5, s4, 49152
    buffer_store_dwordx4 v[4:7], v1, s[48:51], s5 offen
    s_add_u32 s5, s4, 53248
    buffer_store_dwordx4 v[4:7], v1, s[48:51], s5 offen
    s_add_u32 s5, s4, 57344
    buffer_store_dwordx4 v[4:7], v1, s[48:51], s5 offen
    s_add_u32 s5, s4, 61440
    buffer_store_dwordx4 v[4:7], v1, s[48:51], s5 offen
    s_cmp_lg_u32 s3, 0
    s_cbranch_scc1 L_k1_end
    v_add_u32 v2, 0, v0
    v_lshrrev_b32 v3, 6, v2
    v_and_b32 v8, 63, v2
    v_lshrrev_b32 v9, 3, v8
    v_mul_u32_u24 v9, 896, v9
    v_lshlrev_b32 v3, 5, v3
    v_add_u32 v9, v9, v3
    v_and_b32 v8, 7, v8
    v_lshlrev_b32 v8, 2, v8
    v_add_u32 v9, v9, v8
    buffer_load_dword v10, v9, s[52:55], 0 offen
    v_mov_b32 v11, 1
    v_lshlrev_b32 v2, 3, v2
    s_waitcnt vmcnt(0)
    buffer_store_dwordx2 v[10:11], v2, s[48:51], s4 offen
    s_mov_b32 s5, 142606336
    buffer_store_dword v10, v9, s[48:51], s5 offen
    v_add_u32 v2, 256, v0
    v_lshrrev_b32 v3, 6, v2
    v_and_b32 v8, 63, v2
    v_lshrrev_b32 v9, 3, v8
    v_mul_u32_u24 v9, 896, v9
    v_lshlrev_b32 v3, 5, v3
    v_add_u32 v9, v9, v3
    v_and_b32 v8, 7, v8
    v_lshlrev_b32 v8, 2, v8
    v_add_u32 v9, v9, v8
    buffer_load_dword v10, v9, s[52:55], 0 offen
    v_mov_b32 v11, 1
    v_lshlrev_b32 v2, 3, v2
    s_waitcnt vmcnt(0)
    buffer_store_dwordx2 v[10:11], v2, s[48:51], s4 offen
    s_mov_b32 s5, 142606336
    buffer_store_dword v10, v9, s[48:51], s5 offen
    v_add_u32 v2, 512, v0
    v_lshrrev_b32 v3, 6, v2
    v_and_b32 v8, 63, v2
    v_lshrrev_b32 v9, 3, v8
    v_mul_u32_u24 v9, 896, v9
    v_lshlrev_b32 v3, 5, v3
    v_add_u32 v9, v9, v3
    v_and_b32 v8, 7, v8
    v_lshlrev_b32 v8, 2, v8
    v_add_u32 v9, v9, v8
    buffer_load_dword v10, v9, s[52:55], 0 offen
    v_mov_b32 v11, 1
    v_lshlrev_b32 v2, 3, v2
    s_waitcnt vmcnt(0)
    buffer_store_dwordx2 v[10:11], v2, s[48:51], s4 offen
    s_mov_b32 s5, 142606336
    buffer_store_dword v10, v9, s[48:51], s5 offen
    v_add_u32 v2, 768, v0
    v_lshrrev_b32 v3, 6, v2
    v_and_b32 v8, 63, v2
    v_lshrrev_b32 v9, 3, v8
    v_mul_u32_u24 v9, 896, v9
    v_lshlrev_b32 v3, 5, v3
    v_add_u32 v9, v9, v3
    v_and_b32 v8, 7, v8
    v_lshlrev_b32 v8, 2, v8
    v_add_u32 v9, v9, v8
    buffer_load_dword v10, v9, s[52:55], 0 offen
    v_mov_b32 v11, 1
    v_lshlrev_b32 v2, 3, v2
    s_waitcnt vmcnt(0)
    buffer_store_dwordx2 v[10:11], v2, s[48:51], s4 offen
    s_mov_b32 s5, 142606336
    buffer_store_dword v10, v9, s[48:51], s5 offen
    v_add_u32 v2, 1024, v0
    v_lshrrev_b32 v3, 6, v2
    v_and_b32 v8, 63, v2
    v_lshrrev_b32 v9, 3, v8
    v_mul_u32_u24 v9, 896, v9
    v_lshlrev_b32 v3, 5, v3
    v_add_u32 v9, v9, v3
    v_and_b32 v8, 7, v8
    v_lshlrev_b32 v8, 2, v8
    v_add_u32 v9, v9, v8
    buffer_load_dword v10, v9, s[52:55], 0 offen
    v_mov_b32 v11, 1
    v_lshlrev_b32 v2, 3, v2
    s_waitcnt vmcnt(0)
    buffer_store_dwordx2 v[10:11], v2, s[48:51], s4 offen
    s_mov_b32 s5, 142606336
    buffer_store_dword v10, v9, s[48:51], s5 offen
    v_add_u32 v2, 1280, v0
    v_lshrrev_b32 v3, 6, v2
    v_and_b32 v8, 63, v2
    v_lshrrev_b32 v9, 3, v8
    v_mul_u32_u24 v9, 896, v9
    v_lshlrev_b32 v3, 5, v3
    v_add_u32 v9, v9, v3
    v_and_b32 v8, 7, v8
    v_lshlrev_b32 v8, 2, v8
    v_add_u32 v9, v9, v8
    buffer_load_dword v10, v9, s[52:55], 0 offen
    v_mov_b32 v11, 1
    v_lshlrev_b32 v2, 3, v2
    s_waitcnt vmcnt(0)
    buffer_store_dwordx2 v[10:11], v2, s[48:51], s4 offen
    s_mov_b32 s5, 142606336
    buffer_store_dword v10, v9, s[48:51], s5 offen
    v_add_u32 v2, 1536, v0
    v_lshrrev_b32 v3, 6, v2
    v_and_b32 v8, 63, v2
    v_lshrrev_b32 v9, 3, v8
    v_mul_u32_u24 v9, 896, v9
    v_lshlrev_b32 v3, 5, v3
    v_add_u32 v9, v9, v3
    v_and_b32 v8, 7, v8
    v_lshlrev_b32 v8, 2, v8
    v_add_u32 v9, v9, v8
    buffer_load_dword v10, v9, s[52:55], 0 offen
    v_mov_b32 v11, 1
    v_lshlrev_b32 v2, 3, v2
    s_waitcnt vmcnt(0)
    buffer_store_dwordx2 v[10:11], v2, s[48:51], s4 offen
    s_mov_b32 s5, 142606336
    buffer_store_dword v10, v9, s[48:51], s5 offen
L_k1_end:
    s_endpgm
    .globl k2_main_kernel
    .p2align 8
    .type k2_main_kernel,@function
k2_main_kernel:
    s_load_dwordx16 s[16:31], s[0:1], 0
    s_load_dwordx16 s[32:47], s[0:1], 64
    s_waitcnt lgkmcnt(0)
    s_cmp_ge_u32 s2, 256
    s_cbranch_scc1 L_k2_end2
    s_cmp_ge_u32 s2, 44
    s_cbranch_scc1 L_k2_worker
    v_and_b32 v1, 63, v0
    v_lshrrev_b32 v2, 6, v0
    s_nop 1
    v_readfirstlane_b32 s3, v2
    v_and_b32 v3, 15, v1
    v_lshrrev_b32 v4, 4, v1
    s_mov_b32 s48, s46
    s_mov_b32 s49, s47
    s_mov_b32 s50, 0x7fffffff
    s_mov_b32 s51, 0x00020000
    v_xor_b32 v5, 16, v1
    v_lshlrev_b32 v5, 2, v5
    v_xor_b32 v6, 32, v1
    v_lshlrev_b32 v6, 2, v6
    v_lshrrev_b32 v7, 3, v1
    v_mul_u32_u24 v7, 912, v7
    v_and_b32 v8, 7, v1
    v_lshlrev_b32 v8, 2, v8
    v_add_u32 v7, v7, v8
    s_lshl_b32 s4, s3, 5
    s_add_u32 s4, s4, 114688
    v_add_u32 v7, s4, v7
    v_lshlrev_b32 v8, 3, v0
    s_mov_b32 s70, 0
    s_mov_b32 s71, 0
    s_cmp_ge_u32 s2, 16
    s_cbranch_scc1 roleB_14
    v_lshrrev_b32 v9, 3, v1
    v_lshlrev_b32 v10, 13, v9
    v_and_b32 v11, 7, v1
    v_lshlrev_b32 v11, 4, v11
    v_add_u32 v10, v10, v11
    v_mul_u32_u24 v12, 144, v9
    v_add_u32 v12, v12, v11
    s_mul_i32 s4, s3, 4608
    s_add_u32 s4, s4, 114688
    v_add_u32 v12, s4, v12
    v_lshrrev_b32 v13, 2, v3
    v_lshlrev_b32 v14, 3, v4
    v_add_u32 v13, v13, v14
    v_mul_u32_u24 v13, 144, v13
    v_and_b32 v14, 3, v3
    v_lshlrev_b32 v14, 3, v14
    v_add_u32 v13, v13, v14
    v_add_u32 v13, s4, v13
    v_lshlrev_b32 v14, 4, v1
    s_mul_i32 s5, s3, 28672
    v_add_u32 v14, s5, v14
    s_lshl_b32 s6, s2, 9
    s_lshl_b32 s7, s3, 7
    s_add_u32 s6, s6, s7
    s_mov_b32 s52, s20
    s_mov_b32 s53, s21
    s_mov_b32 s54, 0x7fffffff
    s_mov_b32 s55, 0x00020000
    s_add_u32 s8, s6, 0
    buffer_load_dwordx4 v[26:29], v10, s[52:55], s8 offen
    s_add_u32 s8, s6, 65536
    buffer_load_dwordx4 v[30:33], v10, s[52:55], s8 offen
    s_add_u32 s8, s6, 131072
    buffer_load_dwordx4 v[34:37], v10, s[52:55], s8 offen
    s_add_u32 s8, s6, 196608
    buffer_load_dwordx4 v[38:41], v10, s[52:55], s8 offen
    s_add_u32 s8, s6, 262144
    buffer_load_dwordx4 v[42:45], v10, s[52:55], s8 offen
    s_add_u32 s8, s6, 327680
    buffer_load_dwordx4 v[46:49], v10, s[52:55], s8 offen
    s_add_u32 s8, s6, 393216
    buffer_load_dwordx4 v[50:53], v10, s[52:55], s8 offen
    s_add_u32 s8, s6, 458752
    buffer_load_dwordx4 v[54:57], v10, s[52:55], s8 offen
    s_add_u32 s8, s6, 524288
    buffer_load_dwordx4 v[58:61], v10, s[52:55], s8 offen
    s_add_u32 s8, s6, 589824
    buffer_load_dwordx4 v[62:65], v10, s[52:55], s8 offen
    s_add_u32 s8, s6, 655360
    buffer_load_dwordx4 v[66:69], v10, s[52:55], s8 offen
    s_add_u32 s8, s6, 720896
    buffer_load_dwordx4 v[70:73], v10, s[52:55], s8 offen
    s_add_u32 s8, s6, 786432
    buffer_load_dwordx4 v[74:77], v10, s[52:55], s8 offen
    s_add_u32 s8, s6, 851968
    buffer_load_dwordx4 v[78:81], v10, s[52:55], s8 offen
    s_add_u32 s8, s6, 917504
    buffer_load_dwordx4 v[82:85], v10, s[52:55], s8 offen
    s_add_u32 s8, s6, 983040
    buffer_load_dwordx4 v[86:89], v10, s[52:55], s8 offen
    s_add_u32 s8, s6, 1048576
    buffer_load_dwordx4 v[90:93], v10, s[52:55], s8 offen
    s_add_u32 s8, s6, 1114112
    buffer_load_dwordx4 v[94:97], v10, s[52:55], s8 offen
    s_add_u32 s8, s6, 1179648
    buffer_load_dwordx4 v[98:101], v10, s[52:55], s8 offen
    s_add_u32 s8, s6, 1245184
    buffer_load_dwordx4 v[102:105], v10, s[52:55], s8 offen
    s_add_u32 s8, s6, 1310720
    buffer_load_dwordx4 v[106:109], v10, s[52:55], s8 offen
    s_add_u32 s8, s6, 1376256
    buffer_load_dwordx4 v[110:113], v10, s[52:55], s8 offen
    s_add_u32 s8, s6, 1441792
    buffer_load_dwordx4 v[114:117], v10, s[52:55], s8 offen
    s_add_u32 s8, s6, 1507328
    buffer_load_dwordx4 v[118:121], v10, s[52:55], s8 offen
    s_waitcnt vmcnt(0)
    v_add_u32 v15, -114688, v12
    ds_write_b128 v15, v[26:29]
    v_add_u32 v15, -113536, v12
    ds_write_b128 v15, v[30:33]
    v_add_u32 v15, -112384, v12
    ds_write_b128 v15, v[34:37]
    v_add_u32 v15, -111232, v12
    ds_write_b128 v15, v[38:41]
    v_add_u32 v15, -96256, v12
    ds_write_b128 v15, v[42:45]
    v_add_u32 v15, -95104, v12
    ds_write_b128 v15, v[46:49]
    v_add_u32 v15, -93952, v12
    ds_write_b128 v15, v[50:53]
    v_add_u32 v15, -92800, v12
    ds_write_b128 v15, v[54:57]
    v_add_u32 v15, -77824, v12
    ds_write_b128 v15, v[58:61]
    v_add_u32 v15, -76672, v12
    ds_write_b128 v15, v[62:65]
    v_add_u32 v15, -75520, v12
    ds_write_b128 v15, v[66:69]
    v_add_u32 v15, -74368, v12
    ds_write_b128 v15, v[70:73]
    v_add_u32 v15, -59392, v12
    ds_write_b128 v15, v[74:77]
    v_add_u32 v15, -58240, v12
    ds_write_b128 v15, v[78:81]
    v_add_u32 v15, -57088, v12
    ds_write_b128 v15, v[82:85]
    v_add_u32 v15, -55936, v12
    ds_write_b128 v15, v[86:89]
    v_add_u32 v15, -40960, v12
    ds_write_b128 v15, v[90:93]
    v_add_u32 v15, -39808, v12
    ds_write_b128 v15, v[94:97]
    v_add_u32 v15, -38656, v12
    ds_write_b128 v15, v[98:101]
    v_add_u32 v15, -37504, v12
    ds_write_b128 v15, v[102:105]
    v_add_u32 v15, -22528, v12
    ds_write_b128 v15, v[106:109]
    v_add_u32 v15, -21376, v12
    ds_write_b128 v15, v[110:113]
    v_add_u32 v15, -20224, v12
    ds_write_b128 v15, v[114:117]
    v_add_u32 v15, -19072, v12
    ds_write_b128 v15, v[118:121]
    s_waitcnt lgkmcnt(0)
    v_add_u32 v15, -114688, v13
    ds_read_b64_tr_b16 v[26:27], v15 offset:0
    ds_read_b64_tr_b16 v[28:29], v15 offset:576
    ds_read_b64_tr_b16 v[30:31], v15 offset:32
    ds_read_b64_tr_b16 v[32:33], v15 offset:608
    ds_read_b64_tr_b16 v[34:35], v15 offset:64
    ds_read_b64_tr_b16 v[36:37], v15 offset:640
    ds_read_b64_tr_b16 v[38:39], v15 offset:96
    ds_read_b64_tr_b16 v[40:41], v15 offset:672
    v_add_u32 v15, -96256, v13
    ds_read_b64_tr_b16 v[42:43], v15 offset:0
    ds_read_b64_tr_b16 v[44:45], v15 offset:576
    ds_read_b64_tr_b16 v[46:47], v15 offset:32
    ds_read_b64_tr_b16 v[48:49], v15 offset:608
    ds_read_b64_tr_b16 v[50:51], v15 offset:64
    ds_read_b64_tr_b16 v[52:53], v15 offset:640
    ds_read_b64_tr_b16 v[54:55], v15 offset:96
    ds_read_b64_tr_b16 v[56:57], v15 offset:672
    v_add_u32 v15, -77824, v13
    ds_read_b64_tr_b16 v[58:59], v15 offset:0
    ds_read_b64_tr_b16 v[60:61], v15 offset:576
    ds_read_b64_tr_b16 v[62:63], v15 offset:32
    ds_read_b64_tr_b16 v[64:65], v15 offset:608
    ds_read_b64_tr_b16 v[66:67], v15 offset:64
    ds_read_b64_tr_b16 v[68:69], v15 offset:640
    ds_read_b64_tr_b16 v[70:71], v15 offset:96
    ds_read_b64_tr_b16 v[72:73], v15 offset:672
    v_add_u32 v15, -59392, v13
    ds_read_b64_tr_b16 v[74:75], v15 offset:0
    ds_read_b64_tr_b16 v[76:77], v15 offset:576
    ds_read_b64_tr_b16 v[78:79], v15 offset:32
    ds_read_b64_tr_b16 v[80:81], v15 offset:608
    ds_read_b64_tr_b16 v[82:83], v15 offset:64
    ds_read_b64_tr_b16 v[84:85], v15 offset:640
    ds_read_b64_tr_b16 v[86:87], v15 offset:96
    ds_read_b64_tr_b16 v[88:89], v15 offset:672
    v_add_u32 v15, -40960, v13
    ds_read_b64_tr_b16 v[90:91], v15 offset:0
    ds_read_b64_tr_b16 v[92:93], v15 offset:576
    ds_read_b64_tr_b16 v[94:95], v15 offset:32
    ds_read_b64_tr_b16 v[96:97], v15 offset:608
    ds_read_b64_tr_b16 v[98:99], v15 offset:64
    ds_read_b64_tr_b16 v[100:101], v15 offset:640
    ds_read_b64_tr_b16 v[102:103], v15 offset:96
    ds_read_b64_tr_b16 v[104:105], v15 offset:672
    v_add_u32 v15, -22528, v13
    ds_read_b64_tr_b16 v[106:107], v15 offset:0
    ds_read_b64_tr_b16 v[108:109], v15 offset:576
    ds_read_b64_tr_b16 v[110:111], v15 offset:32
    ds_read_b64_tr_b16 v[112:113], v15 offset:608
    ds_read_b64_tr_b16 v[114:115], v15 offset:64
    ds_read_b64_tr_b16 v[116:117], v15 offset:640
    ds_read_b64_tr_b16 v[118:119], v15 offset:96
    ds_read_b64_tr_b16 v[120:121], v15 offset:672
    s_waitcnt lgkmcnt(0)
    s_barrier
    v_accvgpr_write_b32 a0, v26
    v_accvgpr_write_b32 a1, v27
    v_accvgpr_write_b32 a2, v28
    v_accvgpr_write_b32 a3, v29
    v_accvgpr_write_b32 a56, v30
    v_accvgpr_write_b32 a57, v31
    v_accvgpr_write_b32 a58, v32
    v_accvgpr_write_b32 a59, v33
    v_accvgpr_write_b32 a112, v34
    v_accvgpr_write_b32 a113, v35
    v_accvgpr_write_b32 a114, v36
    v_accvgpr_write_b32 a115, v37
    v_accvgpr_write_b32 a168, v38
    v_accvgpr_write_b32 a169, v39
    v_accvgpr_write_b32 a170, v40
    v_accvgpr_write_b32 a171, v41
    v_accvgpr_write_b32 a4, v42
    v_accvgpr_write_b32 a5, v43
    v_accvgpr_write_b32 a6, v44
    v_accvgpr_write_b32 a7, v45
    v_accvgpr_write_b32 a60, v46
    v_accvgpr_write_b32 a61, v47
    v_accvgpr_write_b32 a62, v48
    v_accvgpr_write_b32 a63, v49
    v_accvgpr_write_b32 a116, v50
    v_accvgpr_write_b32 a117, v51
    v_accvgpr_write_b32 a118, v52
    v_accvgpr_write_b32 a119, v53
    v_accvgpr_write_b32 a172, v54
    v_accvgpr_write_b32 a173, v55
    v_accvgpr_write_b32 a174, v56
    v_accvgpr_write_b32 a175, v57
    v_accvgpr_write_b32 a8, v58
    v_accvgpr_write_b32 a9, v59
    v_accvgpr_write_b32 a10, v60
    v_accvgpr_write_b32 a11, v61
    v_accvgpr_write_b32 a64, v62
    v_accvgpr_write_b32 a65, v63
    v_accvgpr_write_b32 a66, v64
    v_accvgpr_write_b32 a67, v65
    v_accvgpr_write_b32 a120, v66
    v_accvgpr_write_b32 a121, v67
    v_accvgpr_write_b32 a122, v68
    v_accvgpr_write_b32 a123, v69
    v_accvgpr_write_b32 a176, v70
    v_accvgpr_write_b32 a177, v71
    v_accvgpr_write_b32 a178, v72
    v_accvgpr_write_b32 a179, v73
    v_accvgpr_write_b32 a12, v74
    v_accvgpr_write_b32 a13, v75
    v_accvgpr_write_b32 a14, v76
    v_accvgpr_write_b32 a15, v77
    v_accvgpr_write_b32 a68, v78
    v_accvgpr_write_b32 a69, v79
    v_accvgpr_write_b32 a70, v80
    v_accvgpr_write_b32 a71, v81
    v_accvgpr_write_b32 a124, v82
    v_accvgpr_write_b32 a125, v83
    v_accvgpr_write_b32 a126, v84
    v_accvgpr_write_b32 a127, v85
    v_accvgpr_write_b32 a180, v86
    v_accvgpr_write_b32 a181, v87
    v_accvgpr_write_b32 a182, v88
    v_accvgpr_write_b32 a183, v89
    v_accvgpr_write_b32 a16, v90
    v_accvgpr_write_b32 a17, v91
    v_accvgpr_write_b32 a18, v92
    v_accvgpr_write_b32 a19, v93
    v_accvgpr_write_b32 a72, v94
    v_accvgpr_write_b32 a73, v95
    v_accvgpr_write_b32 a74, v96
    v_accvgpr_write_b32 a75, v97
    v_accvgpr_write_b32 a128, v98
    v_accvgpr_write_b32 a129, v99
    v_accvgpr_write_b32 a130, v100
    v_accvgpr_write_b32 a131, v101
    v_accvgpr_write_b32 a184, v102
    v_accvgpr_write_b32 a185, v103
    v_accvgpr_write_b32 a186, v104
    v_accvgpr_write_b32 a187, v105
    v_accvgpr_write_b32 a20, v106
    v_accvgpr_write_b32 a21, v107
    v_accvgpr_write_b32 a22, v108
    v_accvgpr_write_b32 a23, v109
    v_accvgpr_write_b32 a76, v110
    v_accvgpr_write_b32 a77, v111
    v_accvgpr_write_b32 a78, v112
    v_accvgpr_write_b32 a79, v113
    v_accvgpr_write_b32 a132, v114
    v_accvgpr_write_b32 a133, v115
    v_accvgpr_write_b32 a134, v116
    v_accvgpr_write_b32 a135, v117
    v_accvgpr_write_b32 a188, v118
    v_accvgpr_write_b32 a189, v119
    v_accvgpr_write_b32 a190, v120
    v_accvgpr_write_b32 a191, v121
    s_waitcnt lgkmcnt(0)
    s_add_u32 s8, s6, 1572864
    buffer_load_dwordx4 v[26:29], v10, s[52:55], s8 offen
    s_add_u32 s8, s6, 1638400
    buffer_load_dwordx4 v[30:33], v10, s[52:55], s8 offen
    s_add_u32 s8, s6, 1703936
    buffer_load_dwordx4 v[34:37], v10, s[52:55], s8 offen
    s_add_u32 s8, s6, 1769472
    buffer_load_dwordx4 v[38:41], v10, s[52:55], s8 offen
    s_add_u32 s8, s6, 1835008
    buffer_load_dwordx4 v[42:45], v10, s[52:55], s8 offen
    s_add_u32 s8, s6, 1900544
    buffer_load_dwordx4 v[46:49], v10, s[52:55], s8 offen
    s_add_u32 s8, s6, 1966080
    buffer_load_dwordx4 v[50:53], v10, s[52:55], s8 offen
    s_add_u32 s8, s6, 2031616
    buffer_load_dwordx4 v[54:57], v10, s[52:55], s8 offen
    s_add_u32 s8, s6, 2097152
    buffer_load_dwordx4 v[58:61], v10, s[52:55], s8 offen
    s_add_u32 s8, s6, 2162688
    buffer_load_dwordx4 v[62:65], v10, s[52:55], s8 offen
    s_add_u32 s8, s6, 2228224
    buffer_load_dwordx4 v[66:69], v10, s[52:55], s8 offen
    s_add_u32 s8, s6, 2293760
    buffer_load_dwordx4 v[70:73], v10, s[52:55], s8 offen
    s_add_u32 s8, s6, 2359296
    buffer_load_dwordx4 v[74:77], v10, s[52:55], s8 offen
    s_add_u32 s8, s6, 2424832
    buffer_load_dwordx4 v[78:81], v10, s[52:55], s8 offen
    s_add_u32 s8, s6, 2490368
    buffer_load_dwordx4 v[82:85], v10, s[52:55], s8 offen
    s_add_u32 s8, s6, 2555904
    buffer_load_dwordx4 v[86:89], v10, s[52:55], s8 offen
    s_add_u32 s8, s6, 2621440
    buffer_load_dwordx4 v[90:93], v10, s[52:55], s8 offen
    s_add_u32 s8, s6, 2686976
    buffer_load_dwordx4 v[94:97], v10, s[52:55], s8 offen
    s_add_u32 s8, s6, 2752512
    buffer_load_dwordx4 v[98:101], v10, s[52:55], s8 offen
    s_add_u32 s8, s6, 2818048
    buffer_load_dwordx4 v[102:105], v10, s[52:55], s8 offen
    s_add_u32 s8, s6, 2883584
    buffer_load_dwordx4 v[106:109], v10, s[52:55], s8 offen
    s_add_u32 s8, s6, 2949120
    buffer_load_dwordx4 v[110:113], v10, s[52:55], s8 offen
    s_add_u32 s8, s6, 3014656
    buffer_load_dwordx4 v[114:117], v10, s[52:55], s8 offen
    s_add_u32 s8, s6, 3080192
    buffer_load_dwordx4 v[118:121], v10, s[52:55], s8 offen
    s_waitcnt vmcnt(0)
    v_add_u32 v15, -114688, v12
    ds_write_b128 v15, v[26:29]
    v_add_u32 v15, -113536, v12
    ds_write_b128 v15, v[30:33]
    v_add_u32 v15, -112384, v12
    ds_write_b128 v15, v[34:37]
    v_add_u32 v15, -111232, v12
    ds_write_b128 v15, v[38:41]
    v_add_u32 v15, -96256, v12
    ds_write_b128 v15, v[42:45]
    v_add_u32 v15, -95104, v12
    ds_write_b128 v15, v[46:49]
    v_add_u32 v15, -93952, v12
    ds_write_b128 v15, v[50:53]
    v_add_u32 v15, -92800, v12
    ds_write_b128 v15, v[54:57]
    v_add_u32 v15, -77824, v12
    ds_write_b128 v15, v[58:61]
    v_add_u32 v15, -76672, v12
    ds_write_b128 v15, v[62:65]
    v_add_u32 v15, -75520, v12
    ds_write_b128 v15, v[66:69]
    v_add_u32 v15, -74368, v12
    ds_write_b128 v15, v[70:73]
    v_add_u32 v15, -59392, v12
    ds_write_b128 v15, v[74:77]
    v_add_u32 v15, -58240, v12
    ds_write_b128 v15, v[78:81]
    v_add_u32 v15, -57088, v12
    ds_write_b128 v15, v[82:85]
    v_add_u32 v15, -55936, v12
    ds_write_b128 v15, v[86:89]
    v_add_u32 v15, -40960, v12
    ds_write_b128 v15, v[90:93]
    v_add_u32 v15, -39808, v12
    ds_write_b128 v15, v[94:97]
    v_add_u32 v15, -38656, v12
    ds_write_b128 v15, v[98:101]
    v_add_u32 v15, -37504, v12
    ds_write_b128 v15, v[102:105]
    v_add_u32 v15, -22528, v12
    ds_write_b128 v15, v[106:109]
    v_add_u32 v15, -21376, v12
    ds_write_b128 v15, v[110:113]
    v_add_u32 v15, -20224, v12
    ds_write_b128 v15, v[114:117]
    v_add_u32 v15, -19072, v12
    ds_write_b128 v15, v[118:121]
    s_waitcnt lgkmcnt(0)
    v_add_u32 v15, -114688, v13
    ds_read_b64_tr_b16 v[26:27], v15 offset:0
    ds_read_b64_tr_b16 v[28:29], v15 offset:576
    ds_read_b64_tr_b16 v[30:31], v15 offset:32
    ds_read_b64_tr_b16 v[32:33], v15 offset:608
    ds_read_b64_tr_b16 v[34:35], v15 offset:64
    ds_read_b64_tr_b16 v[36:37], v15 offset:640
    ds_read_b64_tr_b16 v[38:39], v15 offset:96
    ds_read_b64_tr_b16 v[40:41], v15 offset:672
    v_add_u32 v15, -96256, v13
    ds_read_b64_tr_b16 v[42:43], v15 offset:0
    ds_read_b64_tr_b16 v[44:45], v15 offset:576
    ds_read_b64_tr_b16 v[46:47], v15 offset:32
    ds_read_b64_tr_b16 v[48:49], v15 offset:608
    ds_read_b64_tr_b16 v[50:51], v15 offset:64
    ds_read_b64_tr_b16 v[52:53], v15 offset:640
    ds_read_b64_tr_b16 v[54:55], v15 offset:96
    ds_read_b64_tr_b16 v[56:57], v15 offset:672
    v_add_u32 v15, -77824, v13
    ds_read_b64_tr_b16 v[58:59], v15 offset:0
    ds_read_b64_tr_b16 v[60:61], v15 offset:576
    ds_read_b64_tr_b16 v[62:63], v15 offset:32
    ds_read_b64_tr_b16 v[64:65], v15 offset:608
    ds_read_b64_tr_b16 v[66:67], v15 offset:64
    ds_read_b64_tr_b16 v[68:69], v15 offset:640
    ds_read_b64_tr_b16 v[70:71], v15 offset:96
    ds_read_b64_tr_b16 v[72:73], v15 offset:672
    v_add_u32 v15, -59392, v13
    ds_read_b64_tr_b16 v[74:75], v15 offset:0
    ds_read_b64_tr_b16 v[76:77], v15 offset:576
    ds_read_b64_tr_b16 v[78:79], v15 offset:32
    ds_read_b64_tr_b16 v[80:81], v15 offset:608
    ds_read_b64_tr_b16 v[82:83], v15 offset:64
    ds_read_b64_tr_b16 v[84:85], v15 offset:640
    ds_read_b64_tr_b16 v[86:87], v15 offset:96
    ds_read_b64_tr_b16 v[88:89], v15 offset:672
    v_add_u32 v15, -40960, v13
    ds_read_b64_tr_b16 v[90:91], v15 offset:0
    ds_read_b64_tr_b16 v[92:93], v15 offset:576
    ds_read_b64_tr_b16 v[94:95], v15 offset:32
    ds_read_b64_tr_b16 v[96:97], v15 offset:608
    ds_read_b64_tr_b16 v[98:99], v15 offset:64
    ds_read_b64_tr_b16 v[100:101], v15 offset:640
    ds_read_b64_tr_b16 v[102:103], v15 offset:96
    ds_read_b64_tr_b16 v[104:105], v15 offset:672
    v_add_u32 v15, -22528, v13
    ds_read_b64_tr_b16 v[106:107], v15 offset:0
    ds_read_b64_tr_b16 v[108:109], v15 offset:576
    ds_read_b64_tr_b16 v[110:111], v15 offset:32
    ds_read_b64_tr_b16 v[112:113], v15 offset:608
    ds_read_b64_tr_b16 v[114:115], v15 offset:64
    ds_read_b64_tr_b16 v[116:117], v15 offset:640
    ds_read_b64_tr_b16 v[118:119], v15 offset:96
    ds_read_b64_tr_b16 v[120:121], v15 offset:672
    s_waitcnt lgkmcnt(0)
    s_barrier
    v_accvgpr_write_b32 a24, v26
    v_accvgpr_write_b32 a25, v27
    v_accvgpr_write_b32 a26, v28
    v_accvgpr_write_b32 a27, v29
    v_accvgpr_write_b32 a80, v30
    v_accvgpr_write_b32 a81, v31
    v_accvgpr_write_b32 a82, v32
    v_accvgpr_write_b32 a83, v33
    v_accvgpr_write_b32 a136, v34
    v_accvgpr_write_b32 a137, v35
    v_accvgpr_write_b32 a138, v36
    v_accvgpr_write_b32 a139, v37
    v_accvgpr_write_b32 a192, v38
    v_accvgpr_write_b32 a193, v39
    v_accvgpr_write_b32 a194, v40
    v_accvgpr_write_b32 a195, v41
    v_accvgpr_write_b32 a28, v42
    v_accvgpr_write_b32 a29, v43
    v_accvgpr_write_b32 a30, v44
    v_accvgpr_write_b32 a31, v45
    v_accvgpr_write_b32 a84, v46
    v_accvgpr_write_b32 a85, v47
    v_accvgpr_write_b32 a86, v48
    v_accvgpr_write_b32 a87, v49
    v_accvgpr_write_b32 a140, v50
    v_accvgpr_write_b32 a141, v51
    v_accvgpr_write_b32 a142, v52
    v_accvgpr_write_b32 a143, v53
    v_accvgpr_write_b32 a196, v54
    v_accvgpr_write_b32 a197, v55
    v_accvgpr_write_b32 a198, v56
    v_accvgpr_write_b32 a199, v57
    v_accvgpr_write_b32 a32, v58
    v_accvgpr_write_b32 a33, v59
    v_accvgpr_write_b32 a34, v60
    v_accvgpr_write_b32 a35, v61
    v_accvgpr_write_b32 a88, v62
    v_accvgpr_write_b32 a89, v63
    v_accvgpr_write_b32 a90, v64
    v_accvgpr_write_b32 a91, v65
    v_accvgpr_write_b32 a144, v66
    v_accvgpr_write_b32 a145, v67
    v_accvgpr_write_b32 a146, v68
    v_accvgpr_write_b32 a147, v69
    v_accvgpr_write_b32 a200, v70
    v_accvgpr_write_b32 a201, v71
    v_accvgpr_write_b32 a202, v72
    v_accvgpr_write_b32 a203, v73
    v_accvgpr_write_b32 a36, v74
    v_accvgpr_write_b32 a37, v75
    v_accvgpr_write_b32 a38, v76
    v_accvgpr_write_b32 a39, v77
    v_accvgpr_write_b32 a92, v78
    v_accvgpr_write_b32 a93, v79
    v_accvgpr_write_b32 a94, v80
    v_accvgpr_write_b32 a95, v81
    v_accvgpr_write_b32 a148, v82
    v_accvgpr_write_b32 a149, v83
    v_accvgpr_write_b32 a150, v84
    v_accvgpr_write_b32 a151, v85
    v_accvgpr_write_b32 a204, v86
    v_accvgpr_write_b32 a205, v87
    v_accvgpr_write_b32 a206, v88
    v_accvgpr_write_b32 a207, v89
    v_accvgpr_write_b32 a40, v90
    v_accvgpr_write_b32 a41, v91
    v_accvgpr_write_b32 a42, v92
    v_accvgpr_write_b32 a43, v93
    v_accvgpr_write_b32 a96, v94
    v_accvgpr_write_b32 a97, v95
    v_accvgpr_write_b32 a98, v96
    v_accvgpr_write_b32 a99, v97
    v_accvgpr_write_b32 a152, v98
    v_accvgpr_write_b32 a153, v99
    v_accvgpr_write_b32 a154, v100
    v_accvgpr_write_b32 a155, v101
    v_accvgpr_write_b32 a208, v102
    v_accvgpr_write_b32 a209, v103
    v_accvgpr_write_b32 a210, v104
    v_accvgpr_write_b32 a211, v105
    v_accvgpr_write_b32 a44, v106
    v_accvgpr_write_b32 a45, v107
    v_accvgpr_write_b32 a46, v108
    v_accvgpr_write_b32 a47, v109
    v_accvgpr_write_b32 a100, v110
    v_accvgpr_write_b32 a101, v111
    v_accvgpr_write_b32 a102, v112
    v_accvgpr_write_b32 a103, v113
    v_accvgpr_write_b32 a156, v114
    v_accvgpr_write_b32 a157, v115
    v_accvgpr_write_b32 a158, v116
    v_accvgpr_write_b32 a159, v117
    v_accvgpr_write_b32 a212, v118
    v_accvgpr_write_b32 a213, v119
    v_accvgpr_write_b32 a214, v120
    v_accvgpr_write_b32 a215, v121
    s_waitcnt lgkmcnt(0)
    s_add_u32 s8, s6, 3145728
    buffer_load_dwordx4 v[26:29], v10, s[52:55], s8 offen
    s_add_u32 s8, s6, 3211264
    buffer_load_dwordx4 v[30:33], v10, s[52:55], s8 offen
    s_add_u32 s8, s6, 3276800
    buffer_load_dwordx4 v[34:37], v10, s[52:55], s8 offen
    s_add_u32 s8, s6, 3342336
    buffer_load_dwordx4 v[38:41], v10, s[52:55], s8 offen
    s_add_u32 s8, s6, 3407872
    buffer_load_dwordx4 v[42:45], v10, s[52:55], s8 offen
    s_add_u32 s8, s6, 3473408
    buffer_load_dwordx4 v[46:49], v10, s[52:55], s8 offen
    s_add_u32 s8, s6, 3538944
    buffer_load_dwordx4 v[50:53], v10, s[52:55], s8 offen
    s_add_u32 s8, s6, 3604480
    buffer_load_dwordx4 v[54:57], v10, s[52:55], s8 offen
    s_waitcnt vmcnt(0)
    v_add_u32 v15, -114688, v12
    ds_write_b128 v15, v[26:29]
    v_add_u32 v15, -113536, v12
    ds_write_b128 v15, v[30:33]
    v_add_u32 v15, -112384, v12
    ds_write_b128 v15, v[34:37]
    v_add_u32 v15, -111232, v12
    ds_write_b128 v15, v[38:41]
    v_add_u32 v15, -96256, v12
    ds_write_b128 v15, v[42:45]
    v_add_u32 v15, -95104, v12
    ds_write_b128 v15, v[46:49]
    v_add_u32 v15, -93952, v12
    ds_write_b128 v15, v[50:53]
    v_add_u32 v15, -92800, v12
    ds_write_b128 v15, v[54:57]
    s_waitcnt lgkmcnt(0)
    v_add_u32 v15, -114688, v13
    ds_read_b64_tr_b16 v[26:27], v15 offset:0
    ds_read_b64_tr_b16 v[28:29], v15 offset:576
    ds_read_b64_tr_b16 v[30:31], v15 offset:32
    ds_read_b64_tr_b16 v[32:33], v15 offset:608
    ds_read_b64_tr_b16 v[34:35], v15 offset:64
    ds_read_b64_tr_b16 v[36:37], v15 offset:640
    ds_read_b64_tr_b16 v[38:39], v15 offset:96
    ds_read_b64_tr_b16 v[40:41], v15 offset:672
    v_add_u32 v15, -96256, v13
    ds_read_b64_tr_b16 v[42:43], v15 offset:0
    ds_read_b64_tr_b16 v[44:45], v15 offset:576
    ds_read_b64_tr_b16 v[46:47], v15 offset:32
    ds_read_b64_tr_b16 v[48:49], v15 offset:608
    ds_read_b64_tr_b16 v[50:51], v15 offset:64
    ds_read_b64_tr_b16 v[52:53], v15 offset:640
    ds_read_b64_tr_b16 v[54:55], v15 offset:96
    ds_read_b64_tr_b16 v[56:57], v15 offset:672
    s_waitcnt lgkmcnt(0)
    s_barrier
    v_accvgpr_write_b32 a48, v26
    v_accvgpr_write_b32 a49, v27
    v_accvgpr_write_b32 a50, v28
    v_accvgpr_write_b32 a51, v29
    v_accvgpr_write_b32 a104, v30
    v_accvgpr_write_b32 a105, v31
    v_accvgpr_write_b32 a106, v32
    v_accvgpr_write_b32 a107, v33
    v_accvgpr_write_b32 a160, v34
    v_accvgpr_write_b32 a161, v35
    v_accvgpr_write_b32 a162, v36
    v_accvgpr_write_b32 a163, v37
    v_accvgpr_write_b32 a216, v38
    v_accvgpr_write_b32 a217, v39
    v_accvgpr_write_b32 a218, v40
    v_accvgpr_write_b32 a219, v41
    v_accvgpr_write_b32 a52, v42
    v_accvgpr_write_b32 a53, v43
    v_accvgpr_write_b32 a54, v44
    v_accvgpr_write_b32 a55, v45
    v_accvgpr_write_b32 a108, v46
    v_accvgpr_write_b32 a109, v47
    v_accvgpr_write_b32 a110, v48
    v_accvgpr_write_b32 a111, v49
    v_accvgpr_write_b32 a164, v50
    v_accvgpr_write_b32 a165, v51
    v_accvgpr_write_b32 a166, v52
    v_accvgpr_write_b32 a167, v53
    v_accvgpr_write_b32 a220, v54
    v_accvgpr_write_b32 a221, v55
    v_accvgpr_write_b32 a222, v56
    v_accvgpr_write_b32 a223, v57
    s_waitcnt lgkmcnt(0)
    s_mov_b32 s52, s22
    s_mov_b32 s53, s23
    s_mov_b32 s54, 0x7fffffff
    s_mov_b32 s55, 0x00020000
    s_add_u32 s8, s6, 0
    buffer_load_dwordx4 v[26:29], v10, s[52:55], s8 offen
    s_add_u32 s8, s6, 65536
    buffer_load_dwordx4 v[30:33], v10, s[52:55], s8 offen
    s_add_u32 s8, s6, 131072
    buffer_load_dwordx4 v[34:37], v10, s[52:55], s8 offen
    s_add_u32 s8, s6, 196608
    buffer_load_dwordx4 v[38:41], v10, s[52:55], s8 offen
    s_add_u32 s8, s6, 262144
    buffer_load_dwordx4 v[42:45], v10, s[52:55], s8 offen
    s_add_u32 s8, s6, 327680
    buffer_load_dwordx4 v[46:49], v10, s[52:55], s8 offen
    s_add_u32 s8, s6, 393216
    buffer_load_dwordx4 v[50:53], v10, s[52:55], s8 offen
    s_add_u32 s8, s6, 458752
    buffer_load_dwordx4 v[54:57], v10, s[52:55], s8 offen
    s_waitcnt vmcnt(0)
    v_add_u32 v15, 0, v12
    ds_write_b128 v15, v[26:29]
    v_add_u32 v15, 1152, v12
    ds_write_b128 v15, v[30:33]
    v_add_u32 v15, 2304, v12
    ds_write_b128 v15, v[34:37]
    v_add_u32 v15, 3456, v12
    ds_write_b128 v15, v[38:41]
    v_add_u32 v15, 18432, v12
    ds_write_b128 v15, v[42:45]
    v_add_u32 v15, 19584, v12
    ds_write_b128 v15, v[46:49]
    v_add_u32 v15, 20736, v12
    ds_write_b128 v15, v[50:53]
    v_add_u32 v15, 21888, v12
    ds_write_b128 v15, v[54:57]
    s_waitcnt lgkmcnt(0)
    v_add_u32 v15, 0, v13
    ds_read_b64_tr_b16 v[26:27], v15 offset:0
    ds_read_b64_tr_b16 v[28:29], v15 offset:576
    ds_read_b64_tr_b16 v[30:31], v15 offset:32
    ds_read_b64_tr_b16 v[32:33], v15 offset:608
    ds_read_b64_tr_b16 v[34:35], v15 offset:64
    ds_read_b64_tr_b16 v[36:37], v15 offset:640
    ds_read_b64_tr_b16 v[38:39], v15 offset:96
    ds_read_b64_tr_b16 v[40:41], v15 offset:672
    v_add_u32 v15, 18432, v13
    ds_read_b64_tr_b16 v[42:43], v15 offset:0
    ds_read_b64_tr_b16 v[44:45], v15 offset:576
    ds_read_b64_tr_b16 v[46:47], v15 offset:32
    ds_read_b64_tr_b16 v[48:49], v15 offset:608
    ds_read_b64_tr_b16 v[50:51], v15 offset:64
    ds_read_b64_tr_b16 v[52:53], v15 offset:640
    ds_read_b64_tr_b16 v[54:55], v15 offset:96
    ds_read_b64_tr_b16 v[56:57], v15 offset:672
    s_waitcnt lgkmcnt(0)
    s_barrier
    v_mov_b32 v128, v26
    v_mov_b32 v129, v27
    v_mov_b32 v130, v28
    v_mov_b32 v131, v29
    v_mov_b32 v184, v30
    v_mov_b32 v185, v31
    v_mov_b32 v186, v32
    v_mov_b32 v187, v33
    ds_write_b128 v14, v[34:37] offset:0
    ds_write_b128 v14, v[38:41] offset:14336
    v_mov_b32 v132, v42
    v_mov_b32 v133, v43
    v_mov_b32 v134, v44
    v_mov_b32 v135, v45
    v_mov_b32 v188, v46
    v_mov_b32 v189, v47
    v_mov_b32 v190, v48
    v_mov_b32 v191, v49
    ds_write_b128 v14, v[50:53] offset:1024
    ds_write_b128 v14, v[54:57] offset:15360
    s_waitcnt lgkmcnt(0)
    s_add_u32 s8, s6, 524288
    buffer_load_dwordx4 v[26:29], v10, s[52:55], s8 offen
    s_add_u32 s8, s6, 589824
    buffer_load_dwordx4 v[30:33], v10, s[52:55], s8 offen
    s_add_u32 s8, s6, 655360
    buffer_load_dwordx4 v[34:37], v10, s[52:55], s8 offen
    s_add_u32 s8, s6, 720896
    buffer_load_dwordx4 v[38:41], v10, s[52:55], s8 offen
    s_add_u32 s8, s6, 786432
    buffer_load_dwordx4 v[42:45], v10, s[52:55], s8 offen
    s_add_u32 s8, s6, 851968
    buffer_load_dwordx4 v[46:49], v10, s[52:55], s8 offen
    s_add_u32 s8, s6, 917504
    buffer_load_dwordx4 v[50:53], v10, s[52:55], s8 offen
    s_add_u32 s8, s6, 983040
    buffer_load_dwordx4 v[54:57], v10, s[52:55], s8 offen
    s_waitcnt vmcnt(0)
    v_add_u32 v15, 0, v12
    ds_write_b128 v15, v[26:29]
    v_add_u32 v15, 1152, v12
    ds_write_b128 v15, v[30:33]
    v_add_u32 v15, 2304, v12
    ds_write_b128 v15, v[34:37]
    v_add_u32 v15, 3456, v12
    ds_write_b128 v15, v[38:41]
    v_add_u32 v15, 18432, v12
    ds_write_b128 v15, v[42:45]
    v_add_u32 v15, 19584, v12
    ds_write_b128 v15, v[46:49]
    v_add_u32 v15, 20736, v12
    ds_write_b128 v15, v[50:53]
    v_add_u32 v15, 21888, v12
    ds_write_b128 v15, v[54:57]
    s_waitcnt lgkmcnt(0)
    v_add_u32 v15, 0, v13
    ds_read_b64_tr_b16 v[26:27], v15 offset:0
    ds_read_b64_tr_b16 v[28:29], v15 offset:576
    ds_read_b64_tr_b16 v[30:31], v15 offset:32
    ds_read_b64_tr_b16 v[32:33], v15 offset:608
    ds_read_b64_tr_b16 v[34:35], v15 offset:64
    ds_read_b64_tr_b16 v[36:37], v15 offset:640
    ds_read_b64_tr_b16 v[38:39], v15 offset:96
    ds_read_b64_tr_b16 v[40:41], v15 offset:672
    v_add_u32 v15, 18432, v13
    ds_read_b64_tr_b16 v[42:43], v15 offset:0
    ds_read_b64_tr_b16 v[44:45], v15 offset:576
    ds_read_b64_tr_b16 v[46:47], v15 offset:32
    ds_read_b64_tr_b16 v[48:49], v15 offset:608
    ds_read_b64_tr_b16 v[50:51], v15 offset:64
    ds_read_b64_tr_b16 v[52:53], v15 offset:640
    ds_read_b64_tr_b16 v[54:55], v15 offset:96
    ds_read_b64_tr_b16 v[56:57], v15 offset:672
    s_waitcnt lgkmcnt(0)
    s_barrier
    v_mov_b32 v136, v26
    v_mov_b32 v137, v27
    v_mov_b32 v138, v28
    v_mov_b32 v139, v29
    v_mov_b32 v192, v30
    v_mov_b32 v193, v31
    v_mov_b32 v194, v32
    v_mov_b32 v195, v33
    ds_write_b128 v14, v[34:37] offset:2048
    ds_write_b128 v14, v[38:41] offset:16384
    v_mov_b32 v140, v42
    v_mov_b32 v141, v43
    v_mov_b32 v142, v44
    v_mov_b32 v143, v45
    v_mov_b32 v196, v46
    v_mov_b32 v197, v47
    v_mov_b32 v198, v48
    v_mov_b32 v199, v49
    ds_write_b128 v14, v[50:53] offset:3072
    ds_write_b128 v14, v[54:57] offset:17408
    s_waitcnt lgkmcnt(0)
    s_add_u32 s8, s6, 1048576
    buffer_load_dwordx4 v[26:29], v10, s[52:55], s8 offen
    s_add_u32 s8, s6, 1114112
    buffer_load_dwordx4 v[30:33], v10, s[52:55], s8 offen
    s_add_u32 s8, s6, 1179648
    buffer_load_dwordx4 v[34:37], v10, s[52:55], s8 offen
    s_add_u32 s8, s6, 1245184
    buffer_load_dwordx4 v[38:41], v10, s[52:55], s8 offen
    s_add_u32 s8, s6, 1310720
    buffer_load_dwordx4 v[42:45], v10, s[52:55], s8 offen
    s_add_u32 s8, s6, 1376256
    buffer_load_dwordx4 v[46:49], v10, s[52:55], s8 offen
    s_add_u32 s8, s6, 1441792
    buffer_load_dwordx4 v[50:53], v10, s[52:55], s8 offen
    s_add_u32 s8, s6, 1507328
    buffer_load_dwordx4 v[54:57], v10, s[52:55], s8 offen
    s_waitcnt vmcnt(0)
    v_add_u32 v15, 0, v12
    ds_write_b128 v15, v[26:29]
    v_add_u32 v15, 1152, v12
    ds_write_b128 v15, v[30:33]
    v_add_u32 v15, 2304, v12
    ds_write_b128 v15, v[34:37]
    v_add_u32 v15, 3456, v12
    ds_write_b128 v15, v[38:41]
    v_add_u32 v15, 18432, v12
    ds_write_b128 v15, v[42:45]
    v_add_u32 v15, 19584, v12
    ds_write_b128 v15, v[46:49]
    v_add_u32 v15, 20736, v12
    ds_write_b128 v15, v[50:53]
    v_add_u32 v15, 21888, v12
    ds_write_b128 v15, v[54:57]
    s_waitcnt lgkmcnt(0)
    v_add_u32 v15, 0, v13
    ds_read_b64_tr_b16 v[26:27], v15 offset:0
    ds_read_b64_tr_b16 v[28:29], v15 offset:576
    ds_read_b64_tr_b16 v[30:31], v15 offset:32
    ds_read_b64_tr_b16 v[32:33], v15 offset:608
    ds_read_b64_tr_b16 v[34:35], v15 offset:64
    ds_read_b64_tr_b16 v[36:37], v15 offset:640
    ds_read_b64_tr_b16 v[38:39], v15 offset:96
    ds_read_b64_tr_b16 v[40:41], v15 offset:672
    v_add_u32 v15, 18432, v13
    ds_read_b64_tr_b16 v[42:43], v15 offset:0
    ds_read_b64_tr_b16 v[44:45], v15 offset:576
    ds_read_b64_tr_b16 v[46:47], v15 offset:32
    ds_read_b64_tr_b16 v[48:49], v15 offset:608
    ds_read_b64_tr_b16 v[50:51], v15 offset:64
    ds_read_b64_tr_b16 v[52:53], v15 offset:640
    ds_read_b64_tr_b16 v[54:55], v15 offset:96
    ds_read_b64_tr_b16 v[56:57], v15 offset:672
    s_waitcnt lgkmcnt(0)
    s_barrier
    v_mov_b32 v144, v26
    v_mov_b32 v145, v27
    v_mov_b32 v146, v28
    v_mov_b32 v147, v29
    v_mov_b32 v200, v30
    v_mov_b32 v201, v31
    v_mov_b32 v202, v32
    v_mov_b32 v203, v33
    ds_write_b128 v14, v[34:37] offset:4096
    ds_write_b128 v14, v[38:41] offset:18432
    v_mov_b32 v148, v42
    v_mov_b32 v149, v43
    v_mov_b32 v150, v44
    v_mov_b32 v151, v45
    v_mov_b32 v204, v46
    v_mov_b32 v205, v47
    v_mov_b32 v206, v48
    v_mov_b32 v207, v49
    ds_write_b128 v14, v[50:53] offset:5120
    ds_write_b128 v14, v[54:57] offset:19456
    s_waitcnt lgkmcnt(0)
    s_add_u32 s8, s6, 1572864
    buffer_load_dwordx4 v[26:29], v10, s[52:55], s8 offen
    s_add_u32 s8, s6, 1638400
    buffer_load_dwordx4 v[30:33], v10, s[52:55], s8 offen
    s_add_u32 s8, s6, 1703936
    buffer_load_dwordx4 v[34:37], v10, s[52:55], s8 offen
    s_add_u32 s8, s6, 1769472
    buffer_load_dwordx4 v[38:41], v10, s[52:55], s8 offen
    s_add_u32 s8, s6, 1835008
    buffer_load_dwordx4 v[42:45], v10, s[52:55], s8 offen
    s_add_u32 s8, s6, 1900544
    buffer_load_dwordx4 v[46:49], v10, s[52:55], s8 offen
    s_add_u32 s8, s6, 1966080
    buffer_load_dwordx4 v[50:53], v10, s[52:55], s8 offen
    s_add_u32 s8, s6, 2031616
    buffer_load_dwordx4 v[54:57], v10, s[52:55], s8 offen
    s_waitcnt vmcnt(0)
    v_add_u32 v15, 0, v12
    ds_write_b128 v15, v[26:29]
    v_add_u32 v15, 1152, v12
    ds_write_b128 v15, v[30:33]
    v_add_u32 v15, 2304, v12
    ds_write_b128 v15, v[34:37]
    v_add_u32 v15, 3456, v12
    ds_write_b128 v15, v[38:41]
    v_add_u32 v15, 18432, v12
    ds_write_b128 v15, v[42:45]
    v_add_u32 v15, 19584, v12
    ds_write_b128 v15, v[46:49]
    v_add_u32 v15, 20736, v12
    ds_write_b128 v15, v[50:53]
    v_add_u32 v15, 21888, v12
    ds_write_b128 v15, v[54:57]
    s_waitcnt lgkmcnt(0)
    v_add_u32 v15, 0, v13
    ds_read_b64_tr_b16 v[26:27], v15 offset:0
    ds_read_b64_tr_b16 v[28:29], v15 offset:576
    ds_read_b64_tr_b16 v[30:31], v15 offset:32
    ds_read_b64_tr_b16 v[32:33], v15 offset:608
    ds_read_b64_tr_b16 v[34:35], v15 offset:64
    ds_read_b64_tr_b16 v[36:37], v15 offset:640
    ds_read_b64_tr_b16 v[38:39], v15 offset:96
    ds_read_b64_tr_b16 v[40:41], v15 offset:672
    v_add_u32 v15, 18432, v13
    ds_read_b64_tr_b16 v[42:43], v15 offset:0
    ds_read_b64_tr_b16 v[44:45], v15 offset:576
    ds_read_b64_tr_b16 v[46:47], v15 offset:32
    ds_read_b64_tr_b16 v[48:49], v15 offset:608
    ds_read_b64_tr_b16 v[50:51], v15 offset:64
    ds_read_b64_tr_b16 v[52:53], v15 offset:640
    ds_read_b64_tr_b16 v[54:55], v15 offset:96
    ds_read_b64_tr_b16 v[56:57], v15 offset:672
    s_waitcnt lgkmcnt(0)
    s_barrier
    v_mov_b32 v152, v26
    v_mov_b32 v153, v27
    v_mov_b32 v154, v28
    v_mov_b32 v155, v29
    v_mov_b32 v208, v30
    v_mov_b32 v209, v31
    v_mov_b32 v210, v32
    v_mov_b32 v211, v33
    ds_write_b128 v14, v[34:37] offset:6144
    ds_write_b128 v14, v[38:41] offset:20480
    v_mov_b32 v156, v42
    v_mov_b32 v157, v43
    v_mov_b32 v158, v44
    v_mov_b32 v159, v45
    v_mov_b32 v212, v46
    v_mov_b32 v213, v47
    v_mov_b32 v214, v48
    v_mov_b32 v215, v49
    ds_write_b128 v14, v[50:53] offset:7168
    ds_write_b128 v14, v[54:57] offset:21504
    s_waitcnt lgkmcnt(0)
    s_add_u32 s8, s6, 2097152
    buffer_load_dwordx4 v[26:29], v10, s[52:55], s8 offen
    s_add_u32 s8, s6, 2162688
    buffer_load_dwordx4 v[30:33], v10, s[52:55], s8 offen
    s_add_u32 s8, s6, 2228224
    buffer_load_dwordx4 v[34:37], v10, s[52:55], s8 offen
    s_add_u32 s8, s6, 2293760
    buffer_load_dwordx4 v[38:41], v10, s[52:55], s8 offen
    s_add_u32 s8, s6, 2359296
    buffer_load_dwordx4 v[42:45], v10, s[52:55], s8 offen
    s_add_u32 s8, s6, 2424832
    buffer_load_dwordx4 v[46:49], v10, s[52:55], s8 offen
    s_add_u32 s8, s6, 2490368
    buffer_load_dwordx4 v[50:53], v10, s[52:55], s8 offen
    s_add_u32 s8, s6, 2555904
    buffer_load_dwordx4 v[54:57], v10, s[52:55], s8 offen
    s_waitcnt vmcnt(0)
    v_add_u32 v15, 0, v12
    ds_write_b128 v15, v[26:29]
    v_add_u32 v15, 1152, v12
    ds_write_b128 v15, v[30:33]
    v_add_u32 v15, 2304, v12
    ds_write_b128 v15, v[34:37]
    v_add_u32 v15, 3456, v12
    ds_write_b128 v15, v[38:41]
    v_add_u32 v15, 18432, v12
    ds_write_b128 v15, v[42:45]
    v_add_u32 v15, 19584, v12
    ds_write_b128 v15, v[46:49]
    v_add_u32 v15, 20736, v12
    ds_write_b128 v15, v[50:53]
    v_add_u32 v15, 21888, v12
    ds_write_b128 v15, v[54:57]
    s_waitcnt lgkmcnt(0)
    v_add_u32 v15, 0, v13
    ds_read_b64_tr_b16 v[26:27], v15 offset:0
    ds_read_b64_tr_b16 v[28:29], v15 offset:576
    ds_read_b64_tr_b16 v[30:31], v15 offset:32
    ds_read_b64_tr_b16 v[32:33], v15 offset:608
    ds_read_b64_tr_b16 v[34:35], v15 offset:64
    ds_read_b64_tr_b16 v[36:37], v15 offset:640
    ds_read_b64_tr_b16 v[38:39], v15 offset:96
    ds_read_b64_tr_b16 v[40:41], v15 offset:672
    v_add_u32 v15, 18432, v13
    ds_read_b64_tr_b16 v[42:43], v15 offset:0
    ds_read_b64_tr_b16 v[44:45], v15 offset:576
    ds_read_b64_tr_b16 v[46:47], v15 offset:32
    ds_read_b64_tr_b16 v[48:49], v15 offset:608
    ds_read_b64_tr_b16 v[50:51], v15 offset:64
    ds_read_b64_tr_b16 v[52:53], v15 offset:640
    ds_read_b64_tr_b16 v[54:55], v15 offset:96
    ds_read_b64_tr_b16 v[56:57], v15 offset:672
    s_waitcnt lgkmcnt(0)
    s_barrier
    v_mov_b32 v160, v26
    v_mov_b32 v161, v27
    v_mov_b32 v162, v28
    v_mov_b32 v163, v29
    v_mov_b32 v216, v30
    v_mov_b32 v217, v31
    v_mov_b32 v218, v32
    v_mov_b32 v219, v33
    ds_write_b128 v14, v[34:37] offset:8192
    ds_write_b128 v14, v[38:41] offset:22528
    v_mov_b32 v164, v42
    v_mov_b32 v165, v43
    v_mov_b32 v166, v44
    v_mov_b32 v167, v45
    v_mov_b32 v220, v46
    v_mov_b32 v221, v47
    v_mov_b32 v222, v48
    v_mov_b32 v223, v49
    ds_write_b128 v14, v[50:53] offset:9216
    ds_write_b128 v14, v[54:57] offset:23552
    s_waitcnt lgkmcnt(0)
    s_add_u32 s8, s6, 2621440
    buffer_load_dwordx4 v[26:29], v10, s[52:55], s8 offen
    s_add_u32 s8, s6, 2686976
    buffer_load_dwordx4 v[30:33], v10, s[52:55], s8 offen
    s_add_u32 s8, s6, 2752512
    buffer_load_dwordx4 v[34:37], v10, s[52:55], s8 offen
    s_add_u32 s8, s6, 2818048
    buffer_load_dwordx4 v[38:41], v10, s[52:55], s8 offen
    s_add_u32 s8, s6, 2883584
    buffer_load_dwordx4 v[42:45], v10, s[52:55], s8 offen
    s_add_u32 s8, s6, 2949120
    buffer_load_dwordx4 v[46:49], v10, s[52:55], s8 offen
    s_add_u32 s8, s6, 3014656
    buffer_load_dwordx4 v[50:53], v10, s[52:55], s8 offen
    s_add_u32 s8, s6, 3080192
    buffer_load_dwordx4 v[54:57], v10, s[52:55], s8 offen
    s_waitcnt vmcnt(0)
    v_add_u32 v15, 0, v12
    ds_write_b128 v15, v[26:29]
    v_add_u32 v15, 1152, v12
    ds_write_b128 v15, v[30:33]
    v_add_u32 v15, 2304, v12
    ds_write_b128 v15, v[34:37]
    v_add_u32 v15, 3456, v12
    ds_write_b128 v15, v[38:41]
    v_add_u32 v15, 18432, v12
    ds_write_b128 v15, v[42:45]
    v_add_u32 v15, 19584, v12
    ds_write_b128 v15, v[46:49]
    v_add_u32 v15, 20736, v12
    ds_write_b128 v15, v[50:53]
    v_add_u32 v15, 21888, v12
    ds_write_b128 v15, v[54:57]
    s_waitcnt lgkmcnt(0)
    v_add_u32 v15, 0, v13
    ds_read_b64_tr_b16 v[26:27], v15 offset:0
    ds_read_b64_tr_b16 v[28:29], v15 offset:576
    ds_read_b64_tr_b16 v[30:31], v15 offset:32
    ds_read_b64_tr_b16 v[32:33], v15 offset:608
    ds_read_b64_tr_b16 v[34:35], v15 offset:64
    ds_read_b64_tr_b16 v[36:37], v15 offset:640
    ds_read_b64_tr_b16 v[38:39], v15 offset:96
    ds_read_b64_tr_b16 v[40:41], v15 offset:672
    v_add_u32 v15, 18432, v13
    ds_read_b64_tr_b16 v[42:43], v15 offset:0
    ds_read_b64_tr_b16 v[44:45], v15 offset:576
    ds_read_b64_tr_b16 v[46:47], v15 offset:32
    ds_read_b64_tr_b16 v[48:49], v15 offset:608
    ds_read_b64_tr_b16 v[50:51], v15 offset:64
    ds_read_b64_tr_b16 v[52:53], v15 offset:640
    ds_read_b64_tr_b16 v[54:55], v15 offset:96
    ds_read_b64_tr_b16 v[56:57], v15 offset:672
    s_waitcnt lgkmcnt(0)
    s_barrier
    v_mov_b32 v168, v26
    v_mov_b32 v169, v27
    v_mov_b32 v170, v28
    v_mov_b32 v171, v29
    v_mov_b32 v224, v30
    v_mov_b32 v225, v31
    v_mov_b32 v226, v32
    v_mov_b32 v227, v33
    ds_write_b128 v14, v[34:37] offset:10240
    ds_write_b128 v14, v[38:41] offset:24576
    v_mov_b32 v172, v42
    v_mov_b32 v173, v43
    v_mov_b32 v174, v44
    v_mov_b32 v175, v45
    v_mov_b32 v228, v46
    v_mov_b32 v229, v47
    v_mov_b32 v230, v48
    v_mov_b32 v231, v49
    ds_write_b128 v14, v[50:53] offset:11264
    ds_write_b128 v14, v[54:57] offset:25600
    s_waitcnt lgkmcnt(0)
    s_add_u32 s8, s6, 3145728
    buffer_load_dwordx4 v[26:29], v10, s[52:55], s8 offen
    s_add_u32 s8, s6, 3211264
    buffer_load_dwordx4 v[30:33], v10, s[52:55], s8 offen
    s_add_u32 s8, s6, 3276800
    buffer_load_dwordx4 v[34:37], v10, s[52:55], s8 offen
    s_add_u32 s8, s6, 3342336
    buffer_load_dwordx4 v[38:41], v10, s[52:55], s8 offen
    s_add_u32 s8, s6, 3407872
    buffer_load_dwordx4 v[42:45], v10, s[52:55], s8 offen
    s_add_u32 s8, s6, 3473408
    buffer_load_dwordx4 v[46:49], v10, s[52:55], s8 offen
    s_add_u32 s8, s6, 3538944
    buffer_load_dwordx4 v[50:53], v10, s[52:55], s8 offen
    s_add_u32 s8, s6, 3604480
    buffer_load_dwordx4 v[54:57], v10, s[52:55], s8 offen
    s_waitcnt vmcnt(0)
    v_add_u32 v15, 0, v12
    ds_write_b128 v15, v[26:29]
    v_add_u32 v15, 1152, v12
    ds_write_b128 v15, v[30:33]
    v_add_u32 v15, 2304, v12
    ds_write_b128 v15, v[34:37]
    v_add_u32 v15, 3456, v12
    ds_write_b128 v15, v[38:41]
    v_add_u32 v15, 18432, v12
    ds_write_b128 v15, v[42:45]
    v_add_u32 v15, 19584, v12
    ds_write_b128 v15, v[46:49]
    v_add_u32 v15, 20736, v12
    ds_write_b128 v15, v[50:53]
    v_add_u32 v15, 21888, v12
    ds_write_b128 v15, v[54:57]
    s_waitcnt lgkmcnt(0)
    v_add_u32 v15, 0, v13
    ds_read_b64_tr_b16 v[26:27], v15 offset:0
    ds_read_b64_tr_b16 v[28:29], v15 offset:576
    ds_read_b64_tr_b16 v[30:31], v15 offset:32
    ds_read_b64_tr_b16 v[32:33], v15 offset:608
    ds_read_b64_tr_b16 v[34:35], v15 offset:64
    ds_read_b64_tr_b16 v[36:37], v15 offset:640
    ds_read_b64_tr_b16 v[38:39], v15 offset:96
    ds_read_b64_tr_b16 v[40:41], v15 offset:672
    v_add_u32 v15, 18432, v13
    ds_read_b64_tr_b16 v[42:43], v15 offset:0
    ds_read_b64_tr_b16 v[44:45], v15 offset:576
    ds_read_b64_tr_b16 v[46:47], v15 offset:32
    ds_read_b64_tr_b16 v[48:49], v15 offset:608
    ds_read_b64_tr_b16 v[50:51], v15 offset:64
    ds_read_b64_tr_b16 v[52:53], v15 offset:640
    ds_read_b64_tr_b16 v[54:55], v15 offset:96
    ds_read_b64_tr_b16 v[56:57], v15 offset:672
    s_waitcnt lgkmcnt(0)
    s_barrier
    v_mov_b32 v176, v26
    v_mov_b32 v177, v27
    v_mov_b32 v178, v28
    v_mov_b32 v179, v29
    v_mov_b32 v232, v30
    v_mov_b32 v233, v31
    v_mov_b32 v234, v32
    v_mov_b32 v235, v33
    ds_write_b128 v14, v[34:37] offset:12288
    ds_write_b128 v14, v[38:41] offset:26624
    v_mov_b32 v180, v42
    v_mov_b32 v181, v43
    v_mov_b32 v182, v44
    v_mov_b32 v183, v45
    v_mov_b32 v236, v46
    v_mov_b32 v237, v47
    v_mov_b32 v238, v48
    v_mov_b32 v239, v49
    ds_write_b128 v14, v[50:53] offset:13312
    ds_write_b128 v14, v[54:57] offset:27648
    s_waitcnt lgkmcnt(0)
    s_barrier
    v_and_b32 v9, 7, v3
    v_mul_u32_u24 v9, 912, v9
    v_lshlrev_b32 v10, 4, v4
    v_add_u32 v9, v9, v10
    v_add_u32 v9, 114688, v9
    v_lshlrev_b32 v15, 13, v3
    v_lshlrev_b32 v16, 3, v4
    v_add_u32 v15, v15, v16
    v_lshlrev_b32 v16, 2, v1
    v_add_u32 v17, 122880, v16
    s_mul_i32 s4, s3, 3072
    v_add_u32 v16, s4, v17
    v_mul_u32_u24 v18, 20, v3
    v_lshlrev_b32 v19, 1, v4
    v_add_u32 v18, v18, v19
    v_lshlrev_b32 v18, 3, v18
    s_mov_b32 s56, s46
    s_mov_b32 s57, s47
    s_mov_b32 s58, 0x7fffffff
    s_mov_b32 s59, 0x00020000
    s_mov_b32 s9, 0
aloop_15:
    s_lshl_b32 s10, s9, 18
    s_add_u32 s10, s10, s6
    s_add_u32 s10, s10, 16777216
    s_add_u32 s11, s10, 0
    buffer_load_dwordx2 v[112:113], v15, s[56:59], s11 offen offset:0
    buffer_load_dwordx2 v[114:115], v15, s[56:59], s11 offen offset:32
    buffer_load_dwordx2 v[116:117], v15, s[56:59], s11 offen offset:64
    buffer_load_dwordx2 v[118:119], v15, s[56:59], s11 offen offset:96
    s_add_u32 s11, s10, 131072
    buffer_load_dwordx2 v[120:121], v15, s[56:59], s11 offen offset:0
    buffer_load_dwordx2 v[122:123], v15, s[56:59], s11 offen offset:32
    buffer_load_dwordx2 v[124:125], v15, s[56:59], s11 offen offset:64
    buffer_load_dwordx2 v[126:127], v15, s[56:59], s11 offen offset:96
    s_mul_i32 s62, s9, 16384
    s_add_u32 s62, s62, 153092096
    s_add_u32 s63, s9, 1
    v_min_u32 v46, 27, v1
    v_lshlrev_b32 v46, 9, v46
    v_add_u32 v46, 504, v46
cheapm_17:
    buffer_load_dwordx2 v[32:33], v46, s[48:51], s62 offen sc1
    s_waitcnt vmcnt(0)
    v_cmp_ne_u32 vcc, s63, v33
    s_cbranch_vccnz cheapm_17
pollm_16:
    s_add_u32 s61, s62, 0
    buffer_load_dwordx2 v[32:33], v8, s[48:51], s61 offen sc1
    s_add_u32 s61, s62, 2048
    buffer_load_dwordx2 v[34:35], v8, s[48:51], s61 offen sc1
    s_add_u32 s61, s62, 4096
    buffer_load_dwordx2 v[36:37], v8, s[48:51], s61 offen sc1
    s_add_u32 s61, s62, 6144
    buffer_load_dwordx2 v[38:39], v8, s[48:51], s61 offen sc1
    s_add_u32 s61, s62, 8192
    buffer_load_dwordx2 v[40:41], v8, s[48:51], s61 offen sc1
    s_add_u32 s61, s62, 10240
    buffer_load_dwordx2 v[42:43], v8, s[48:51], s61 offen sc1
    s_add_u32 s61, s62, 12288
    buffer_load_dwordx2 v[44:45], v8, s[48:51], s61 offen sc1
    s_waitcnt vmcnt(0)
    v_xor_b32 v46, s63, v33
    v_xor_b32 v47, s63, v35
    v_or_b32 v46, v46, v47
    v_xor_b32 v47, s63, v37
    v_or_b32 v46, v46, v47
    v_xor_b32 v47, s63, v39
    v_or_b32 v46, v46, v47
    v_xor_b32 v47, s63, v41
    v_or_b32 v46, v46, v47
    v_xor_b32 v47, s63, v43
    v_or_b32 v46, v46, v47
    v_xor_b32 v47, s63, v45
    v_or_b32 v46, v46, v47
    v_cmp_ne_u32 vcc, 0, v46
    s_cbranch_vccnz pollm_16
    ds_write_b32 v7, v32 offset:0
    ds_write_b32 v7, v34 offset:128
    ds_write_b32 v7, v36 offset:256
    ds_write_b32 v7, v38 offset:384
    ds_write_b32 v7, v40 offset:512
    ds_write_b32 v7, v42 offset:640
    ds_write_b32 v7, v44 offset:768
    s_waitcnt lgkmcnt(0)
    s_barrier
    ds_read_b128 v[56:59], v9 offset:0
    ds_read_b128 v[60:63], v9 offset:64
    ds_read_b128 v[64:67], v9 offset:128
    ds_read_b128 v[68:71], v9 offset:192
    ds_read_b128 v[72:75], v9 offset:256
    ds_read_b128 v[76:79], v9 offset:320
    ds_read_b128 v[80:83], v9 offset:384
    ds_read_b128 v[84:87], v9 offset:448
    ds_read_b128 v[88:91], v9 offset:512
    ds_read_b128 v[92:95], v9 offset:576
    ds_read_b128 v[96:99], v9 offset:640
    ds_read_b128 v[100:103], v9 offset:704
    ds_read_b128 v[104:107], v9 offset:768
    ds_read_b128 v[108:111], v9 offset:832
    v_mov_b32 v24, 0
    v_mov_b32 v25, 0
    v_mov_b32 v26, 0
    v_mov_b32 v27, 0
    v_mov_b32 v28, 0
    v_mov_b32 v29, 0
    v_mov_b32 v30, 0
    v_mov_b32 v31, 0
    v_mov_b32 v32, 0
    v_mov_b32 v33, 0
    v_mov_b32 v34, 0
    v_mov_b32 v35, 0
    v_mov_b32 v36, 0
    v_mov_b32 v37, 0
    v_mov_b32 v38, 0
    v_mov_b32 v39, 0
    v_mov_b32 v40, 0
    v_mov_b32 v41, 0
    v_mov_b32 v42, 0
    v_mov_b32 v43, 0
    v_mov_b32 v44, 0
    v_mov_b32 v45, 0
    v_mov_b32 v46, 0
    v_mov_b32 v47, 0
    v_mov_b32 v48, 0
    v_mov_b32 v49, 0
    v_mov_b32 v50, 0
    v_mov_b32 v51, 0
    v_mov_b32 v52, 0
    v_mov_b32 v53, 0
    v_mov_b32 v54, 0
    v_mov_b32 v55, 0
    s_waitcnt lgkmcnt(0)
    ds_read_b128 v[240:243], v14 offset:0
    ds_read_b128 v[244:247], v14 offset:14336
    ds_read_b128 v[248:251], v14 offset:1024
    ds_read_b128 v[252:255], v14 offset:15360
    v_mfma_f32_16x16x32_bf16 v[24:27], a[0:3], v[56:59], v[24:27]
    v_mfma_f32_16x16x32_bf16 v[28:31], a[56:59], v[56:59], v[28:31]
    v_mfma_f32_16x16x32_bf16 v[32:35], a[112:115], v[56:59], v[32:35]
    v_mfma_f32_16x16x32_bf16 v[36:39], a[168:171], v[56:59], v[36:39]
    v_mfma_f32_16x16x32_bf16 v[40:43], v[128:131], v[56:59], v[40:43]
    v_mfma_f32_16x16x32_bf16 v[44:47], v[184:187], v[56:59], v[44:47]
    s_waitcnt lgkmcnt(2)
    v_mfma_f32_16x16x32_bf16 v[48:51], v[240:243], v[56:59], v[48:51]
    v_mfma_f32_16x16x32_bf16 v[52:55], v[244:247], v[56:59], v[52:55]
    ds_read_b128 v[240:243], v14 offset:2048
    ds_read_b128 v[244:247], v14 offset:16384
    v_mfma_f32_16x16x32_bf16 v[24:27], a[4:7], v[60:63], v[24:27]
    v_mfma_f32_16x16x32_bf16 v[28:31], a[60:63], v[60:63], v[28:31]
    v_mfma_f32_16x16x32_bf16 v[32:35], a[116:119], v[60:63], v[32:35]
    v_mfma_f32_16x16x32_bf16 v[36:39], a[172:175], v[60:63], v[36:39]
    v_mfma_f32_16x16x32_bf16 v[40:43], v[132:135], v[60:63], v[40:43]
    v_mfma_f32_16x16x32_bf16 v[44:47], v[188:191], v[60:63], v[44:47]
    s_waitcnt lgkmcnt(2)
    v_mfma_f32_16x16x32_bf16 v[48:51], v[248:251], v[60:63], v[48:51]
    v_mfma_f32_16x16x32_bf16 v[52:55], v[252:255], v[60:63], v[52:55]
    ds_read_b128 v[248:251], v14 offset:3072
    ds_read_b128 v[252:255], v14 offset:17408
    v_mfma_f32_16x16x32_bf16 v[24:27], a[8:11], v[64:67], v[24:27]
    v_mfma_f32_16x16x32_bf16 v[28:31], a[64:67], v[64:67], v[28:31]
    v_mfma_f32_16x16x32_bf16 v[32:35], a[120:123], v[64:67], v[32:35]
    v_mfma_f32_16x16x32_bf16 v[36:39], a[176:179], v[64:67], v[36:39]
    v_mfma_f32_16x16x32_bf16 v[40:43], v[136:139], v[64:67], v[40:43]
    v_mfma_f32_16x16x32_bf16 v[44:47], v[192:195], v[64:67], v[44:47]
    s_waitcnt lgkmcnt(2)
    v_mfma_f32_16x16x32_bf16 v[48:51], v[240:243], v[64:67], v[48:51]
    v_mfma_f32_16x16x32_bf16 v[52:55], v[244:247], v[64:67], v[52:55]
    ds_read_b128 v[240:243], v14 offset:4096
    ds_read_b128 v[244:247], v14 offset:18432
    v_mfma_f32_16x16x32_bf16 v[24:27], a[12:15], v[68:71], v[24:27]
    v_mfma_f32_16x16x32_bf16 v[28:31], a[68:71], v[68:71], v[28:31]
    v_mfma_f32_16x16x32_bf16 v[32:35], a[124:127], v[68:71], v[32:35]
    v_mfma_f32_16x16x32_bf16 v[36:39], a[180:183], v[68:71], v[36:39]
    v_mfma_f32_16x16x32_bf16 v[40:43], v[140:143], v[68:71], v[40:43]
    v_mfma_f32_16x16x32_bf16 v[44:47], v[196:199], v[68:71], v[44:47]
    s_waitcnt lgkmcnt(2)
    v_mfma_f32_16x16x32_bf16 v[48:51], v[248:251], v[68:71], v[48:51]
    v_mfma_f32_16x16x32_bf16 v[52:55], v[252:255], v[68:71], v[52:55]
    ds_read_b128 v[248:251], v14 offset:5120
    ds_read_b128 v[252:255], v14 offset:19456
    v_mfma_f32_16x16x32_bf16 v[24:27], a[16:19], v[72:75], v[24:27]
    v_mfma_f32_16x16x32_bf16 v[28:31], a[72:75], v[72:75], v[28:31]
    v_mfma_f32_16x16x32_bf16 v[32:35], a[128:131], v[72:75], v[32:35]
    v_mfma_f32_16x16x32_bf16 v[36:39], a[184:187], v[72:75], v[36:39]
    v_mfma_f32_16x16x32_bf16 v[40:43], v[144:147], v[72:75], v[40:43]
    v_mfma_f32_16x16x32_bf16 v[44:47], v[200:203], v[72:75], v[44:47]
    s_waitcnt lgkmcnt(2)
    v_mfma_f32_16x16x32_bf16 v[48:51], v[240:243], v[72:75], v[48:51]
    v_mfma_f32_16x16x32_bf16 v[52:55], v[244:247], v[72:75], v[52:55]
    ds_read_b128 v[240:243], v14 offset:6144
    ds_read_b128 v[244:247], v14 offset:20480
    v_mfma_f32_16x16x32_bf16 v[24:27], a[20:23], v[76:79], v[24:27]
    v_mfma_f32_16x16x32_bf16 v[28:31], a[76:79], v[76:79], v[28:31]
    v_mfma_f32_16x16x32_bf16 v[32:35], a[132:135], v[76:79], v[32:35]
    v_mfma_f32_16x16x32_bf16 v[36:39], a[188:191], v[76:79], v[36:39]
    v_mfma_f32_16x16x32_bf16 v[40:43], v[148:151], v[76:79], v[40:43]
    v_mfma_f32_16x16x32_bf16 v[44:47], v[204:207], v[76:79], v[44:47]
    s_waitcnt lgkmcnt(2)
    v_mfma_f32_16x16x32_bf16 v[48:51], v[248:251], v[76:79], v[48:51]
    v_mfma_f32_16x16x32_bf16 v[52:55], v[252:255], v[76:79], v[52:55]
    ds_read_b128 v[248:251], v14 offset:7168
    ds_read_b128 v[252:255], v14 offset:21504
    v_mfma_f32_16x16x32_bf16 v[24:27], a[24:27], v[80:83], v[24:27]
    v_mfma_f32_16x16x32_bf16 v[28:31], a[80:83], v[80:83], v[28:31]
    v_mfma_f32_16x16x32_bf16 v[32:35], a[136:139], v[80:83], v[32:35]
    v_mfma_f32_16x16x32_bf16 v[36:39], a[192:195], v[80:83], v[36:39]
    v_mfma_f32_16x16x32_bf16 v[40:43], v[152:155], v[80:83], v[40:43]
    v_mfma_f32_16x16x32_bf16 v[44:47], v[208:211], v[80:83], v[44:47]
    s_waitcnt lgkmcnt(2)
    v_mfma_f32_16x16x32_bf16 v[48:51], v[240:243], v[80:83], v[48:51]
    v_mfma_f32_16x16x32_bf16 v[52:55], v[244:247], v[80:83], v[52:55]
    ds_read_b128 v[240:243], v14 offset:8192
    ds_read_b128 v[244:247], v14 offset:22528
    v_mfma_f32_16x16x32_bf16 v[24:27], a[28:31], v[84:87], v[24:27]
    v_mfma_f32_16x16x32_bf16 v[28:31], a[84:87], v[84:87], v[28:31]
    v_mfma_f32_16x16x32_bf16 v[32:35], a[140:143], v[84:87], v[32:35]
    v_mfma_f32_16x16x32_bf16 v[36:39], a[196:199], v[84:87], v[36:39]
    v_mfma_f32_16x16x32_bf16 v[40:43], v[156:159], v[84:87], v[40:43]
    v_mfma_f32_16x16x32_bf16 v[44:47], v[212:215], v[84:87], v[44:47]
    s_waitcnt lgkmcnt(2)
    v_mfma_f32_16x16x32_bf16 v[48:51], v[248:251], v[84:87], v[48:51]
    v_mfma_f32_16x16x32_bf16 v[52:55], v[252:255], v[84:87], v[52:55]
    ds_read_b128 v[248:251], v14 offset:9216
    ds_read_b128 v[252:255], v14 offset:23552
    v_mfma_f32_16x16x32_bf16 v[24:27], a[32:35], v[88:91], v[24:27]
    v_mfma_f32_16x16x32_bf16 v[28:31], a[88:91], v[88:91], v[28:31]
    v_mfma_f32_16x16x32_bf16 v[32:35], a[144:147], v[88:91], v[32:35]
    v_mfma_f32_16x16x32_bf16 v[36:39], a[200:203], v[88:91], v[36:39]
    v_mfma_f32_16x16x32_bf16 v[40:43], v[160:163], v[88:91], v[40:43]
    v_mfma_f32_16x16x32_bf16 v[44:47], v[216:219], v[88:91], v[44:47]
    s_waitcnt lgkmcnt(2)
    v_mfma_f32_16x16x32_bf16 v[48:51], v[240:243], v[88:91], v[48:51]
    v_mfma_f32_16x16x32_bf16 v[52:55], v[244:247], v[88:91], v[52:55]
    ds_read_b128 v[240:243], v14 offset:10240
    ds_read_b128 v[244:247], v14 offset:24576
    v_mfma_f32_16x16x32_bf16 v[24:27], a[36:39], v[92:95], v[24:27]
    v_mfma_f32_16x16x32_bf16 v[28:31], a[92:95], v[92:95], v[28:31]
    v_mfma_f32_16x16x32_bf16 v[32:35], a[148:151], v[92:95], v[32:35]
    v_mfma_f32_16x16x32_bf16 v[36:39], a[204:207], v[92:95], v[36:39]
    v_mfma_f32_16x16x32_bf16 v[40:43], v[164:167], v[92:95], v[40:43]
    v_mfma_f32_16x16x32_bf16 v[44:47], v[220:223], v[92:95], v[44:47]
    s_waitcnt lgkmcnt(2)
    v_mfma_f32_16x16x32_bf16 v[48:51], v[248:251], v[92:95], v[48:51]
    v_mfma_f32_16x16x32_bf16 v[52:55], v[252:255], v[92:95], v[52:55]
    ds_read_b128 v[248:251], v14 offset:11264
    ds_read_b128 v[252:255], v14 offset:25600
    v_mfma_f32_16x16x32_bf16 v[24:27], a[40:43], v[96:99], v[24:27]
    v_mfma_f32_16x16x32_bf16 v[28:31], a[96:99], v[96:99], v[28:31]
    v_mfma_f32_16x16x32_bf16 v[32:35], a[152:155], v[96:99], v[32:35]
    v_mfma_f32_16x16x32_bf16 v[36:39], a[208:211], v[96:99], v[36:39]
    v_mfma_f32_16x16x32_bf16 v[40:43], v[168:171], v[96:99], v[40:43]
    v_mfma_f32_16x16x32_bf16 v[44:47], v[224:227], v[96:99], v[44:47]
    s_waitcnt lgkmcnt(2)
    v_mfma_f32_16x16x32_bf16 v[48:51], v[240:243], v[96:99], v[48:51]
    v_mfma_f32_16x16x32_bf16 v[52:55], v[244:247], v[96:99], v[52:55]
    ds_read_b128 v[240:243], v14 offset:12288
    ds_read_b128 v[244:247], v14 offset:26624
    v_mfma_f32_16x16x32_bf16 v[24:27], a[44:47], v[100:103], v[24:27]
    v_mfma_f32_16x16x32_bf16 v[28:31], a[100:103], v[100:103], v[28:31]
    v_mfma_f32_16x16x32_bf16 v[32:35], a[156:159], v[100:103], v[32:35]
    v_mfma_f32_16x16x32_bf16 v[36:39], a[212:215], v[100:103], v[36:39]
    v_mfma_f32_16x16x32_bf16 v[40:43], v[172:175], v[100:103], v[40:43]
    v_mfma_f32_16x16x32_bf16 v[44:47], v[228:231], v[100:103], v[44:47]
    s_waitcnt lgkmcnt(2)
    v_mfma_f32_16x16x32_bf16 v[48:51], v[248:251], v[100:103], v[48:51]
    v_mfma_f32_16x16x32_bf16 v[52:55], v[252:255], v[100:103], v[52:55]
    ds_read_b128 v[248:251], v14 offset:13312
    ds_read_b128 v[252:255], v14 offset:27648
    v_mfma_f32_16x16x32_bf16 v[24:27], a[48:51], v[104:107], v[24:27]
    v_mfma_f32_16x16x32_bf16 v[28:31], a[104:107], v[104:107], v[28:31]
    v_mfma_f32_16x16x32_bf16 v[32:35], a[160:163], v[104:107], v[32:35]
    v_mfma_f32_16x16x32_bf16 v[36:39], a[216:219], v[104:107], v[36:39]
    v_mfma_f32_16x16x32_bf16 v[40:43], v[176:179], v[104:107], v[40:43]
    v_mfma_f32_16x16x32_bf16 v[44:47], v[232:235], v[104:107], v[44:47]
    s_waitcnt lgkmcnt(2)
    v_mfma_f32_16x16x32_bf16 v[48:51], v[240:243], v[104:107], v[48:51]
    v_mfma_f32_16x16x32_bf16 v[52:55], v[244:247], v[104:107], v[52:55]
    v_mfma_f32_16x16x32_bf16 v[24:27], a[52:55], v[108:111], v[24:27]
    v_mfma_f32_16x16x32_bf16 v[28:31], a[108:111], v[108:111], v[28:31]
    v_mfma_f32_16x16x32_bf16 v[32:35], a[164:167], v[108:111], v[32:35]
    v_mfma_f32_16x16x32_bf16 v[36:39], a[220:223], v[108:111], v[36:39]
    v_mfma_f32_16x16x32_bf16 v[40:43], v[180:183], v[108:111], v[40:43]
    v_mfma_f32_16x16x32_bf16 v[44:47], v[236:239], v[108:111], v[44:47]
    s_waitcnt lgkmcnt(0)
    v_mfma_f32_16x16x32_bf16 v[48:51], v[248:251], v[108:111], v[48:51]
    v_mfma_f32_16x16x32_bf16 v[52:55], v[252:255], v[108:111], v[52:55]
    s_nop 7
    s_nop 1
    v_cvt_pk_bf16_f32 v56, v24, v25
    v_cvt_pk_bf16_f32 v57, v26, v27
    v_cvt_pk_bf16_f32 v64, v40, v41
    v_cvt_pk_bf16_f32 v65, v42, v43
    v_cvt_pk_bf16_f32 v58, v28, v29
    v_cvt_pk_bf16_f32 v59, v30, v31
    v_cvt_pk_bf16_f32 v66, v44, v45
    v_cvt_pk_bf16_f32 v67, v46, v47
    v_cvt_pk_bf16_f32 v60, v32, v33
    v_cvt_pk_bf16_f32 v61, v34, v35
    v_cvt_pk_bf16_f32 v68, v48, v49
    v_cvt_pk_bf16_f32 v69, v50, v51
    v_cvt_pk_bf16_f32 v62, v36, v37
    v_cvt_pk_bf16_f32 v63, v38, v39
    v_cvt_pk_bf16_f32 v70, v52, v53
    v_cvt_pk_bf16_f32 v71, v54, v55
    v_mov_b32 v72, 0
    v_mov_b32 v73, 0
    v_mov_b32 v74, 0
    v_mov_b32 v75, 0
    v_mov_b32 v76, 0
    v_mov_b32 v77, 0
    v_mov_b32 v78, 0
    v_mov_b32 v79, 0
    v_mov_b32 v80, 0
    v_mov_b32 v81, 0
    v_mov_b32 v82, 0
    v_mov_b32 v83, 0
    s_waitcnt vmcnt(0)
    s_nop 1
    v_mfma_f32_16x16x32_bf16 v[72:75], v[64:67], v[56:59], v[72:75]
    v_mfma_f32_16x16x32_bf16 v[76:79], v[112:115], v[56:59], v[76:79]
    v_mfma_f32_16x16x32_bf16 v[80:83], v[120:123], v[56:59], v[80:83]
    v_mfma_f32_16x16x32_bf16 v[72:75], v[68:71], v[60:63], v[72:75]
    v_mfma_f32_16x16x32_bf16 v[76:79], v[116:119], v[60:63], v[76:79]
    v_mfma_f32_16x16x32_bf16 v[80:83], v[124:127], v[60:63], v[80:83]
    s_nop 7
    s_nop 1
    v_mul_u32_u24 v20, 48, v1
    v_add_u32 v20, s4, v20
    v_add_u32 v20, 122880, v20
    ds_write_b128 v20, v[72:75] offset:0
    ds_write_b128 v20, v[76:79] offset:16
    ds_write_b128 v20, v[80:83] offset:32
    s_waitcnt lgkmcnt(0)
    s_barrier
    s_cmp_lg_u32 s3, 0
    s_cbranch_scc1 nopub_18
    ds_read_b128 v[24:27], v20 offset:0
    ds_read_b128 v[28:31], v20 offset:16
    ds_read_b128 v[32:35], v20 offset:32
    ds_read_b128 v[36:39], v20 offset:3072
    ds_read_b128 v[40:43], v20 offset:3088
    ds_read_b128 v[44:47], v20 offset:3104
    ds_read_b128 v[48:51], v20 offset:6144
    ds_read_b128 v[52:55], v20 offset:6160
    ds_read_b128 v[56:59], v20 offset:6176
    ds_read_b128 v[60:63], v20 offset:9216
    ds_read_b128 v[64:67], v20 offset:9232
    ds_read_b128 v[68:71], v20 offset:9248
    s_waitcnt lgkmcnt(0)
    v_add_f32 v72, v24, v36
    v_add_f32 v48, v48, v60
    v_add_f32 v73, v25, v37
    v_add_f32 v49, v49, v61
    v_add_f32 v74, v26, v38
    v_add_f32 v50, v50, v62
    v_add_f32 v75, v27, v39
    v_add_f32 v51, v51, v63
    v_add_f32 v76, v28, v40
    v_add_f32 v52, v52, v64
    v_add_f32 v77, v29, v41
    v_add_f32 v53, v53, v65
    v_add_f32 v78, v30, v42
    v_add_f32 v54, v54, v66
    v_add_f32 v79, v31, v43
    v_add_f32 v55, v55, v67
    v_add_f32 v80, v32, v44
    v_add_f32 v56, v56, v68
    v_add_f32 v81, v33, v45
    v_add_f32 v57, v57, v69
    v_add_f32 v82, v34, v46
    v_add_f32 v58, v58, v70
    v_add_f32 v83, v35, v47
    v_add_f32 v59, v59, v71
    v_add_f32 v72, v72, v48
    v_add_f32 v73, v73, v49
    v_add_f32 v74, v74, v50
    v_add_f32 v75, v75, v51
    v_add_f32 v76, v76, v52
    v_add_f32 v77, v77, v53
    v_add_f32 v78, v78, v54
    v_add_f32 v79, v79, v55
    v_add_f32 v80, v80, v56
    v_add_f32 v81, v81, v57
    v_add_f32 v82, v82, v58
    v_add_f32 v83, v83, v59
    v_cvt_pk_bf16_f32 v24, v72, v73
    v_lshlrev_b32 v72, 16, v24
    v_and_b32 v73, 0xffff0000, v24
    v_cvt_pk_bf16_f32 v24, v74, v75
    v_lshlrev_b32 v74, 16, v24
    v_and_b32 v75, 0xffff0000, v24
    v_cvt_pk_bf16_f32 v24, v76, v77
    v_lshlrev_b32 v76, 16, v24
    v_and_b32 v77, 0xffff0000, v24
    v_cvt_pk_bf16_f32 v24, v78, v79
    v_lshlrev_b32 v78, 16, v24
    v_and_b32 v79, 0xffff0000, v24
    v_cvt_pk_bf16_f32 v24, v80, v81
    v_lshlrev_b32 v80, 16, v24
    v_and_b32 v81, 0xffff0000, v24
    v_cvt_pk_bf16_f32 v24, v82, v83
    v_lshlrev_b32 v82, 16, v24
    v_and_b32 v83, 0xffff0000, v24
    v_mul_f32 v72, 0x3d800000, v72
    v_mul_f32 v73, 0x3d800000, v73
    v_mul_f32 v74, 0x3d800000, v74
    v_mul_f32 v75, 0x3d800000, v75
    v_mul_f32 v76, 0x3d800000, v76
    v_mul_f32 v77, 0x3d800000, v77
    v_mul_f32 v78, 0x3d800000, v78
    v_mul_f32 v79, 0x3d800000, v79
    v_mul_f32 v80, 0x3d800000, v80
    v_mul_f32 v81, 0x3d800000, v81
    v_mul_f32 v82, 0x3d800000, v82
    v_mul_f32 v83, 0x3d800000, v83
    v_cmp_gt_u32 vcc, 2, v4
    s_mov_b32 s12, 0xff800000
    v_mov_b32 v96, s12
    v_cndmask_b32 v72, v96, v72, vcc
    v_cndmask_b32 v73, v96, v73, vcc
    v_cndmask_b32 v74, v96, v74, vcc
    v_cndmask_b32 v75, v96, v75, vcc
    v_max3_f32 v97, v72, v73, v74
    v_max3_f32 v97, v97, v75, v76
    v_max3_f32 v97, v97, v77, v78
    v_max3_f32 v97, v97, v79, v80
    v_max3_f32 v97, v97, v81, v82
    v_max_f32 v97, v97, v83
    ds_bpermute_b32 v98, v5, v97
    s_waitcnt lgkmcnt(0)
    v_max_f32 v97, v97, v98
    ds_bpermute_b32 v98, v6, v97
    s_waitcnt lgkmcnt(0)
    v_max_f32 v97, v97, v98
    s_mov_b32 s12, 0x3fb8aa3b
    v_sub_f32 v72, v72, v97
    v_mul_f32 v72, s12, v72
    v_exp_f32 v72, v72
    v_sub_f32 v73, v73, v97
    v_mul_f32 v73, s12, v73
    v_exp_f32 v73, v73
    v_sub_f32 v74, v74, v97
    v_mul_f32 v74, s12, v74
    v_exp_f32 v74, v74
    v_sub_f32 v75, v75, v97
    v_mul_f32 v75, s12, v75
    v_exp_f32 v75, v75
    v_sub_f32 v76, v76, v97
    v_mul_f32 v76, s12, v76
    v_exp_f32 v76, v76
    v_sub_f32 v77, v77, v97
    v_mul_f32 v77, s12, v77
    v_exp_f32 v77, v77
    v_sub_f32 v78, v78, v97
    v_mul_f32 v78, s12, v78
    v_exp_f32 v78, v78
    v_sub_f32 v79, v79, v97
    v_mul_f32 v79, s12, v79
    v_exp_f32 v79, v79
    v_sub_f32 v80, v80, v97
    v_mul_f32 v80, s12, v80
    v_exp_f32 v80, v80
    v_sub_f32 v81, v81, v97
    v_mul_f32 v81, s12, v81
    v_exp_f32 v81, v81
    v_sub_f32 v82, v82, v97
    v_mul_f32 v82, s12, v82
    v_exp_f32 v82, v82
    v_sub_f32 v83, v83, v97
    v_mul_f32 v83, s12, v83
    v_exp_f32 v83, v83
    s_nop 0
    v_add_f32 v98, v72, v73
    v_add_f32 v98, v98, v74
    v_add_f32 v98, v98, v75
    v_add_f32 v98, v98, v76
    v_add_f32 v98, v98, v77
    v_add_f32 v98, v98, v78
    v_add_f32 v98, v98, v79
    v_add_f32 v98, v98, v80
    v_add_f32 v98, v98, v81
    v_add_f32 v98, v98, v82
    v_add_f32 v98, v98, v83
    ds_bpermute_b32 v99, v5, v98
    s_waitcnt lgkmcnt(0)
    v_add_f32 v98, v98, v99
    ds_bpermute_b32 v99, v6, v98
    s_waitcnt lgkmcnt(0)
    v_add_f32 v98, v98, v99
    v_rcp_f32 v98, v98
    s_nop 0
    v_mul_f32 v72, v72, v98
    v_mul_f32 v73, v73, v98
    v_mul_f32 v74, v74, v98
    v_mul_f32 v75, v75, v98
    v_mul_f32 v76, v76, v98
    v_mul_f32 v77, v77, v98
    v_mul_f32 v78, v78, v98
    v_mul_f32 v79, v79, v98
    v_mul_f32 v80, v80, v98
    v_mul_f32 v81, v81, v98
    v_mul_f32 v82, v82, v98
    v_mul_f32 v83, v83, v98
    s_mul_i32 s12, s9, 32768
    s_mul_i32 s13, s2, 1280
    s_add_u32 s12, s12, s13
    s_add_u32 s12, s12, 155189248
    s_add_u32 s13, s9, 1
    v_cmp_gt_u32 vcc, 8, v3
    s_and_saveexec_b64 s[14:15], vcc
    v_cmp_gt_u32 vcc, 2, v4
    s_and_saveexec_b64 s[60:61], vcc
    v_cvt_pk_bf16_f32 v100, v72, v73
    v_mov_b32 v101, s13
    buffer_store_dwordx2 v[100:101], v18, s[56:59], s12 offen offset:0 sc1
    v_cvt_pk_bf16_f32 v100, v74, v75
    v_mov_b32 v101, s13
    buffer_store_dwordx2 v[100:101], v18, s[56:59], s12 offen offset:8 sc1
    s_mov_b64 exec, s[60:61]
    v_cvt_pk_bf16_f32 v100, v76, v77
    v_mov_b32 v101, s13
    buffer_store_dwordx2 v[100:101], v18, s[56:59], s12 offen offset:32 sc1
    v_cvt_pk_bf16_f32 v100, v78, v79
    v_mov_b32 v101, s13
    buffer_store_dwordx2 v[100:101], v18, s[56:59], s12 offen offset:40 sc1
    v_cvt_pk_bf16_f32 v100, v80, v81
    v_mov_b32 v101, s13
    buffer_store_dwordx2 v[100:101], v18, s[56:59], s12 offen offset:96 sc1
    v_cvt_pk_bf16_f32 v100, v82, v83
    v_mov_b32 v101, s13
    buffer_store_dwordx2 v[100:101], v18, s[56:59], s12 offen offset:104 sc1
    s_mov_b64 exec, s[14:15]
nopub_18:
    s_add_u32 s9, s9, 1
    s_cmp_lt_u32 s9, 63
    s_cbranch_scc1 aloop_15
    s_branch L_chain_end
roleB_14:
    s_sub_u32 s20, s2, 16
    v_lshrrev_b32 v9, 1, v1
    v_mul_u32_u24 v10, 896, v9
    v_and_b32 v11, 1, v1
    v_lshlrev_b32 v11, 4, v11
    v_add_u32 v10, v10, v11
    v_mul_u32_u24 v12, 48, v9
    v_add_u32 v12, v12, v11
    s_mul_i32 s4, s3, 21504
    v_add_u32 v12, s4, v12
    v_lshrrev_b32 v13, 2, v3
    v_lshlrev_b32 v14, 3, v4
    v_add_u32 v13, v13, v14
    v_mul_u32_u24 v13, 48, v13
    v_and_b32 v14, 3, v3
    v_lshlrev_b32 v14, 3, v14
    v_add_u32 v13, v13, v14
    v_add_u32 v13, s4, v13
    s_mul_i32 s6, s3, 1605632
    s_lshl_b32 s7, s20, 5
    s_add_u32 s6, s6, s7
    s_add_u32 s6, s6, 134217728
    s_add_u32 s7, s6, 0
    buffer_load_dwordx4 v[32:35], v10, s[48:51], s7 offen
    s_add_u32 s7, s6, 28672
    buffer_load_dwordx4 v[36:39], v10, s[48:51], s7 offen
    s_add_u32 s7, s6, 57344
    buffer_load_dwordx4 v[40:43], v10, s[48:51], s7 offen
    s_add_u32 s7, s6, 86016
    buffer_load_dwordx4 v[44:47], v10, s[48:51], s7 offen
    s_add_u32 s7, s6, 114688
    buffer_load_dwordx4 v[48:51], v10, s[48:51], s7 offen
    s_add_u32 s7, s6, 143360
    buffer_load_dwordx4 v[52:55], v10, s[48:51], s7 offen
    s_add_u32 s7, s6, 172032
    buffer_load_dwordx4 v[56:59], v10, s[48:51], s7 offen
    s_add_u32 s7, s6, 200704
    buffer_load_dwordx4 v[60:63], v10, s[48:51], s7 offen
    s_add_u32 s7, s6, 229376
    buffer_load_dwordx4 v[64:67], v10, s[48:51], s7 offen
    s_add_u32 s7, s6, 258048
    buffer_load_dwordx4 v[68:71], v10, s[48:51], s7 offen
    s_add_u32 s7, s6, 286720
    buffer_load_dwordx4 v[72:75], v10, s[48:51], s7 offen
    s_add_u32 s7, s6, 315392
    buffer_load_dwordx4 v[76:79], v10, s[48:51], s7 offen
    s_add_u32 s7, s6, 344064
    buffer_load_dwordx4 v[80:83], v10, s[48:51], s7 offen
    s_add_u32 s7, s6, 372736
    buffer_load_dwordx4 v[84:87], v10, s[48:51], s7 offen
    s_waitcnt vmcnt(0)
    ds_write_b128 v12, v[32:35] offset:0
    ds_write_b128 v12, v[36:39] offset:1536
    ds_write_b128 v12, v[40:43] offset:3072
    ds_write_b128 v12, v[44:47] offset:4608
    ds_write_b128 v12, v[48:51] offset:6144
    ds_write_b128 v12, v[52:55] offset:7680
    ds_write_b128 v12, v[56:59] offset:9216
    ds_write_b128 v12, v[60:63] offset:10752
    ds_write_b128 v12, v[64:67] offset:12288
    ds_write_b128 v12, v[68:71] offset:13824
    ds_write_b128 v12, v[72:75] offset:15360
    ds_write_b128 v12, v[76:79] offset:16896
    ds_write_b128 v12, v[80:83] offset:18432
    ds_write_b128 v12, v[84:87] offset:19968
    s_waitcnt lgkmcnt(0)
    ds_read_b64_tr_b16 v[32:33], v13 offset:0
    ds_read_b64_tr_b16 v[34:35], v13 offset:192
    ds_read_b64_tr_b16 v[36:37], v13 offset:1536
    ds_read_b64_tr_b16 v[38:39], v13 offset:1728
    ds_read_b64_tr_b16 v[40:41], v13 offset:3072
    ds_read_b64_tr_b16 v[42:43], v13 offset:3264
    ds_read_b64_tr_b16 v[44:45], v13 offset:4608
    ds_read_b64_tr_b16 v[46:47], v13 offset:4800
    ds_read_b64_tr_b16 v[48:49], v13 offset:6144
    ds_read_b64_tr_b16 v[50:51], v13 offset:6336
    ds_read_b64_tr_b16 v[52:53], v13 offset:7680
    ds_read_b64_tr_b16 v[54:55], v13 offset:7872
    ds_read_b64_tr_b16 v[56:57], v13 offset:9216
    ds_read_b64_tr_b16 v[58:59], v13 offset:9408
    ds_read_b64_tr_b16 v[60:61], v13 offset:10752
    ds_read_b64_tr_b16 v[62:63], v13 offset:10944
    ds_read_b64_tr_b16 v[64:65], v13 offset:12288
    ds_read_b64_tr_b16 v[66:67], v13 offset:12480
    ds_read_b64_tr_b16 v[68:69], v13 offset:13824
    ds_read_b64_tr_b16 v[70:71], v13 offset:14016
    ds_read_b64_tr_b16 v[72:73], v13 offset:15360
    ds_read_b64_tr_b16 v[74:75], v13 offset:15552
    ds_read_b64_tr_b16 v[76:77], v13 offset:16896
    ds_read_b64_tr_b16 v[78:79], v13 offset:17088
    ds_read_b64_tr_b16 v[80:81], v13 offset:18432
    ds_read_b64_tr_b16 v[82:83], v13 offset:18624
    ds_read_b64_tr_b16 v[84:85], v13 offset:19968
    ds_read_b64_tr_b16 v[86:87], v13 offset:20160
    s_waitcnt lgkmcnt(0)
    v_accvgpr_write_b32 a0, v32
    v_accvgpr_write_b32 a1, v33
    v_accvgpr_write_b32 a2, v34
    v_accvgpr_write_b32 a3, v35
    v_accvgpr_write_b32 a4, v36
    v_accvgpr_write_b32 a5, v37
    v_accvgpr_write_b32 a6, v38
    v_accvgpr_write_b32 a7, v39
    v_accvgpr_write_b32 a8, v40
    v_accvgpr_write_b32 a9, v41
    v_accvgpr_write_b32 a10, v42
    v_accvgpr_write_b32 a11, v43
    v_accvgpr_write_b32 a12, v44
    v_accvgpr_write_b32 a13, v45
    v_accvgpr_write_b32 a14, v46
    v_accvgpr_write_b32 a15, v47
    v_accvgpr_write_b32 a16, v48
    v_accvgpr_write_b32 a17, v49
    v_accvgpr_write_b32 a18, v50
    v_accvgpr_write_b32 a19, v51
    v_accvgpr_write_b32 a20, v52
    v_accvgpr_write_b32 a21, v53
    v_accvgpr_write_b32 a22, v54
    v_accvgpr_write_b32 a23, v55
    v_accvgpr_write_b32 a24, v56
    v_accvgpr_write_b32 a25, v57
    v_accvgpr_write_b32 a26, v58
    v_accvgpr_write_b32 a27, v59
    v_accvgpr_write_b32 a28, v60
    v_accvgpr_write_b32 a29, v61
    v_accvgpr_write_b32 a30, v62
    v_accvgpr_write_b32 a31, v63
    v_accvgpr_write_b32 a32, v64
    v_accvgpr_write_b32 a33, v65
    v_accvgpr_write_b32 a34, v66
    v_accvgpr_write_b32 a35, v67
    v_accvgpr_write_b32 a36, v68
    v_accvgpr_write_b32 a37, v69
    v_accvgpr_write_b32 a38, v70
    v_accvgpr_write_b32 a39, v71
    v_accvgpr_write_b32 a40, v72
    v_accvgpr_write_b32 a41, v73
    v_accvgpr_write_b32 a42, v74
    v_accvgpr_write_b32 a43, v75
    v_accvgpr_write_b32 a44, v76
    v_accvgpr_write_b32 a45, v77
    v_accvgpr_write_b32 a46, v78
    v_accvgpr_write_b32 a47, v79
    v_accvgpr_write_b32 a48, v80
    v_accvgpr_write_b32 a49, v81
    v_accvgpr_write_b32 a50, v82
    v_accvgpr_write_b32 a51, v83
    v_accvgpr_write_b32 a52, v84
    v_accvgpr_write_b32 a53, v85
    v_accvgpr_write_b32 a54, v86
    v_accvgpr_write_b32 a55, v87
    s_add_u32 s7, s6, 401408
    buffer_load_dwordx4 v[32:35], v10, s[48:51], s7 offen
    s_add_u32 s7, s6, 430080
    buffer_load_dwordx4 v[36:39], v10, s[48:51], s7 offen
    s_add_u32 s7, s6, 458752
    buffer_load_dwordx4 v[40:43], v10, s[48:51], s7 offen
    s_add_u32 s7, s6, 487424
    buffer_load_dwordx4 v[44:47], v10, s[48:51], s7 offen
    s_add_u32 s7, s6, 516096
    buffer_load_dwordx4 v[48:51], v10, s[48:51], s7 offen
    s_add_u32 s7, s6, 544768
    buffer_load_dwordx4 v[52:55], v10, s[48:51], s7 offen
    s_add_u32 s7, s6, 573440
    buffer_load_dwordx4 v[56:59], v10, s[48:51], s7 offen
    s_add_u32 s7, s6, 602112
    buffer_load_dwordx4 v[60:63], v10, s[48:51], s7 offen
    s_add_u32 s7, s6, 630784
    buffer_load_dwordx4 v[64:67], v10, s[48:51], s7 offen
    s_add_u32 s7, s6, 659456
    buffer_load_dwordx4 v[68:71], v10, s[48:51], s7 offen
    s_add_u32 s7, s6, 688128
    buffer_load_dwordx4 v[72:75], v10, s[48:51], s7 offen
    s_add_u32 s7, s6, 716800
    buffer_load_dwordx4 v[76:79], v10, s[48:51], s7 offen
    s_add_u32 s7, s6, 745472
    buffer_load_dwordx4 v[80:83], v10, s[48:51], s7 offen
    s_add_u32 s7, s6, 774144
    buffer_load_dwordx4 v[84:87], v10, s[48:51], s7 offen
    s_waitcnt vmcnt(0)
    ds_write_b128 v12, v[32:35] offset:0
    ds_write_b128 v12, v[36:39] offset:1536
    ds_write_b128 v12, v[40:43] offset:3072
    ds_write_b128 v12, v[44:47] offset:4608
    ds_write_b128 v12, v[48:51] offset:6144
    ds_write_b128 v12, v[52:55] offset:7680
    ds_write_b128 v12, v[56:59] offset:9216
    ds_write_b128 v12, v[60:63] offset:10752
    ds_write_b128 v12, v[64:67] offset:12288
    ds_write_b128 v12, v[68:71] offset:13824
    ds_write_b128 v12, v[72:75] offset:15360
    ds_write_b128 v12, v[76:79] offset:16896
    ds_write_b128 v12, v[80:83] offset:18432
    ds_write_b128 v12, v[84:87] offset:19968
    s_waitcnt lgkmcnt(0)
    ds_read_b64_tr_b16 v[32:33], v13 offset:0
    ds_read_b64_tr_b16 v[34:35], v13 offset:192
    ds_read_b64_tr_b16 v[36:37], v13 offset:1536
    ds_read_b64_tr_b16 v[38:39], v13 offset:1728
    ds_read_b64_tr_b16 v[40:41], v13 offset:3072
    ds_read_b64_tr_b16 v[42:43], v13 offset:3264
    ds_read_b64_tr_b16 v[44:45], v13 offset:4608
    ds_read_b64_tr_b16 v[46:47], v13 offset:4800
    ds_read_b64_tr_b16 v[48:49], v13 offset:6144
    ds_read_b64_tr_b16 v[50:51], v13 offset:6336
    ds_read_b64_tr_b16 v[52:53], v13 offset:7680
    ds_read_b64_tr_b16 v[54:55], v13 offset:7872
    ds_read_b64_tr_b16 v[56:57], v13 offset:9216
    ds_read_b64_tr_b16 v[58:59], v13 offset:9408
    ds_read_b64_tr_b16 v[60:61], v13 offset:10752
    ds_read_b64_tr_b16 v[62:63], v13 offset:10944
    ds_read_b64_tr_b16 v[64:65], v13 offset:12288
    ds_read_b64_tr_b16 v[66:67], v13 offset:12480
    ds_read_b64_tr_b16 v[68:69], v13 offset:13824
    ds_read_b64_tr_b16 v[70:71], v13 offset:14016
    ds_read_b64_tr_b16 v[72:73], v13 offset:15360
    ds_read_b64_tr_b16 v[74:75], v13 offset:15552
    ds_read_b64_tr_b16 v[76:77], v13 offset:16896
    ds_read_b64_tr_b16 v[78:79], v13 offset:17088
    ds_read_b64_tr_b16 v[80:81], v13 offset:18432
    ds_read_b64_tr_b16 v[82:83], v13 offset:18624
    ds_read_b64_tr_b16 v[84:85], v13 offset:19968
    ds_read_b64_tr_b16 v[86:87], v13 offset:20160
    s_waitcnt lgkmcnt(0)
    v_accvgpr_write_b32 a56, v32
    v_accvgpr_write_b32 a57, v33
    v_accvgpr_write_b32 a58, v34
    v_accvgpr_write_b32 a59, v35
    v_accvgpr_write_b32 a60, v36
    v_accvgpr_write_b32 a61, v37
    v_accvgpr_write_b32 a62, v38
    v_accvgpr_write_b32 a63, v39
    v_accvgpr_write_b32 a64, v40
    v_accvgpr_write_b32 a65, v41
    v_accvgpr_write_b32 a66, v42
    v_accvgpr_write_b32 a67, v43
    v_accvgpr_write_b32 a68, v44
    v_accvgpr_write_b32 a69, v45
    v_accvgpr_write_b32 a70, v46
    v_accvgpr_write_b32 a71, v47
    v_accvgpr_write_b32 a72, v48
    v_accvgpr_write_b32 a73, v49
    v_accvgpr_write_b32 a74, v50
    v_accvgpr_write_b32 a75, v51
    v_accvgpr_write_b32 a76, v52
    v_accvgpr_write_b32 a77, v53
    v_accvgpr_write_b32 a78, v54
    v_accvgpr_write_b32 a79, v55
    v_accvgpr_write_b32 a80, v56
    v_accvgpr_write_b32 a81, v57
    v_accvgpr_write_b32 a82, v58
    v_accvgpr_write_b32 a83, v59
    v_accvgpr_write_b32 a84, v60
    v_accvgpr_write_b32 a85, v61
    v_accvgpr_write_b32 a86, v62
    v_accvgpr_write_b32 a87, v63
    v_accvgpr_write_b32 a88, v64
    v_accvgpr_write_b32 a89, v65
    v_accvgpr_write_b32 a90, v66
    v_accvgpr_write_b32 a91, v67
    v_accvgpr_write_b32 a92, v68
    v_accvgpr_write_b32 a93, v69
    v_accvgpr_write_b32 a94, v70
    v_accvgpr_write_b32 a95, v71
    v_accvgpr_write_b32 a96, v72
    v_accvgpr_write_b32 a97, v73
    v_accvgpr_write_b32 a98, v74
    v_accvgpr_write_b32 a99, v75
    v_accvgpr_write_b32 a100, v76
    v_accvgpr_write_b32 a101, v77
    v_accvgpr_write_b32 a102, v78
    v_accvgpr_write_b32 a103, v79
    v_accvgpr_write_b32 a104, v80
    v_accvgpr_write_b32 a105, v81
    v_accvgpr_write_b32 a106, v82
    v_accvgpr_write_b32 a107, v83
    v_accvgpr_write_b32 a108, v84
    v_accvgpr_write_b32 a109, v85
    v_accvgpr_write_b32 a110, v86
    v_accvgpr_write_b32 a111, v87
    s_add_u32 s7, s6, 802816
    buffer_load_dwordx4 v[32:35], v10, s[48:51], s7 offen
    s_add_u32 s7, s6, 831488
    buffer_load_dwordx4 v[36:39], v10, s[48:51], s7 offen
    s_add_u32 s7, s6, 860160
    buffer_load_dwordx4 v[40:43], v10, s[48:51], s7 offen
    s_add_u32 s7, s6, 888832
    buffer_load_dwordx4 v[44:47], v10, s[48:51], s7 offen
    s_add_u32 s7, s6, 917504
    buffer_load_dwordx4 v[48:51], v10, s[48:51], s7 offen
    s_add_u32 s7, s6, 946176
    buffer_load_dwordx4 v[52:55], v10, s[48:51], s7 offen
    s_add_u32 s7, s6, 974848
    buffer_load_dwordx4 v[56:59], v10, s[48:51], s7 offen
    s_add_u32 s7, s6, 1003520
    buffer_load_dwordx4 v[60:63], v10, s[48:51], s7 offen
    s_add_u32 s7, s6, 1032192
    buffer_load_dwordx4 v[64:67], v10, s[48:51], s7 offen
    s_add_u32 s7, s6, 1060864
    buffer_load_dwordx4 v[68:71], v10, s[48:51], s7 offen
    s_add_u32 s7, s6, 1089536
    buffer_load_dwordx4 v[72:75], v10, s[48:51], s7 offen
    s_add_u32 s7, s6, 1118208
    buffer_load_dwordx4 v[76:79], v10, s[48:51], s7 offen
    s_add_u32 s7, s6, 1146880
    buffer_load_dwordx4 v[80:83], v10, s[48:51], s7 offen
    s_add_u32 s7, s6, 1175552
    buffer_load_dwordx4 v[84:87], v10, s[48:51], s7 offen
    s_waitcnt vmcnt(0)
    ds_write_b128 v12, v[32:35] offset:0
    ds_write_b128 v12, v[36:39] offset:1536
    ds_write_b128 v12, v[40:43] offset:3072
    ds_write_b128 v12, v[44:47] offset:4608
    ds_write_b128 v12, v[48:51] offset:6144
    ds_write_b128 v12, v[52:55] offset:7680
    ds_write_b128 v12, v[56:59] offset:9216
    ds_write_b128 v12, v[60:63] offset:10752
    ds_write_b128 v12, v[64:67] offset:12288
    ds_write_b128 v12, v[68:71] offset:13824
    ds_write_b128 v12, v[72:75] offset:15360
    ds_write_b128 v12, v[76:79] offset:16896
    ds_write_b128 v12, v[80:83] offset:18432
    ds_write_b128 v12, v[84:87] offset:19968
    s_waitcnt lgkmcnt(0)
    ds_read_b64_tr_b16 v[32:33], v13 offset:0
    ds_read_b64_tr_b16 v[34:35], v13 offset:192
    ds_read_b64_tr_b16 v[36:37], v13 offset:1536
    ds_read_b64_tr_b16 v[38:39], v13 offset:1728
    ds_read_b64_tr_b16 v[40:41], v13 offset:3072
    ds_read_b64_tr_b16 v[42:43], v13 offset:3264
    ds_read_b64_tr_b16 v[44:45], v13 offset:4608
    ds_read_b64_tr_b16 v[46:47], v13 offset:4800
    ds_read_b64_tr_b16 v[48:49], v13 offset:6144
    ds_read_b64_tr_b16 v[50:51], v13 offset:6336
    ds_read_b64_tr_b16 v[52:53], v13 offset:7680
    ds_read_b64_tr_b16 v[54:55], v13 offset:7872
    ds_read_b64_tr_b16 v[56:57], v13 offset:9216
    ds_read_b64_tr_b16 v[58:59], v13 offset:9408
    ds_read_b64_tr_b16 v[60:61], v13 offset:10752
    ds_read_b64_tr_b16 v[62:63], v13 offset:10944
    ds_read_b64_tr_b16 v[64:65], v13 offset:12288
    ds_read_b64_tr_b16 v[66:67], v13 offset:12480
    ds_read_b64_tr_b16 v[68:69], v13 offset:13824
    ds_read_b64_tr_b16 v[70:71], v13 offset:14016
    ds_read_b64_tr_b16 v[72:73], v13 offset:15360
    ds_read_b64_tr_b16 v[74:75], v13 offset:15552
    ds_read_b64_tr_b16 v[76:77], v13 offset:16896
    ds_read_b64_tr_b16 v[78:79], v13 offset:17088
    ds_read_b64_tr_b16 v[80:81], v13 offset:18432
    ds_read_b64_tr_b16 v[82:83], v13 offset:18624
    ds_read_b64_tr_b16 v[84:85], v13 offset:19968
    ds_read_b64_tr_b16 v[86:87], v13 offset:20160
    s_waitcnt lgkmcnt(0)
    v_accvgpr_write_b32 a112, v32
    v_accvgpr_write_b32 a113, v33
    v_accvgpr_write_b32 a114, v34
    v_accvgpr_write_b32 a115, v35
    v_accvgpr_write_b32 a116, v36
    v_accvgpr_write_b32 a117, v37
    v_accvgpr_write_b32 a118, v38
    v_accvgpr_write_b32 a119, v39
    v_accvgpr_write_b32 a120, v40
    v_accvgpr_write_b32 a121, v41
    v_accvgpr_write_b32 a122, v42
    v_accvgpr_write_b32 a123, v43
    v_accvgpr_write_b32 a124, v44
    v_accvgpr_write_b32 a125, v45
    v_accvgpr_write_b32 a126, v46
    v_accvgpr_write_b32 a127, v47
    v_accvgpr_write_b32 a128, v48
    v_accvgpr_write_b32 a129, v49
    v_accvgpr_write_b32 a130, v50
    v_accvgpr_write_b32 a131, v51
    v_accvgpr_write_b32 a132, v52
    v_accvgpr_write_b32 a133, v53
    v_accvgpr_write_b32 a134, v54
    v_accvgpr_write_b32 a135, v55
    v_accvgpr_write_b32 a136, v56
    v_accvgpr_write_b32 a137, v57
    v_accvgpr_write_b32 a138, v58
    v_accvgpr_write_b32 a139, v59
    v_accvgpr_write_b32 a140, v60
    v_accvgpr_write_b32 a141, v61
    v_accvgpr_write_b32 a142, v62
    v_accvgpr_write_b32 a143, v63
    v_accvgpr_write_b32 a144, v64
    v_accvgpr_write_b32 a145, v65
    v_accvgpr_write_b32 a146, v66
    v_accvgpr_write_b32 a147, v67
    v_accvgpr_write_b32 a148, v68
    v_accvgpr_write_b32 a149, v69
    v_accvgpr_write_b32 a150, v70
    v_accvgpr_write_b32 a151, v71
    v_accvgpr_write_b32 a152, v72
    v_accvgpr_write_b32 a153, v73
    v_accvgpr_write_b32 a154, v74
    v_accvgpr_write_b32 a155, v75
    v_accvgpr_write_b32 a156, v76
    v_accvgpr_write_b32 a157, v77
    v_accvgpr_write_b32 a158, v78
    v_accvgpr_write_b32 a159, v79
    v_accvgpr_write_b32 a160, v80
    v_accvgpr_write_b32 a161, v81
    v_accvgpr_write_b32 a162, v82
    v_accvgpr_write_b32 a163, v83
    v_accvgpr_write_b32 a164, v84
    v_accvgpr_write_b32 a165, v85
    v_accvgpr_write_b32 a166, v86
    v_accvgpr_write_b32 a167, v87
    s_add_u32 s7, s6, 1204224
    buffer_load_dwordx4 v[32:35], v10, s[48:51], s7 offen
    s_add_u32 s7, s6, 1232896
    buffer_load_dwordx4 v[36:39], v10, s[48:51], s7 offen
    s_add_u32 s7, s6, 1261568
    buffer_load_dwordx4 v[40:43], v10, s[48:51], s7 offen
    s_add_u32 s7, s6, 1290240
    buffer_load_dwordx4 v[44:47], v10, s[48:51], s7 offen
    s_add_u32 s7, s6, 1318912
    buffer_load_dwordx4 v[48:51], v10, s[48:51], s7 offen
    s_add_u32 s7, s6, 1347584
    buffer_load_dwordx4 v[52:55], v10, s[48:51], s7 offen
    s_add_u32 s7, s6, 1376256
    buffer_load_dwordx4 v[56:59], v10, s[48:51], s7 offen
    s_add_u32 s7, s6, 1404928
    buffer_load_dwordx4 v[60:63], v10, s[48:51], s7 offen
    s_add_u32 s7, s6, 1433600
    buffer_load_dwordx4 v[64:67], v10, s[48:51], s7 offen
    s_add_u32 s7, s6, 1462272
    buffer_load_dwordx4 v[68:71], v10, s[48:51], s7 offen
    s_add_u32 s7, s6, 1490944
    buffer_load_dwordx4 v[72:75], v10, s[48:51], s7 offen
    s_add_u32 s7, s6, 1519616
    buffer_load_dwordx4 v[76:79], v10, s[48:51], s7 offen
    s_add_u32 s7, s6, 1548288
    buffer_load_dwordx4 v[80:83], v10, s[48:51], s7 offen
    s_add_u32 s7, s6, 1576960
    buffer_load_dwordx4 v[84:87], v10, s[48:51], s7 offen
    s_waitcnt vmcnt(0)
    ds_write_b128 v12, v[32:35] offset:0
    ds_write_b128 v12, v[36:39] offset:1536
    ds_write_b128 v12, v[40:43] offset:3072
    ds_write_b128 v12, v[44:47] offset:4608
    ds_write_b128 v12, v[48:51] offset:6144
    ds_write_b128 v12, v[52:55] offset:7680
    ds_write_b128 v12, v[56:59] offset:9216
    ds_write_b128 v12, v[60:63] offset:10752
    ds_write_b128 v12, v[64:67] offset:12288
    ds_write_b128 v12, v[68:71] offset:13824
    ds_write_b128 v12, v[72:75] offset:15360
    ds_write_b128 v12, v[76:79] offset:16896
    ds_write_b128 v12, v[80:83] offset:18432
    ds_write_b128 v12, v[84:87] offset:19968
    s_waitcnt lgkmcnt(0)
    ds_read_b64_tr_b16 v[32:33], v13 offset:0
    ds_read_b64_tr_b16 v[34:35], v13 offset:192
    ds_read_b64_tr_b16 v[36:37], v13 offset:1536
    ds_read_b64_tr_b16 v[38:39], v13 offset:1728
    ds_read_b64_tr_b16 v[40:41], v13 offset:3072
    ds_read_b64_tr_b16 v[42:43], v13 offset:3264
    ds_read_b64_tr_b16 v[44:45], v13 offset:4608
    ds_read_b64_tr_b16 v[46:47], v13 offset:4800
    ds_read_b64_tr_b16 v[48:49], v13 offset:6144
    ds_read_b64_tr_b16 v[50:51], v13 offset:6336
    ds_read_b64_tr_b16 v[52:53], v13 offset:7680
    ds_read_b64_tr_b16 v[54:55], v13 offset:7872
    ds_read_b64_tr_b16 v[56:57], v13 offset:9216
    ds_read_b64_tr_b16 v[58:59], v13 offset:9408
    ds_read_b64_tr_b16 v[60:61], v13 offset:10752
    ds_read_b64_tr_b16 v[62:63], v13 offset:10944
    ds_read_b64_tr_b16 v[64:65], v13 offset:12288
    ds_read_b64_tr_b16 v[66:67], v13 offset:12480
    ds_read_b64_tr_b16 v[68:69], v13 offset:13824
    ds_read_b64_tr_b16 v[70:71], v13 offset:14016
    ds_read_b64_tr_b16 v[72:73], v13 offset:15360
    ds_read_b64_tr_b16 v[74:75], v13 offset:15552
    ds_read_b64_tr_b16 v[76:77], v13 offset:16896
    ds_read_b64_tr_b16 v[78:79], v13 offset:17088
    ds_read_b64_tr_b16 v[80:81], v13 offset:18432
    ds_read_b64_tr_b16 v[82:83], v13 offset:18624
    ds_read_b64_tr_b16 v[84:85], v13 offset:19968
    ds_read_b64_tr_b16 v[86:87], v13 offset:20160
    s_waitcnt lgkmcnt(0)
    v_accvgpr_write_b32 a168, v32
    v_accvgpr_write_b32 a169, v33
    v_accvgpr_write_b32 a170, v34
    v_accvgpr_write_b32 a171, v35
    v_accvgpr_write_b32 a172, v36
    v_accvgpr_write_b32 a173, v37
    v_accvgpr_write_b32 a174, v38
    v_accvgpr_write_b32 a175, v39
    v_accvgpr_write_b32 a176, v40
    v_accvgpr_write_b32 a177, v41
    v_accvgpr_write_b32 a178, v42
    v_accvgpr_write_b32 a179, v43
    v_accvgpr_write_b32 a180, v44
    v_accvgpr_write_b32 a181, v45
    v_accvgpr_write_b32 a182, v46
    v_accvgpr_write_b32 a183, v47
    v_accvgpr_write_b32 a184, v48
    v_accvgpr_write_b32 a185, v49
    v_accvgpr_write_b32 a186, v50
    v_accvgpr_write_b32 a187, v51
    v_accvgpr_write_b32 a188, v52
    v_accvgpr_write_b32 a189, v53
    v_accvgpr_write_b32 a190, v54
    v_accvgpr_write_b32 a191, v55
    v_accvgpr_write_b32 a192, v56
    v_accvgpr_write_b32 a193, v57
    v_accvgpr_write_b32 a194, v58
    v_accvgpr_write_b32 a195, v59
    v_accvgpr_write_b32 a196, v60
    v_accvgpr_write_b32 a197, v61
    v_accvgpr_write_b32 a198, v62
    v_accvgpr_write_b32 a199, v63
    v_accvgpr_write_b32 a200, v64
    v_accvgpr_write_b32 a201, v65
    v_accvgpr_write_b32 a202, v66
    v_accvgpr_write_b32 a203, v67
    v_accvgpr_write_b32 a204, v68
    v_accvgpr_write_b32 a205, v69
    v_accvgpr_write_b32 a206, v70
    v_accvgpr_write_b32 a207, v71
    v_accvgpr_write_b32 a208, v72
    v_accvgpr_write_b32 a209, v73
    v_accvgpr_write_b32 a210, v74
    v_accvgpr_write_b32 a211, v75
    v_accvgpr_write_b32 a212, v76
    v_accvgpr_write_b32 a213, v77
    v_accvgpr_write_b32 a214, v78
    v_accvgpr_write_b32 a215, v79
    v_accvgpr_write_b32 a216, v80
    v_accvgpr_write_b32 a217, v81
    v_accvgpr_write_b32 a218, v82
    v_accvgpr_write_b32 a219, v83
    v_accvgpr_write_b32 a220, v84
    v_accvgpr_write_b32 a221, v85
    v_accvgpr_write_b32 a222, v86
    v_accvgpr_write_b32 a223, v87
    s_barrier
    v_mov_b32 v26, 0
    v_mov_b32 v27, 0
    v_mov_b32 v28, 0
    v_mov_b32 v29, 0
    v_lshlrev_b32 v9, 5, v0
    v_add_u32 v9, 151168, v9
    v_cmp_gt_u32 vcc, 228, v0
    s_and_saveexec_b64 s[14:15], vcc
    ds_write_b128 v9, v[26:29]
    ds_write_b128 v9, v[26:29] offset:16
    s_mov_b64 exec, s[14:15]
    v_add_u32 v9, 0, v0
    s_mov_b32 s12, 0x4924925
    v_mul_hi_u32 v10, v9, s12
    v_mul_u32_u24 v11, 56, v10
    v_sub_u32 v11, v9, v11
    v_mul_u32_u24 v12, 912, v10
    v_lshlrev_b32 v11, 4, v11
    v_add_u32 v12, v12, v11
    v_add_u32 v226, 121984, v12
    v_add_u32 v9, 256, v0
    s_mov_b32 s12, 0x4924925
    v_mul_hi_u32 v10, v9, s12
    v_mul_u32_u24 v11, 56, v10
    v_sub_u32 v11, v9, v11
    v_mul_u32_u24 v12, 912, v10
    v_lshlrev_b32 v11, 4, v11
    v_add_u32 v12, v12, v11
    v_add_u32 v227, 121984, v12
    v_add_u32 v9, 512, v0
    s_mov_b32 s12, 0x4924925
    v_mul_hi_u32 v10, v9, s12
    v_mul_u32_u24 v11, 56, v10
    v_sub_u32 v11, v9, v11
    v_mul_u32_u24 v12, 912, v10
    v_lshlrev_b32 v11, 4, v11
    v_add_u32 v12, v12, v11
    v_add_u32 v228, 121984, v12
    v_add_u32 v9, 768, v0
    s_mov_b32 s12, 0x4924925
    v_mul_hi_u32 v10, v9, s12
    v_mul_u32_u24 v11, 56, v10
    v_sub_u32 v11, v9, v11
    v_mul_u32_u24 v12, 912, v10
    v_lshlrev_b32 v11, 4, v11
    v_add_u32 v12, v12, v11
    v_add_u32 v229, 121984, v12
    v_add_u32 v9, 1024, v0
    s_mov_b32 s12, 0x4924925
    v_mul_hi_u32 v10, v9, s12
    v_mul_u32_u24 v11, 56, v10
    v_sub_u32 v11, v9, v11
    v_mul_u32_u24 v12, 912, v10
    v_lshlrev_b32 v11, 4, v11
    v_add_u32 v12, v12, v11
    v_add_u32 v230, 121984, v12
    v_add_u32 v9, 1280, v0
    s_mov_b32 s12, 0x4924925
    v_mul_hi_u32 v10, v9, s12
    v_mul_u32_u24 v11, 56, v10
    v_sub_u32 v11, v9, v11
    v_mul_u32_u24 v12, 912, v10
    v_lshlrev_b32 v11, 4, v11
    v_add_u32 v12, v12, v11
    v_add_u32 v231, 121984, v12
    v_add_u32 v9, 1536, v0
    s_mov_b32 s12, 0x4924925
    v_mul_hi_u32 v10, v9, s12
    v_mul_u32_u24 v11, 56, v10
    v_sub_u32 v11, v9, v11
    v_mul_u32_u24 v12, 912, v10
    v_lshlrev_b32 v11, 4, v11
    v_add_u32 v12, v12, v11
    v_add_u32 v232, 121984, v12
    v_lshlrev_b32 v233, 4, v0
    s_mov_b32 s52, s16
    s_mov_b32 s53, s17
    s_mov_b32 s54, 0x7fffffff
    s_mov_b32 s55, 0x00020000
    v_mul_u32_u24 v9, 912, v3
    v_lshlrev_b32 v10, 4, v4
    v_add_u32 v9, v9, v10
    v_add_u32 v9, 114688, v9
    v_and_b32 v15, 7, v3
    v_mul_u32_u24 v15, 20, v15
    v_lshlrev_b32 v16, 1, v4
    v_add_u32 v15, v15, v16
    v_lshlrev_b32 v15, 3, v15
    v_and_b32 v21, 7, v3
    v_mul_u32_u24 v21, 20, v21
    v_and_b32 v22, 1, v4
    v_lshlrev_b32 v22, 1, v22
    v_add_u32 v21, v21, v22
    v_lshlrev_b32 v21, 3, v21
    v_lshlrev_b32 v16, 2, v1
    v_add_u32 v17, 158464, v16
    s_lshl_b32 s4, s3, 10
    v_add_u32 v16, s4, v17
    v_lshlrev_b32 v18, 3, v3
    v_lshlrev_b32 v19, 1, v4
    v_add_u32 v18, v18, v19
    v_lshlrev_b32 v18, 3, v18
    v_mul_u32_u24 v19, 896, v3
    v_lshlrev_b32 v20, 3, v4
    v_add_u32 v19, v19, v20
    s_mov_b32 s9, 0
    s_mul_i32 s10, s9, 28672
    s_add_u32 s11, s10, 0
    buffer_load_dwordx4 v[196:199], v233, s[52:55], s11 offen
    s_add_u32 s11, s10, 4096
    buffer_load_dwordx4 v[200:203], v233, s[52:55], s11 offen
    s_add_u32 s11, s10, 8192
    buffer_load_dwordx4 v[204:207], v233, s[52:55], s11 offen
    s_add_u32 s11, s10, 12288
    buffer_load_dwordx4 v[208:211], v233, s[52:55], s11 offen
    s_add_u32 s11, s10, 16384
    buffer_load_dwordx4 v[212:215], v233, s[52:55], s11 offen
    s_add_u32 s11, s10, 20480
    buffer_load_dwordx4 v[216:219], v233, s[52:55], s11 offen
    s_add_u32 s11, s10, 24576
    buffer_load_dwordx4 v[220:223], v233, s[52:55], s11 offen
    s_waitcnt vmcnt(0)
bloop_19:
    ds_write_b128 v226, v[196:199]
    ds_write_b128 v227, v[200:203]
    ds_write_b128 v228, v[204:207]
    ds_write_b128 v229, v[208:211]
    ds_write_b128 v230, v[212:215]
    ds_write_b128 v231, v[216:219]
    ds_write_b128 v232, v[220:223]
    s_mul_i32 s62, s9, 16384
    s_add_u32 s62, s62, 153092096
    s_add_u32 s63, s9, 1
    v_min_u32 v46, 27, v1
    v_lshlrev_b32 v46, 9, v46
    v_add_u32 v46, 504, v46
cheapm_21:
    buffer_load_dwordx2 v[32:33], v46, s[48:51], s62 offen sc1
    s_waitcnt vmcnt(0)
    v_cmp_ne_u32 vcc, s63, v33
    s_cbranch_vccnz cheapm_21
pollm_20:
    s_add_u32 s61, s62, 0
    buffer_load_dwordx2 v[32:33], v8, s[48:51], s61 offen sc1
    s_add_u32 s61, s62, 2048
    buffer_load_dwordx2 v[34:35], v8, s[48:51], s61 offen sc1
    s_add_u32 s61, s62, 4096
    buffer_load_dwordx2 v[36:37], v8, s[48:51], s61 offen sc1
    s_add_u32 s61, s62, 6144
    buffer_load_dwordx2 v[38:39], v8, s[48:51], s61 offen sc1
    s_add_u32 s61, s62, 8192
    buffer_load_dwordx2 v[40:41], v8, s[48:51], s61 offen sc1
    s_add_u32 s61, s62, 10240
    buffer_load_dwordx2 v[42:43], v8, s[48:51], s61 offen sc1
    s_add_u32 s61, s62, 12288
    buffer_load_dwordx2 v[44:45], v8, s[48:51], s61 offen sc1
    s_waitcnt vmcnt(0)
    v_xor_b32 v46, s63, v33
    v_xor_b32 v47, s63, v35
    v_or_b32 v46, v46, v47
    v_xor_b32 v47, s63, v37
    v_or_b32 v46, v46, v47
    v_xor_b32 v47, s63, v39
    v_or_b32 v46, v46, v47
    v_xor_b32 v47, s63, v41
    v_or_b32 v46, v46, v47
    v_xor_b32 v47, s63, v43
    v_or_b32 v46, v46, v47
    v_xor_b32 v47, s63, v45
    v_or_b32 v46, v46, v47
    v_cmp_ne_u32 vcc, 0, v46
    s_cbranch_vccnz pollm_20
    ds_write_b32 v7, v32 offset:0
    ds_write_b32 v7, v34 offset:128
    ds_write_b32 v7, v36 offset:256
    ds_write_b32 v7, v38 offset:384
    ds_write_b32 v7, v40 offset:512
    ds_write_b32 v7, v42 offset:640
    ds_write_b32 v7, v44 offset:768
    s_waitcnt lgkmcnt(0)
    s_barrier
    v_mov_b32 v32, 0
    v_mov_b32 v33, 0
    v_mov_b32 v34, 0
    v_mov_b32 v35, 0
    v_mov_b32 v36, 0
    v_mov_b32 v37, 0
    v_mov_b32 v38, 0
    v_mov_b32 v39, 0
    v_mov_b32 v40, 0
    v_mov_b32 v41, 0
    v_mov_b32 v42, 0
    v_mov_b32 v43, 0
    v_mov_b32 v44, 0
    v_mov_b32 v45, 0
    v_mov_b32 v46, 0
    v_mov_b32 v47, 0
    v_mov_b32 v48, 0
    v_mov_b32 v49, 0
    v_mov_b32 v50, 0
    v_mov_b32 v51, 0
    v_mov_b32 v52, 0
    v_mov_b32 v53, 0
    v_mov_b32 v54, 0
    v_mov_b32 v55, 0
    v_mov_b32 v56, 0
    v_mov_b32 v57, 0
    v_mov_b32 v58, 0
    v_mov_b32 v59, 0
    v_mov_b32 v60, 0
    v_mov_b32 v61, 0
    v_mov_b32 v62, 0
    v_mov_b32 v63, 0
    v_mov_b32 v64, 0
    v_mov_b32 v65, 0
    v_mov_b32 v66, 0
    v_mov_b32 v67, 0
    v_mov_b32 v68, 0
    v_mov_b32 v69, 0
    v_mov_b32 v70, 0
    v_mov_b32 v71, 0
    v_mov_b32 v72, 0
    v_mov_b32 v73, 0
    v_mov_b32 v74, 0
    v_mov_b32 v75, 0
    v_mov_b32 v76, 0
    v_mov_b32 v77, 0
    v_mov_b32 v78, 0
    v_mov_b32 v79, 0
    ds_read_b128 v[80:83], v9 offset:0
    ds_read_b128 v[84:87], v9 offset:14592
    ds_read_b128 v[88:91], v9 offset:29184
    s_waitcnt lgkmcnt(0)
    v_mfma_f32_16x16x32_bf16 v[32:35], v[80:83], a[0:3], v[32:35]
    v_mfma_f32_16x16x32_bf16 v[36:39], v[84:87], a[0:3], v[36:39]
    v_mfma_f32_16x16x32_bf16 v[40:43], v[88:91], a[0:3], v[40:43]
    v_mfma_f32_16x16x32_bf16 v[44:47], v[80:83], a[56:59], v[44:47]
    v_mfma_f32_16x16x32_bf16 v[48:51], v[84:87], a[56:59], v[48:51]
    v_mfma_f32_16x16x32_bf16 v[52:55], v[88:91], a[56:59], v[52:55]
    v_mfma_f32_16x16x32_bf16 v[56:59], v[80:83], a[112:115], v[56:59]
    v_mfma_f32_16x16x32_bf16 v[60:63], v[84:87], a[112:115], v[60:63]
    v_mfma_f32_16x16x32_bf16 v[64:67], v[88:91], a[112:115], v[64:67]
    v_mfma_f32_16x16x32_bf16 v[68:71], v[80:83], a[168:171], v[68:71]
    v_mfma_f32_16x16x32_bf16 v[72:75], v[84:87], a[168:171], v[72:75]
    v_mfma_f32_16x16x32_bf16 v[76:79], v[88:91], a[168:171], v[76:79]
    ds_read_b128 v[80:83], v9 offset:64
    ds_read_b128 v[84:87], v9 offset:14656
    ds_read_b128 v[88:91], v9 offset:29248
    s_waitcnt lgkmcnt(0)
    v_mfma_f32_16x16x32_bf16 v[32:35], v[80:83], a[4:7], v[32:35]
    v_mfma_f32_16x16x32_bf16 v[36:39], v[84:87], a[4:7], v[36:39]
    v_mfma_f32_16x16x32_bf16 v[40:43], v[88:91], a[4:7], v[40:43]
    v_mfma_f32_16x16x32_bf16 v[44:47], v[80:83], a[60:63], v[44:47]
    v_mfma_f32_16x16x32_bf16 v[48:51], v[84:87], a[60:63], v[48:51]
    v_mfma_f32_16x16x32_bf16 v[52:55], v[88:91], a[60:63], v[52:55]
    v_mfma_f32_16x16x32_bf16 v[56:59], v[80:83], a[116:119], v[56:59]
    v_mfma_f32_16x16x32_bf16 v[60:63], v[84:87], a[116:119], v[60:63]
    v_mfma_f32_16x16x32_bf16 v[64:67], v[88:91], a[116:119], v[64:67]
    v_mfma_f32_16x16x32_bf16 v[68:71], v[80:83], a[172:175], v[68:71]
    v_mfma_f32_16x16x32_bf16 v[72:75], v[84:87], a[172:175], v[72:75]
    v_mfma_f32_16x16x32_bf16 v[76:79], v[88:91], a[172:175], v[76:79]
    ds_read_b128 v[80:83], v9 offset:128
    ds_read_b128 v[84:87], v9 offset:14720
    ds_read_b128 v[88:91], v9 offset:29312
    s_waitcnt lgkmcnt(0)
    v_mfma_f32_16x16x32_bf16 v[32:35], v[80:83], a[8:11], v[32:35]
    v_mfma_f32_16x16x32_bf16 v[36:39], v[84:87], a[8:11], v[36:39]
    v_mfma_f32_16x16x32_bf16 v[40:43], v[88:91], a[8:11], v[40:43]
    v_mfma_f32_16x16x32_bf16 v[44:47], v[80:83], a[64:67], v[44:47]
    v_mfma_f32_16x16x32_bf16 v[48:51], v[84:87], a[64:67], v[48:51]
    v_mfma_f32_16x16x32_bf16 v[52:55], v[88:91], a[64:67], v[52:55]
    v_mfma_f32_16x16x32_bf16 v[56:59], v[80:83], a[120:123], v[56:59]
    v_mfma_f32_16x16x32_bf16 v[60:63], v[84:87], a[120:123], v[60:63]
    v_mfma_f32_16x16x32_bf16 v[64:67], v[88:91], a[120:123], v[64:67]
    v_mfma_f32_16x16x32_bf16 v[68:71], v[80:83], a[176:179], v[68:71]
    v_mfma_f32_16x16x32_bf16 v[72:75], v[84:87], a[176:179], v[72:75]
    v_mfma_f32_16x16x32_bf16 v[76:79], v[88:91], a[176:179], v[76:79]
    ds_read_b128 v[80:83], v9 offset:192
    ds_read_b128 v[84:87], v9 offset:14784
    ds_read_b128 v[88:91], v9 offset:29376
    s_waitcnt lgkmcnt(0)
    v_mfma_f32_16x16x32_bf16 v[32:35], v[80:83], a[12:15], v[32:35]
    v_mfma_f32_16x16x32_bf16 v[36:39], v[84:87], a[12:15], v[36:39]
    v_mfma_f32_16x16x32_bf16 v[40:43], v[88:91], a[12:15], v[40:43]
    v_mfma_f32_16x16x32_bf16 v[44:47], v[80:83], a[68:71], v[44:47]
    v_mfma_f32_16x16x32_bf16 v[48:51], v[84:87], a[68:71], v[48:51]
    v_mfma_f32_16x16x32_bf16 v[52:55], v[88:91], a[68:71], v[52:55]
    v_mfma_f32_16x16x32_bf16 v[56:59], v[80:83], a[124:127], v[56:59]
    v_mfma_f32_16x16x32_bf16 v[60:63], v[84:87], a[124:127], v[60:63]
    v_mfma_f32_16x16x32_bf16 v[64:67], v[88:91], a[124:127], v[64:67]
    v_mfma_f32_16x16x32_bf16 v[68:71], v[80:83], a[180:183], v[68:71]
    v_mfma_f32_16x16x32_bf16 v[72:75], v[84:87], a[180:183], v[72:75]
    v_mfma_f32_16x16x32_bf16 v[76:79], v[88:91], a[180:183], v[76:79]
    ds_read_b128 v[80:83], v9 offset:256
    ds_read_b128 v[84:87], v9 offset:14848
    ds_read_b128 v[88:91], v9 offset:29440
    s_waitcnt lgkmcnt(0)
    v_mfma_f32_16x16x32_bf16 v[32:35], v[80:83], a[16:19], v[32:35]
    v_mfma_f32_16x16x32_bf16 v[36:39], v[84:87], a[16:19], v[36:39]
    v_mfma_f32_16x16x32_bf16 v[40:43], v[88:91], a[16:19], v[40:43]
    v_mfma_f32_16x16x32_bf16 v[44:47], v[80:83], a[72:75], v[44:47]
    v_mfma_f32_16x16x32_bf16 v[48:51], v[84:87], a[72:75], v[48:51]
    v_mfma_f32_16x16x32_bf16 v[52:55], v[88:91], a[72:75], v[52:55]
    v_mfma_f32_16x16x32_bf16 v[56:59], v[80:83], a[128:131], v[56:59]
    v_mfma_f32_16x16x32_bf16 v[60:63], v[84:87], a[128:131], v[60:63]
    v_mfma_f32_16x16x32_bf16 v[64:67], v[88:91], a[128:131], v[64:67]
    v_mfma_f32_16x16x32_bf16 v[68:71], v[80:83], a[184:187], v[68:71]
    v_mfma_f32_16x16x32_bf16 v[72:75], v[84:87], a[184:187], v[72:75]
    v_mfma_f32_16x16x32_bf16 v[76:79], v[88:91], a[184:187], v[76:79]
    ds_read_b128 v[80:83], v9 offset:320
    ds_read_b128 v[84:87], v9 offset:14912
    ds_read_b128 v[88:91], v9 offset:29504
    s_waitcnt lgkmcnt(0)
    v_mfma_f32_16x16x32_bf16 v[32:35], v[80:83], a[20:23], v[32:35]
    v_mfma_f32_16x16x32_bf16 v[36:39], v[84:87], a[20:23], v[36:39]
    v_mfma_f32_16x16x32_bf16 v[40:43], v[88:91], a[20:23], v[40:43]
    v_mfma_f32_16x16x32_bf16 v[44:47], v[80:83], a[76:79], v[44:47]
    v_mfma_f32_16x16x32_bf16 v[48:51], v[84:87], a[76:79], v[48:51]
    v_mfma_f32_16x16x32_bf16 v[52:55], v[88:91], a[76:79], v[52:55]
    v_mfma_f32_16x16x32_bf16 v[56:59], v[80:83], a[132:135], v[56:59]
    v_mfma_f32_16x16x32_bf16 v[60:63], v[84:87], a[132:135], v[60:63]
    v_mfma_f32_16x16x32_bf16 v[64:67], v[88:91], a[132:135], v[64:67]
    v_mfma_f32_16x16x32_bf16 v[68:71], v[80:83], a[188:191], v[68:71]
    v_mfma_f32_16x16x32_bf16 v[72:75], v[84:87], a[188:191], v[72:75]
    v_mfma_f32_16x16x32_bf16 v[76:79], v[88:91], a[188:191], v[76:79]
    ds_read_b128 v[80:83], v9 offset:384
    ds_read_b128 v[84:87], v9 offset:14976
    ds_read_b128 v[88:91], v9 offset:29568
    s_waitcnt lgkmcnt(0)
    v_mfma_f32_16x16x32_bf16 v[32:35], v[80:83], a[24:27], v[32:35]
    v_mfma_f32_16x16x32_bf16 v[36:39], v[84:87], a[24:27], v[36:39]
    v_mfma_f32_16x16x32_bf16 v[40:43], v[88:91], a[24:27], v[40:43]
    v_mfma_f32_16x16x32_bf16 v[44:47], v[80:83], a[80:83], v[44:47]
    v_mfma_f32_16x16x32_bf16 v[48:51], v[84:87], a[80:83], v[48:51]
    v_mfma_f32_16x16x32_bf16 v[52:55], v[88:91], a[80:83], v[52:55]
    v_mfma_f32_16x16x32_bf16 v[56:59], v[80:83], a[136:139], v[56:59]
    v_mfma_f32_16x16x32_bf16 v[60:63], v[84:87], a[136:139], v[60:63]
    v_mfma_f32_16x16x32_bf16 v[64:67], v[88:91], a[136:139], v[64:67]
    v_mfma_f32_16x16x32_bf16 v[68:71], v[80:83], a[192:195], v[68:71]
    v_mfma_f32_16x16x32_bf16 v[72:75], v[84:87], a[192:195], v[72:75]
    v_mfma_f32_16x16x32_bf16 v[76:79], v[88:91], a[192:195], v[76:79]
    ds_read_b128 v[80:83], v9 offset:448
    ds_read_b128 v[84:87], v9 offset:15040
    ds_read_b128 v[88:91], v9 offset:29632
    s_waitcnt lgkmcnt(0)
    v_mfma_f32_16x16x32_bf16 v[32:35], v[80:83], a[28:31], v[32:35]
    v_mfma_f32_16x16x32_bf16 v[36:39], v[84:87], a[28:31], v[36:39]
    v_mfma_f32_16x16x32_bf16 v[40:43], v[88:91], a[28:31], v[40:43]
    v_mfma_f32_16x16x32_bf16 v[44:47], v[80:83], a[84:87], v[44:47]
    v_mfma_f32_16x16x32_bf16 v[48:51], v[84:87], a[84:87], v[48:51]
    v_mfma_f32_16x16x32_bf16 v[52:55], v[88:91], a[84:87], v[52:55]
    v_mfma_f32_16x16x32_bf16 v[56:59], v[80:83], a[140:143], v[56:59]
    v_mfma_f32_16x16x32_bf16 v[60:63], v[84:87], a[140:143], v[60:63]
    v_mfma_f32_16x16x32_bf16 v[64:67], v[88:91], a[140:143], v[64:67]
    v_mfma_f32_16x16x32_bf16 v[68:71], v[80:83], a[196:199], v[68:71]
    v_mfma_f32_16x16x32_bf16 v[72:75], v[84:87], a[196:199], v[72:75]
    v_mfma_f32_16x16x32_bf16 v[76:79], v[88:91], a[196:199], v[76:79]
    ds_read_b128 v[80:83], v9 offset:512
    ds_read_b128 v[84:87], v9 offset:15104
    ds_read_b128 v[88:91], v9 offset:29696
    s_waitcnt lgkmcnt(0)
    v_mfma_f32_16x16x32_bf16 v[32:35], v[80:83], a[32:35], v[32:35]
    v_mfma_f32_16x16x32_bf16 v[36:39], v[84:87], a[32:35], v[36:39]
    v_mfma_f32_16x16x32_bf16 v[40:43], v[88:91], a[32:35], v[40:43]
    v_mfma_f32_16x16x32_bf16 v[44:47], v[80:83], a[88:91], v[44:47]
    v_mfma_f32_16x16x32_bf16 v[48:51], v[84:87], a[88:91], v[48:51]
    v_mfma_f32_16x16x32_bf16 v[52:55], v[88:91], a[88:91], v[52:55]
    v_mfma_f32_16x16x32_bf16 v[56:59], v[80:83], a[144:147], v[56:59]
    v_mfma_f32_16x16x32_bf16 v[60:63], v[84:87], a[144:147], v[60:63]
    v_mfma_f32_16x16x32_bf16 v[64:67], v[88:91], a[144:147], v[64:67]
    v_mfma_f32_16x16x32_bf16 v[68:71], v[80:83], a[200:203], v[68:71]
    v_mfma_f32_16x16x32_bf16 v[72:75], v[84:87], a[200:203], v[72:75]
    v_mfma_f32_16x16x32_bf16 v[76:79], v[88:91], a[200:203], v[76:79]
    ds_read_b128 v[80:83], v9 offset:576
    ds_read_b128 v[84:87], v9 offset:15168
    ds_read_b128 v[88:91], v9 offset:29760
    s_waitcnt lgkmcnt(0)
    v_mfma_f32_16x16x32_bf16 v[32:35], v[80:83], a[36:39], v[32:35]
    v_mfma_f32_16x16x32_bf16 v[36:39], v[84:87], a[36:39], v[36:39]
    v_mfma_f32_16x16x32_bf16 v[40:43], v[88:91], a[36:39], v[40:43]
    v_mfma_f32_16x16x32_bf16 v[44:47], v[80:83], a[92:95], v[44:47]
    v_mfma_f32_16x16x32_bf16 v[48:51], v[84:87], a[92:95], v[48:51]
    v_mfma_f32_16x16x32_bf16 v[52:55], v[88:91], a[92:95], v[52:55]
    v_mfma_f32_16x16x32_bf16 v[56:59], v[80:83], a[148:151], v[56:59]
    v_mfma_f32_16x16x32_bf16 v[60:63], v[84:87], a[148:151], v[60:63]
    v_mfma_f32_16x16x32_bf16 v[64:67], v[88:91], a[148:151], v[64:67]
    v_mfma_f32_16x16x32_bf16 v[68:71], v[80:83], a[204:207], v[68:71]
    v_mfma_f32_16x16x32_bf16 v[72:75], v[84:87], a[204:207], v[72:75]
    v_mfma_f32_16x16x32_bf16 v[76:79], v[88:91], a[204:207], v[76:79]
    ds_read_b128 v[80:83], v9 offset:640
    ds_read_b128 v[84:87], v9 offset:15232
    ds_read_b128 v[88:91], v9 offset:29824
    s_waitcnt lgkmcnt(0)
    v_mfma_f32_16x16x32_bf16 v[32:35], v[80:83], a[40:43], v[32:35]
    v_mfma_f32_16x16x32_bf16 v[36:39], v[84:87], a[40:43], v[36:39]
    v_mfma_f32_16x16x32_bf16 v[40:43], v[88:91], a[40:43], v[40:43]
    v_mfma_f32_16x16x32_bf16 v[44:47], v[80:83], a[96:99], v[44:47]
    v_mfma_f32_16x16x32_bf16 v[48:51], v[84:87], a[96:99], v[48:51]
    v_mfma_f32_16x16x32_bf16 v[52:55], v[88:91], a[96:99], v[52:55]
    v_mfma_f32_16x16x32_bf16 v[56:59], v[80:83], a[152:155], v[56:59]
    v_mfma_f32_16x16x32_bf16 v[60:63], v[84:87], a[152:155], v[60:63]
    v_mfma_f32_16x16x32_bf16 v[64:67], v[88:91], a[152:155], v[64:67]
    v_mfma_f32_16x16x32_bf16 v[68:71], v[80:83], a[208:211], v[68:71]
    v_mfma_f32_16x16x32_bf16 v[72:75], v[84:87], a[208:211], v[72:75]
    v_mfma_f32_16x16x32_bf16 v[76:79], v[88:91], a[208:211], v[76:79]
    ds_read_b128 v[80:83], v9 offset:704
    ds_read_b128 v[84:87], v9 offset:15296
    ds_read_b128 v[88:91], v9 offset:29888
    s_waitcnt lgkmcnt(0)
    v_mfma_f32_16x16x32_bf16 v[32:35], v[80:83], a[44:47], v[32:35]
    v_mfma_f32_16x16x32_bf16 v[36:39], v[84:87], a[44:47], v[36:39]
    v_mfma_f32_16x16x32_bf16 v[40:43], v[88:91], a[44:47], v[40:43]
    v_mfma_f32_16x16x32_bf16 v[44:47], v[80:83], a[100:103], v[44:47]
    v_mfma_f32_16x16x32_bf16 v[48:51], v[84:87], a[100:103], v[48:51]
    v_mfma_f32_16x16x32_bf16 v[52:55], v[88:91], a[100:103], v[52:55]
    v_mfma_f32_16x16x32_bf16 v[56:59], v[80:83], a[156:159], v[56:59]
    v_mfma_f32_16x16x32_bf16 v[60:63], v[84:87], a[156:159], v[60:63]
    v_mfma_f32_16x16x32_bf16 v[64:67], v[88:91], a[156:159], v[64:67]
    v_mfma_f32_16x16x32_bf16 v[68:71], v[80:83], a[212:215], v[68:71]
    v_mfma_f32_16x16x32_bf16 v[72:75], v[84:87], a[212:215], v[72:75]
    v_mfma_f32_16x16x32_bf16 v[76:79], v[88:91], a[212:215], v[76:79]
    ds_read_b128 v[80:83], v9 offset:768
    ds_read_b128 v[84:87], v9 offset:15360
    ds_read_b128 v[88:91], v9 offset:29952
    s_waitcnt lgkmcnt(0)
    v_mfma_f32_16x16x32_bf16 v[32:35], v[80:83], a[48:51], v[32:35]
    v_mfma_f32_16x16x32_bf16 v[36:39], v[84:87], a[48:51], v[36:39]
    v_mfma_f32_16x16x32_bf16 v[40:43], v[88:91], a[48:51], v[40:43]
    v_mfma_f32_16x16x32_bf16 v[44:47], v[80:83], a[104:107], v[44:47]
    v_mfma_f32_16x16x32_bf16 v[48:51], v[84:87], a[104:107], v[48:51]
    v_mfma_f32_16x16x32_bf16 v[52:55], v[88:91], a[104:107], v[52:55]
    v_mfma_f32_16x16x32_bf16 v[56:59], v[80:83], a[160:163], v[56:59]
    v_mfma_f32_16x16x32_bf16 v[60:63], v[84:87], a[160:163], v[60:63]
    v_mfma_f32_16x16x32_bf16 v[64:67], v[88:91], a[160:163], v[64:67]
    v_mfma_f32_16x16x32_bf16 v[68:71], v[80:83], a[216:219], v[68:71]
    v_mfma_f32_16x16x32_bf16 v[72:75], v[84:87], a[216:219], v[72:75]
    v_mfma_f32_16x16x32_bf16 v[76:79], v[88:91], a[216:219], v[76:79]
    ds_read_b128 v[80:83], v9 offset:832
    ds_read_b128 v[84:87], v9 offset:15424
    ds_read_b128 v[88:91], v9 offset:30016
    s_waitcnt lgkmcnt(0)
    v_mfma_f32_16x16x32_bf16 v[32:35], v[80:83], a[52:55], v[32:35]
    v_mfma_f32_16x16x32_bf16 v[36:39], v[84:87], a[52:55], v[36:39]
    v_mfma_f32_16x16x32_bf16 v[40:43], v[88:91], a[52:55], v[40:43]
    v_mfma_f32_16x16x32_bf16 v[44:47], v[80:83], a[108:111], v[44:47]
    v_mfma_f32_16x16x32_bf16 v[48:51], v[84:87], a[108:111], v[48:51]
    v_mfma_f32_16x16x32_bf16 v[52:55], v[88:91], a[108:111], v[52:55]
    v_mfma_f32_16x16x32_bf16 v[56:59], v[80:83], a[164:167], v[56:59]
    v_mfma_f32_16x16x32_bf16 v[60:63], v[84:87], a[164:167], v[60:63]
    v_mfma_f32_16x16x32_bf16 v[64:67], v[88:91], a[164:167], v[64:67]
    v_mfma_f32_16x16x32_bf16 v[68:71], v[80:83], a[220:223], v[68:71]
    v_mfma_f32_16x16x32_bf16 v[72:75], v[84:87], a[220:223], v[72:75]
    v_mfma_f32_16x16x32_bf16 v[76:79], v[88:91], a[220:223], v[76:79]
    s_nop 7
    s_nop 1
    s_add_u32 s10, s9, 1
    s_min_u32 s10, s10, 63
    s_mul_i32 s10, s10, 28672
    s_add_u32 s11, s10, 0
    buffer_load_dwordx4 v[196:199], v233, s[52:55], s11 offen
    s_add_u32 s11, s10, 4096
    buffer_load_dwordx4 v[200:203], v233, s[52:55], s11 offen
    s_add_u32 s11, s10, 8192
    buffer_load_dwordx4 v[204:207], v233, s[52:55], s11 offen
    s_add_u32 s11, s10, 12288
    buffer_load_dwordx4 v[208:211], v233, s[52:55], s11 offen
    s_add_u32 s11, s10, 16384
    buffer_load_dwordx4 v[212:215], v233, s[52:55], s11 offen
    s_add_u32 s11, s10, 20480
    buffer_load_dwordx4 v[216:219], v233, s[52:55], s11 offen
    s_add_u32 s11, s10, 24576
    buffer_load_dwordx4 v[220:223], v233, s[52:55], s11 offen
    v_cvt_pk_bf16_f32 v100, v32, v33
    v_cvt_pk_bf16_f32 v101, v34, v35
    v_cvt_pk_bf16_f32 v102, v36, v37
    v_cvt_pk_bf16_f32 v103, v38, v39
    v_cvt_pk_bf16_f32 v104, v40, v41
    v_cvt_pk_bf16_f32 v105, v42, v43
    v_mov_b32 v106, 0
    v_mov_b32 v107, 0
    v_cvt_pk_bf16_f32 v108, v44, v45
    v_cvt_pk_bf16_f32 v109, v46, v47
    v_cvt_pk_bf16_f32 v110, v48, v49
    v_cvt_pk_bf16_f32 v111, v50, v51
    v_cvt_pk_bf16_f32 v112, v52, v53
    v_cvt_pk_bf16_f32 v113, v54, v55
    v_mov_b32 v114, 0
    v_mov_b32 v115, 0
    v_cvt_pk_bf16_f32 v116, v56, v57
    v_cvt_pk_bf16_f32 v117, v58, v59
    v_cvt_pk_bf16_f32 v118, v60, v61
    v_cvt_pk_bf16_f32 v119, v62, v63
    v_cvt_pk_bf16_f32 v120, v64, v65
    v_cvt_pk_bf16_f32 v121, v66, v67
    v_mov_b32 v122, 0
    v_mov_b32 v123, 0
    v_cvt_pk_bf16_f32 v124, v68, v69
    v_cvt_pk_bf16_f32 v125, v70, v71
    v_cvt_pk_bf16_f32 v126, v72, v73
    v_cvt_pk_bf16_f32 v127, v74, v75
    v_cvt_pk_bf16_f32 v128, v76, v77
    v_cvt_pk_bf16_f32 v129, v78, v79
    v_mov_b32 v130, 0
    v_mov_b32 v131, 0
    s_mul_i32 s12, s9, 32768
    s_mul_i32 s13, s3, 5120
    s_add_u32 s12, s12, s13
    s_add_u32 s12, s12, 155189248
    s_add_u32 s13, s9, 1
    v_and_b32 v24, 3, v1
    v_mul_u32_u24 v24, 1280, v24
    v_add_u32 v24, 1272, v24
cheapp_23:
    buffer_load_dwordx2 v[26:27], v24, s[48:51], s12 offen sc1
    s_waitcnt vmcnt(0)
    v_cmp_ne_u32 vcc, s13, v27
    s_cbranch_vccnz cheapp_23
pollp_22:
    buffer_load_dwordx2 v[132:133], v15, s[48:51], s12 offen offset:0 sc1
    buffer_load_dwordx2 v[134:135], v15, s[48:51], s12 offen offset:8 sc1
    buffer_load_dwordx2 v[136:137], v15, s[48:51], s12 offen offset:64 sc1
    buffer_load_dwordx2 v[138:139], v15, s[48:51], s12 offen offset:72 sc1
    buffer_load_dwordx2 v[140:141], v21, s[48:51], s12 offen offset:128 sc1
    buffer_load_dwordx2 v[142:143], v21, s[48:51], s12 offen offset:136 sc1
    buffer_load_dwordx2 v[144:145], v15, s[48:51], s12 offen offset:1280 sc1
    buffer_load_dwordx2 v[146:147], v15, s[48:51], s12 offen offset:1288 sc1
    buffer_load_dwordx2 v[148:149], v15, s[48:51], s12 offen offset:1344 sc1
    buffer_load_dwordx2 v[150:151], v15, s[48:51], s12 offen offset:1352 sc1
    buffer_load_dwordx2 v[152:153], v21, s[48:51], s12 offen offset:1408 sc1
    buffer_load_dwordx2 v[154:155], v21, s[48:51], s12 offen offset:1416 sc1
    buffer_load_dwordx2 v[156:157], v15, s[48:51], s12 offen offset:2560 sc1
    buffer_load_dwordx2 v[158:159], v15, s[48:51], s12 offen offset:2568 sc1
    buffer_load_dwordx2 v[160:161], v15, s[48:51], s12 offen offset:2624 sc1
    buffer_load_dwordx2 v[162:163], v15, s[48:51], s12 offen offset:2632 sc1
    buffer_load_dwordx2 v[164:165], v21, s[48:51], s12 offen offset:2688 sc1
    buffer_load_dwordx2 v[166:167], v21, s[48:51], s12 offen offset:2696 sc1
    buffer_load_dwordx2 v[168:169], v15, s[48:51], s12 offen offset:3840 sc1
    buffer_load_dwordx2 v[170:171], v15, s[48:51], s12 offen offset:3848 sc1
    buffer_load_dwordx2 v[172:173], v15, s[48:51], s12 offen offset:3904 sc1
    buffer_load_dwordx2 v[174:175], v15, s[48:51], s12 offen offset:3912 sc1
    buffer_load_dwordx2 v[176:177], v21, s[48:51], s12 offen offset:3968 sc1
    buffer_load_dwordx2 v[178:179], v21, s[48:51], s12 offen offset:3976 sc1
    s_waitcnt vmcnt(0)
    v_xor_b32 v24, s13, v133
    v_xor_b32 v25, s13, v135
    v_or_b32 v24, v24, v25
    v_xor_b32 v25, s13, v137
    v_or_b32 v24, v24, v25
    v_xor_b32 v25, s13, v139
    v_or_b32 v24, v24, v25
    v_xor_b32 v25, s13, v141
    v_or_b32 v24, v24, v25
    v_xor_b32 v25, s13, v143
    v_or_b32 v24, v24, v25
    v_xor_b32 v25, s13, v145
    v_or_b32 v24, v24, v25
    v_xor_b32 v25, s13, v147
    v_or_b32 v24, v24, v25
    v_xor_b32 v25, s13, v149
    v_or_b32 v24, v24, v25
    v_xor_b32 v25, s13, v151
    v_or_b32 v24, v24, v25
    v_xor_b32 v25, s13, v153
    v_or_b32 v24, v24, v25
    v_xor_b32 v25, s13, v155
    v_or_b32 v24, v24, v25
    v_xor_b32 v25, s13, v157
    v_or_b32 v24, v24, v25
    v_xor_b32 v25, s13, v159
    v_or_b32 v24, v24, v25
    v_xor_b32 v25, s13, v161
    v_or_b32 v24, v24, v25
    v_xor_b32 v25, s13, v163
    v_or_b32 v24, v24, v25
    v_xor_b32 v25, s13, v165
    v_or_b32 v24, v24, v25
    v_xor_b32 v25, s13, v167
    v_or_b32 v24, v24, v25
    v_xor_b32 v25, s13, v169
    v_or_b32 v24, v24, v25
    v_xor_b32 v25, s13, v171
    v_or_b32 v24, v24, v25
    v_xor_b32 v25, s13, v173
    v_or_b32 v24, v24, v25
    v_xor_b32 v25, s13, v175
    v_or_b32 v24, v24, v25
    v_xor_b32 v25, s13, v177
    v_or_b32 v24, v24, v25
    v_xor_b32 v25, s13, v179
    v_or_b32 v24, v24, v25
    v_cmp_ne_u32 vcc, 0, v24
    s_cbranch_vccnz pollp_22
    v_mov_b32 v40, v132
    v_mov_b32 v41, v134
    v_mov_b32 v42, v136
    v_mov_b32 v43, v138
    v_mov_b32 v44, v140
    v_mov_b32 v45, v142
    v_mov_b32 v46, 0
    v_mov_b32 v47, 0
    v_mov_b32 v48, v144
    v_mov_b32 v49, v146
    v_mov_b32 v50, v148
    v_mov_b32 v51, v150
    v_mov_b32 v52, v152
    v_mov_b32 v53, v154
    v_mov_b32 v54, 0
    v_mov_b32 v55, 0
    v_mov_b32 v56, v156
    v_mov_b32 v57, v158
    v_mov_b32 v58, v160
    v_mov_b32 v59, v162
    v_mov_b32 v60, v164
    v_mov_b32 v61, v166
    v_mov_b32 v62, 0
    v_mov_b32 v63, 0
    v_mov_b32 v64, v168
    v_mov_b32 v65, v170
    v_mov_b32 v66, v172
    v_mov_b32 v67, v174
    v_mov_b32 v68, v176
    v_mov_b32 v69, v178
    v_mov_b32 v70, 0
    v_mov_b32 v71, 0
    v_mov_b32 v32, 0
    v_mov_b32 v33, 0
    v_mov_b32 v34, 0
    v_mov_b32 v35, 0
    s_nop 1
    v_mfma_f32_16x16x32_bf16 v[32:35], v[100:103], v[40:43], v[32:35]
    v_mfma_f32_16x16x32_bf16 v[32:35], v[104:107], v[44:47], v[32:35]
    v_mfma_f32_16x16x32_bf16 v[32:35], v[108:111], v[48:51], v[32:35]
    v_mfma_f32_16x16x32_bf16 v[32:35], v[112:115], v[52:55], v[32:35]
    v_mfma_f32_16x16x32_bf16 v[32:35], v[116:119], v[56:59], v[32:35]
    v_mfma_f32_16x16x32_bf16 v[32:35], v[120:123], v[60:63], v[32:35]
    v_mfma_f32_16x16x32_bf16 v[32:35], v[124:127], v[64:67], v[32:35]
    v_mfma_f32_16x16x32_bf16 v[32:35], v[128:131], v[68:71], v[32:35]
    s_nop 7
    s_nop 1
    ds_write_b32 v16, v32 offset:0
    ds_write_b32 v16, v33 offset:256
    ds_write_b32 v16, v34 offset:512
    ds_write_b32 v16, v35 offset:768
    s_waitcnt lgkmcnt(0)
    s_barrier
    s_cmp_lg_u32 s3, 0
    s_cbranch_scc1 nopubB_24
    ds_read_b32 v32, v17 offset:0
    ds_read_b32 v33, v17 offset:256
    ds_read_b32 v34, v17 offset:512
    ds_read_b32 v35, v17 offset:768
    ds_read_b32 v36, v17 offset:1024
    ds_read_b32 v37, v17 offset:1280
    ds_read_b32 v38, v17 offset:1536
    ds_read_b32 v39, v17 offset:1792
    ds_read_b32 v40, v17 offset:2048
    ds_read_b32 v41, v17 offset:2304
    ds_read_b32 v42, v17 offset:2560
    ds_read_b32 v43, v17 offset:2816
    ds_read_b32 v44, v17 offset:3072
    ds_read_b32 v45, v17 offset:3328
    ds_read_b32 v46, v17 offset:3584
    ds_read_b32 v47, v17 offset:3840
    s_waitcnt lgkmcnt(0)
    v_add_f32 v32, v32, v36
    v_add_f32 v40, v40, v44
    v_add_f32 v32, v32, v40
    v_add_f32 v33, v33, v37
    v_add_f32 v41, v41, v45
    v_add_f32 v33, v33, v41
    v_add_f32 v34, v34, v38
    v_add_f32 v42, v42, v46
    v_add_f32 v34, v34, v42
    v_add_f32 v35, v35, v39
    v_add_f32 v43, v43, v47
    v_add_f32 v35, v35, v43
    v_cvt_pk_bf16_f32 v48, v32, v33
    v_cvt_pk_bf16_f32 v50, v34, v35
    s_add_u32 s13, s9, 2
    v_mov_b32 v49, s13
    v_mov_b32 v51, s13
    v_mov_b32 v52, v48
    v_mov_b32 v53, v50
    s_add_u32 s12, s9, 1
    s_mul_i32 s12, s12, 16384
    s_lshl_b32 s13, s20, 9
    s_add_u32 s12, s12, s13
    s_add_u32 s12, s12, 153092096
    s_add_u32 s13, s9, 1
    s_mul_i32 s13, s13, 7168
    s_lshl_b32 s21, s20, 5
    s_add_u32 s13, s13, s21
    s_add_u32 s13, s13, 142606336
    v_cmp_gt_u32 vcc, 8, v3
    s_and_saveexec_b64 s[14:15], vcc
    buffer_store_dwordx2 v[48:49], v18, s[48:51], s12 offen sc1
    buffer_store_dwordx2 v[50:51], v18, s[48:51], s12 offen offset:8 sc1
    buffer_store_dwordx2 v[52:53], v19, s[48:51], s13 offen
    s_mov_b64 exec, s[14:15]
nopubB_24:
    s_barrier
    s_add_u32 s9, s9, 1
    s_cmp_lt_u32 s9, 63
    s_cbranch_scc1 bloop_19
L_chain_end:
    s_branch L_k2_end
L_k2_worker:
    s_mov_b32 s84, s44
    s_mov_b32 s85, s45
    s_mov_b32 s86, 256
    s_mov_b32 s87, 0x00020000
    s_sub_u32 s82, s2, 44
    s_mov_b32 s83, s82
L_k2_g:
    s_cmp_ge_u32 s83, 2560
    s_cbranch_scc1 L_k2_gdone
    s_lshr_b32 s3, s83, 9
    s_and_b32 s4, s83, 511
    s_lshr_b32 s5, s4, 5
    s_lshl_b32 s5, s5, 7
    s_and_b32 s6, s4, 31
    s_lshl_b32 s6, s6, 7
    s_mov_b32 s48, s32
    s_mov_b32 s49, s33
    s_mov_b32 s52, s36
    s_mov_b32 s53, s37
    s_mov_b32 s56, s46
    s_mov_b32 s57, s47
    s_mov_b32 s7, 2048
    s_mov_b32 s8, 16
    s_cmp_lg_u32 s3, 0
    s_cbranch_scc1 sel_25
    s_mov_b32 s48, s32
    s_mov_b32 s49, s33
    s_mov_b32 s52, s36
    s_mov_b32 s53, s37
    s_add_u32 s56, s46, 67108864
    s_addc_u32 s57, s47, 0
    s_mov_b32 s7, 2048
    s_mov_b32 s8, 16
sel_25:
    s_cmp_lg_u32 s3, 1
    s_cbranch_scc1 sel_26
    s_mov_b32 s48, s32
    s_mov_b32 s49, s33
    s_mov_b32 s52, s38
    s_mov_b32 s53, s39
    s_add_u32 s56, s46, 83886080
    s_addc_u32 s57, s47, 0
    s_mov_b32 s7, 2048
    s_mov_b32 s8, 16
sel_26:
    s_cmp_lg_u32 s3, 2
    s_cbranch_scc1 sel_27
    s_mov_b32 s48, s30
    s_mov_b32 s49, s31
    s_mov_b32 s52, s34
    s_mov_b32 s53, s35
    s_add_u32 s56, s46, 50331648
    s_addc_u32 s57, s47, 0
    s_mov_b32 s7, 896
    s_mov_b32 s8, 7
sel_27:
    s_cmp_lg_u32 s3, 3
    s_cbranch_scc1 sel_28
    s_mov_b32 s48, s16
    s_mov_b32 s49, s17
    s_mov_b32 s52, s20
    s_mov_b32 s53, s21
    s_add_u32 s56, s46, 0
    s_addc_u32 s57, s47, 0
    s_mov_b32 s7, 896
    s_mov_b32 s8, 7
sel_28:
    s_cmp_lg_u32 s3, 4
    s_cbranch_scc1 sel_29
    s_mov_b32 s48, s16
    s_mov_b32 s49, s17
    s_mov_b32 s52, s24
    s_mov_b32 s53, s25
    s_add_u32 s56, s46, 33554432
    s_addc_u32 s57, s47, 0
    s_mov_b32 s7, 896
    s_mov_b32 s8, 7
sel_29:
    s_mov_b32 s50, 0x7fffffff
    s_mov_b32 s51, 0x00020000
    s_mov_b32 s54, 0x7fffffff
    s_mov_b32 s55, 0x00020000
    s_mov_b32 s58, 0x7fffffff
    s_mov_b32 s59, 0x00020000
    s_mov_b32 s9, 8192
    v_lshrrev_b32 v1, 3, v0
    v_and_b32 v2, 7, v0
    v_mul_lo_u32 v3, v1, s7
    v_lshlrev_b32 v4, 4, v2
    v_add_u32 v3, v3, v4
    v_mul_u32_u24 v5, 144, v1
    v_add_u32 v5, v5, v4
    v_add_u32 v5, 0, v5
    v_lshrrev_b32 v6, 4, v0
    v_and_b32 v7, 15, v0
    v_lshlrev_b32 v8, 4, v7
    v_mul_lo_u32 v9, v6, s9
    v_add_u32 v9, v9, v8
    v_mul_u32_u24 v10, 272, v6
    v_add_u32 v10, v10, v8
    v_add_u32 v10, 18432, v10
    s_mul_i32 s60, s5, s7
    s_lshl_b32 s65, s7, 5
    s_add_u32 s61, s60, s65
    s_add_u32 s62, s61, s65
    s_add_u32 s63, s62, s65
    s_lshl_b32 s66, s6, 1
    s_mov_b32 s68, s66
    s_mul_i32 s65, s9, 16
    s_add_u32 s69, s68, s65
    s_add_u32 s70, s69, s65
    s_add_u32 s71, s70, s65
    s_lshl_b32 s67, s9, 6
    v_and_b32 v11, 63, v0
    v_lshrrev_b32 v12, 6, v0
    v_and_b32 v13, 15, v11
    v_lshrrev_b32 v14, 4, v11
    v_and_b32 v15, 1, v12
    v_lshrrev_b32 v16, 1, v12
    v_mul_u32_u24 v17, 64, v15
    v_add_u32 v17, v17, v13
    v_mul_u32_u24 v17, 144, v17
    v_lshlrev_b32 v18, 4, v14
    v_add_u32 v17, v17, v18
    v_add_u32 v17, 0, v17
    v_lshrrev_b32 v18, 2, v13
    v_lshlrev_b32 v19, 3, v14
    v_add_u32 v18, v18, v19
    v_mul_u32_u24 v18, 272, v18
    v_and_b32 v19, 3, v13
    v_lshlrev_b32 v19, 3, v19
    v_add_u32 v18, v18, v19
    v_mul_u32_u24 v19, 128, v16
    v_add_u32 v18, v18, v19
    v_add_u32 v18, 18432, v18
    v_mov_b32 v64, 0
    v_mov_b32 v65, 0
    v_mov_b32 v66, 0
    v_mov_b32 v67, 0
    v_mov_b32 v68, 0
    v_mov_b32 v69, 0
    v_mov_b32 v70, 0
    v_mov_b32 v71, 0
    v_mov_b32 v72, 0
    v_mov_b32 v73, 0
    v_mov_b32 v74, 0
    v_mov_b32 v75, 0
    v_mov_b32 v76, 0
    v_mov_b32 v77, 0
    v_mov_b32 v78, 0
    v_mov_b32 v79, 0
    v_mov_b32 v80, 0
    v_mov_b32 v81, 0
    v_mov_b32 v82, 0
    v_mov_b32 v83, 0
    v_mov_b32 v84, 0
    v_mov_b32 v85, 0
    v_mov_b32 v86, 0
    v_mov_b32 v87, 0
    v_mov_b32 v88, 0
    v_mov_b32 v89, 0
    v_mov_b32 v90, 0
    v_mov_b32 v91, 0
    v_mov_b32 v92, 0
    v_mov_b32 v93, 0
    v_mov_b32 v94, 0
    v_mov_b32 v95, 0
    v_mov_b32 v96, 0
    v_mov_b32 v97, 0
    v_mov_b32 v98, 0
    v_mov_b32 v99, 0
    v_mov_b32 v100, 0
    v_mov_b32 v101, 0
    v_mov_b32 v102, 0
    v_mov_b32 v103, 0
    v_mov_b32 v104, 0
    v_mov_b32 v105, 0
    v_mov_b32 v106, 0
    v_mov_b32 v107, 0
    v_mov_b32 v108, 0
    v_mov_b32 v109, 0
    v_mov_b32 v110, 0
    v_mov_b32 v111, 0
    v_mov_b32 v112, 0
    v_mov_b32 v113, 0
    v_mov_b32 v114, 0
    v_mov_b32 v115, 0
    v_mov_b32 v116, 0
    v_mov_b32 v117, 0
    v_mov_b32 v118, 0
    v_mov_b32 v119, 0
    v_mov_b32 v120, 0
    v_mov_b32 v121, 0
    v_mov_b32 v122, 0
    v_mov_b32 v123, 0
    v_mov_b32 v124, 0
    v_mov_b32 v125, 0
    v_mov_b32 v126, 0
    v_mov_b32 v127, 0
    buffer_load_dwordx4 v[128:131], v3, s[48:51], s60 offen
    buffer_load_dwordx4 v[132:135], v3, s[48:51], s61 offen
    buffer_load_dwordx4 v[136:139], v3, s[48:51], s62 offen
    buffer_load_dwordx4 v[140:143], v3, s[48:51], s63 offen
    buffer_load_dwordx4 v[144:147], v9, s[52:55], s68 offen
    buffer_load_dwordx4 v[148:151], v9, s[52:55], s69 offen
    buffer_load_dwordx4 v[152:155], v9, s[52:55], s70 offen
    buffer_load_dwordx4 v[156:159], v9, s[52:55], s71 offen
    v_add_u32 v3, 128, v3
    v_add_u32 v9, s67, v9
    s_waitcnt vmcnt(0)
    ds_write_b128 v5, v[128:131] offset:0
    ds_write_b128 v5, v[132:135] offset:4608
    ds_write_b128 v5, v[136:139] offset:9216
    ds_write_b128 v5, v[140:143] offset:13824
    ds_write_b128 v10, v[144:147] offset:0
    ds_write_b128 v10, v[148:151] offset:4352
    ds_write_b128 v10, v[152:155] offset:8704
    ds_write_b128 v10, v[156:159] offset:13056
    s_waitcnt lgkmcnt(0)
    s_barrier
    s_mov_b32 s72, 0
gk_30:
    s_add_u32 s73, s72, 1
    s_cmp_ge_u32 s73, s8
    s_cbranch_scc1 noload_32
    buffer_load_dwordx4 v[128:131], v3, s[48:51], s60 offen
    buffer_load_dwordx4 v[132:135], v3, s[48:51], s61 offen
    buffer_load_dwordx4 v[136:139], v3, s[48:51], s62 offen
    buffer_load_dwordx4 v[140:143], v3, s[48:51], s63 offen
    buffer_load_dwordx4 v[144:147], v9, s[52:55], s68 offen
    buffer_load_dwordx4 v[148:151], v9, s[52:55], s69 offen
    buffer_load_dwordx4 v[152:155], v9, s[52:55], s70 offen
    buffer_load_dwordx4 v[156:159], v9, s[52:55], s71 offen
    v_add_u32 v3, 128, v3
    v_add_u32 v9, s67, v9
noload_32:
    ds_read_b128 v[32:35], v17 offset:0
    ds_read_b128 v[36:39], v17 offset:2304
    ds_read_b128 v[40:43], v17 offset:4608
    ds_read_b128 v[44:47], v17 offset:6912
    ds_read_b64_tr_b16 v[48:49], v18 offset:0
    ds_read_b64_tr_b16 v[50:51], v18 offset:1088
    ds_read_b64_tr_b16 v[52:53], v18 offset:32
    ds_read_b64_tr_b16 v[54:55], v18 offset:1120
    ds_read_b64_tr_b16 v[56:57], v18 offset:64
    ds_read_b64_tr_b16 v[58:59], v18 offset:1152
    ds_read_b64_tr_b16 v[60:61], v18 offset:96
    ds_read_b64_tr_b16 v[62:63], v18 offset:1184
    s_waitcnt lgkmcnt(0)
    v_mfma_f32_16x16x32_bf16 v[64:67], v[48:51], v[32:35], v[64:67]
    v_mfma_f32_16x16x32_bf16 v[68:71], v[48:51], v[36:39], v[68:71]
    v_mfma_f32_16x16x32_bf16 v[72:75], v[48:51], v[40:43], v[72:75]
    v_mfma_f32_16x16x32_bf16 v[76:79], v[48:51], v[44:47], v[76:79]
    v_mfma_f32_16x16x32_bf16 v[80:83], v[52:55], v[32:35], v[80:83]
    v_mfma_f32_16x16x32_bf16 v[84:87], v[52:55], v[36:39], v[84:87]
    v_mfma_f32_16x16x32_bf16 v[88:91], v[52:55], v[40:43], v[88:91]
    v_mfma_f32_16x16x32_bf16 v[92:95], v[52:55], v[44:47], v[92:95]
    v_mfma_f32_16x16x32_bf16 v[96:99], v[56:59], v[32:35], v[96:99]
    v_mfma_f32_16x16x32_bf16 v[100:103], v[56:59], v[36:39], v[100:103]
    v_mfma_f32_16x16x32_bf16 v[104:107], v[56:59], v[40:43], v[104:107]
    v_mfma_f32_16x16x32_bf16 v[108:111], v[56:59], v[44:47], v[108:111]
    v_mfma_f32_16x16x32_bf16 v[112:115], v[60:63], v[32:35], v[112:115]
    v_mfma_f32_16x16x32_bf16 v[116:119], v[60:63], v[36:39], v[116:119]
    v_mfma_f32_16x16x32_bf16 v[120:123], v[60:63], v[40:43], v[120:123]
    v_mfma_f32_16x16x32_bf16 v[124:127], v[60:63], v[44:47], v[124:127]
    ds_read_b128 v[32:35], v17 offset:64
    ds_read_b128 v[36:39], v17 offset:2368
    ds_read_b128 v[40:43], v17 offset:4672
    ds_read_b128 v[44:47], v17 offset:6976
    ds_read_b64_tr_b16 v[48:49], v18 offset:8704
    ds_read_b64_tr_b16 v[50:51], v18 offset:9792
    ds_read_b64_tr_b16 v[52:53], v18 offset:8736
    ds_read_b64_tr_b16 v[54:55], v18 offset:9824
    ds_read_b64_tr_b16 v[56:57], v18 offset:8768
    ds_read_b64_tr_b16 v[58:59], v18 offset:9856
    ds_read_b64_tr_b16 v[60:61], v18 offset:8800
    ds_read_b64_tr_b16 v[62:63], v18 offset:9888
    s_waitcnt lgkmcnt(0)
    v_mfma_f32_16x16x32_bf16 v[64:67], v[48:51], v[32:35], v[64:67]
    v_mfma_f32_16x16x32_bf16 v[68:71], v[48:51], v[36:39], v[68:71]
    v_mfma_f32_16x16x32_bf16 v[72:75], v[48:51], v[40:43], v[72:75]
    v_mfma_f32_16x16x32_bf16 v[76:79], v[48:51], v[44:47], v[76:79]
    v_mfma_f32_16x16x32_bf16 v[80:83], v[52:55], v[32:35], v[80:83]
    v_mfma_f32_16x16x32_bf16 v[84:87], v[52:55], v[36:39], v[84:87]
    v_mfma_f32_16x16x32_bf16 v[88:91], v[52:55], v[40:43], v[88:91]
    v_mfma_f32_16x16x32_bf16 v[92:95], v[52:55], v[44:47], v[92:95]
    v_mfma_f32_16x16x32_bf16 v[96:99], v[56:59], v[32:35], v[96:99]
    v_mfma_f32_16x16x32_bf16 v[100:103], v[56:59], v[36:39], v[100:103]
    v_mfma_f32_16x16x32_bf16 v[104:107], v[56:59], v[40:43], v[104:107]
    v_mfma_f32_16x16x32_bf16 v[108:111], v[56:59], v[44:47], v[108:111]
    v_mfma_f32_16x16x32_bf16 v[112:115], v[60:63], v[32:35], v[112:115]
    v_mfma_f32_16x16x32_bf16 v[116:119], v[60:63], v[36:39], v[116:119]
    v_mfma_f32_16x16x32_bf16 v[120:123], v[60:63], v[40:43], v[120:123]
    v_mfma_f32_16x16x32_bf16 v[124:127], v[60:63], v[44:47], v[124:127]
    s_waitcnt vmcnt(0)
    ds_write_b128 v5, v[128:131] offset:35840
    ds_write_b128 v5, v[132:135] offset:40448
    ds_write_b128 v5, v[136:139] offset:45056
    ds_write_b128 v5, v[140:143] offset:49664
    ds_write_b128 v10, v[144:147] offset:35840
    ds_write_b128 v10, v[148:151] offset:40192
    ds_write_b128 v10, v[152:155] offset:44544
    ds_write_b128 v10, v[156:159] offset:48896
    s_waitcnt lgkmcnt(0)
    s_barrier
    s_add_u32 s72, s72, 1
    s_cmp_ge_u32 s72, s8
    s_cbranch_scc1 gkdone_31
    s_add_u32 s73, s72, 1
    s_cmp_ge_u32 s73, s8
    s_cbranch_scc1 noload_33
    buffer_load_dwordx4 v[128:131], v3, s[48:51], s60 offen
    buffer_load_dwordx4 v[132:135], v3, s[48:51], s61 offen
    buffer_load_dwordx4 v[136:139], v3, s[48:51], s62 offen
    buffer_load_dwordx4 v[140:143], v3, s[48:51], s63 offen
    buffer_load_dwordx4 v[144:147], v9, s[52:55], s68 offen
    buffer_load_dwordx4 v[148:151], v9, s[52:55], s69 offen
    buffer_load_dwordx4 v[152:155], v9, s[52:55], s70 offen
    buffer_load_dwordx4 v[156:159], v9, s[52:55], s71 offen
    v_add_u32 v3, 128, v3
    v_add_u32 v9, s67, v9
noload_33:
    ds_read_b128 v[32:35], v17 offset:35840
    ds_read_b128 v[36:39], v17 offset:38144
    ds_read_b128 v[40:43], v17 offset:40448
    ds_read_b128 v[44:47], v17 offset:42752
    ds_read_b64_tr_b16 v[48:49], v18 offset:35840
    ds_read_b64_tr_b16 v[50:51], v18 offset:36928
    ds_read_b64_tr_b16 v[52:53], v18 offset:35872
    ds_read_b64_tr_b16 v[54:55], v18 offset:36960
    ds_read_b64_tr_b16 v[56:57], v18 offset:35904
    ds_read_b64_tr_b16 v[58:59], v18 offset:36992
    ds_read_b64_tr_b16 v[60:61], v18 offset:35936
    ds_read_b64_tr_b16 v[62:63], v18 offset:37024
    s_waitcnt lgkmcnt(0)
    v_mfma_f32_16x16x32_bf16 v[64:67], v[48:51], v[32:35], v[64:67]
    v_mfma_f32_16x16x32_bf16 v[68:71], v[48:51], v[36:39], v[68:71]
    v_mfma_f32_16x16x32_bf16 v[72:75], v[48:51], v[40:43], v[72:75]
    v_mfma_f32_16x16x32_bf16 v[76:79], v[48:51], v[44:47], v[76:79]
    v_mfma_f32_16x16x32_bf16 v[80:83], v[52:55], v[32:35], v[80:83]
    v_mfma_f32_16x16x32_bf16 v[84:87], v[52:55], v[36:39], v[84:87]
    v_mfma_f32_16x16x32_bf16 v[88:91], v[52:55], v[40:43], v[88:91]
    v_mfma_f32_16x16x32_bf16 v[92:95], v[52:55], v[44:47], v[92:95]
    v_mfma_f32_16x16x32_bf16 v[96:99], v[56:59], v[32:35], v[96:99]
    v_mfma_f32_16x16x32_bf16 v[100:103], v[56:59], v[36:39], v[100:103]
    v_mfma_f32_16x16x32_bf16 v[104:107], v[56:59], v[40:43], v[104:107]
    v_mfma_f32_16x16x32_bf16 v[108:111], v[56:59], v[44:47], v[108:111]
    v_mfma_f32_16x16x32_bf16 v[112:115], v[60:63], v[32:35], v[112:115]
    v_mfma_f32_16x16x32_bf16 v[116:119], v[60:63], v[36:39], v[116:119]
    v_mfma_f32_16x16x32_bf16 v[120:123], v[60:63], v[40:43], v[120:123]
    v_mfma_f32_16x16x32_bf16 v[124:127], v[60:63], v[44:47], v[124:127]
    ds_read_b128 v[32:35], v17 offset:35904
    ds_read_b128 v[36:39], v17 offset:38208
    ds_read_b128 v[40:43], v17 offset:40512
    ds_read_b128 v[44:47], v17 offset:42816
    ds_read_b64_tr_b16 v[48:49], v18 offset:44544
    ds_read_b64_tr_b16 v[50:51], v18 offset:45632
    ds_read_b64_tr_b16 v[52:53], v18 offset:44576
    ds_read_b64_tr_b16 v[54:55], v18 offset:45664
    ds_read_b64_tr_b16 v[56:57], v18 offset:44608
    ds_read_b64_tr_b16 v[58:59], v18 offset:45696
    ds_read_b64_tr_b16 v[60:61], v18 offset:44640
    ds_read_b64_tr_b16 v[62:63], v18 offset:45728
    s_waitcnt lgkmcnt(0)
    v_mfma_f32_16x16x32_bf16 v[64:67], v[48:51], v[32:35], v[64:67]
    v_mfma_f32_16x16x32_bf16 v[68:71], v[48:51], v[36:39], v[68:71]
    v_mfma_f32_16x16x32_bf16 v[72:75], v[48:51], v[40:43], v[72:75]
    v_mfma_f32_16x16x32_bf16 v[76:79], v[48:51], v[44:47], v[76:79]
    v_mfma_f32_16x16x32_bf16 v[80:83], v[52:55], v[32:35], v[80:83]
    v_mfma_f32_16x16x32_bf16 v[84:87], v[52:55], v[36:39], v[84:87]
    v_mfma_f32_16x16x32_bf16 v[88:91], v[52:55], v[40:43], v[88:91]
    v_mfma_f32_16x16x32_bf16 v[92:95], v[52:55], v[44:47], v[92:95]
    v_mfma_f32_16x16x32_bf16 v[96:99], v[56:59], v[32:35], v[96:99]
    v_mfma_f32_16x16x32_bf16 v[100:103], v[56:59], v[36:39], v[100:103]
    v_mfma_f32_16x16x32_bf16 v[104:107], v[56:59], v[40:43], v[104:107]
    v_mfma_f32_16x16x32_bf16 v[108:111], v[56:59], v[44:47], v[108:111]
    v_mfma_f32_16x16x32_bf16 v[112:115], v[60:63], v[32:35], v[112:115]
    v_mfma_f32_16x16x32_bf16 v[116:119], v[60:63], v[36:39], v[116:119]
    v_mfma_f32_16x16x32_bf16 v[120:123], v[60:63], v[40:43], v[120:123]
    v_mfma_f32_16x16x32_bf16 v[124:127], v[60:63], v[44:47], v[124:127]
    s_waitcnt vmcnt(0)
    ds_write_b128 v5, v[128:131] offset:0
    ds_write_b128 v5, v[132:135] offset:4608
    ds_write_b128 v5, v[136:139] offset:9216
    ds_write_b128 v5, v[140:143] offset:13824
    ds_write_b128 v10, v[144:147] offset:0
    ds_write_b128 v10, v[148:151] offset:4352
    ds_write_b128 v10, v[152:155] offset:8704
    ds_write_b128 v10, v[156:159] offset:13056
    s_waitcnt lgkmcnt(0)
    s_barrier
    s_add_u32 s72, s72, 1
    s_cmp_ge_u32 s72, s8
    s_cbranch_scc1 gkdone_31
    s_branch gk_30
gkdone_31:
    s_nop 7
    s_nop 7
    v_mul_u32_u24 v20, 64, v15
    v_add_u32 v20, v20, v13
    v_mul_lo_u32 v20, v20, s9
    v_mul_u32_u24 v21, 128, v16
    v_lshlrev_b32 v22, 3, v14
    v_add3_u32 v20, v20, v21, v22
    s_mul_i32 s74, s5, s9
    s_add_u32 s74, s74, s66
    s_lshl_b32 s76, s9, 4
    v_cvt_pk_bf16_f32 v24, v64, v65
    v_cvt_pk_bf16_f32 v25, v66, v67
    buffer_store_dwordx2 v[24:25], v20, s[56:59], s74 offen offset:0
    v_cvt_pk_bf16_f32 v24, v80, v81
    v_cvt_pk_bf16_f32 v25, v82, v83
    buffer_store_dwordx2 v[24:25], v20, s[56:59], s74 offen offset:32
    v_cvt_pk_bf16_f32 v24, v96, v97
    v_cvt_pk_bf16_f32 v25, v98, v99
    buffer_store_dwordx2 v[24:25], v20, s[56:59], s74 offen offset:64
    v_cvt_pk_bf16_f32 v24, v112, v113
    v_cvt_pk_bf16_f32 v25, v114, v115
    buffer_store_dwordx2 v[24:25], v20, s[56:59], s74 offen offset:96
    s_add_u32 s74, s74, s76
    v_cvt_pk_bf16_f32 v24, v68, v69
    v_cvt_pk_bf16_f32 v25, v70, v71
    buffer_store_dwordx2 v[24:25], v20, s[56:59], s74 offen offset:0
    v_cvt_pk_bf16_f32 v24, v84, v85
    v_cvt_pk_bf16_f32 v25, v86, v87
    buffer_store_dwordx2 v[24:25], v20, s[56:59], s74 offen offset:32
    v_cvt_pk_bf16_f32 v24, v100, v101
    v_cvt_pk_bf16_f32 v25, v102, v103
    buffer_store_dwordx2 v[24:25], v20, s[56:59], s74 offen offset:64
    v_cvt_pk_bf16_f32 v24, v116, v117
    v_cvt_pk_bf16_f32 v25, v118, v119
    buffer_store_dwordx2 v[24:25], v20, s[56:59], s74 offen offset:96
    s_add_u32 s74, s74, s76
    v_cvt_pk_bf16_f32 v24, v72, v73
    v_cvt_pk_bf16_f32 v25, v74, v75
    buffer_store_dwordx2 v[24:25], v20, s[56:59], s74 offen offset:0
    v_cvt_pk_bf16_f32 v24, v88, v89
    v_cvt_pk_bf16_f32 v25, v90, v91
    buffer_store_dwordx2 v[24:25], v20, s[56:59], s74 offen offset:32
    v_cvt_pk_bf16_f32 v24, v104, v105
    v_cvt_pk_bf16_f32 v25, v106, v107
    buffer_store_dwordx2 v[24:25], v20, s[56:59], s74 offen offset:64
    v_cvt_pk_bf16_f32 v24, v120, v121
    v_cvt_pk_bf16_f32 v25, v122, v123
    buffer_store_dwordx2 v[24:25], v20, s[56:59], s74 offen offset:96
    s_add_u32 s74, s74, s76
    v_cvt_pk_bf16_f32 v24, v76, v77
    v_cvt_pk_bf16_f32 v25, v78, v79
    buffer_store_dwordx2 v[24:25], v20, s[56:59], s74 offen offset:0
    v_cvt_pk_bf16_f32 v24, v92, v93
    v_cvt_pk_bf16_f32 v25, v94, v95
    buffer_store_dwordx2 v[24:25], v20, s[56:59], s74 offen offset:32
    v_cvt_pk_bf16_f32 v24, v108, v109
    v_cvt_pk_bf16_f32 v25, v110, v111
    buffer_store_dwordx2 v[24:25], v20, s[56:59], s74 offen offset:64
    v_cvt_pk_bf16_f32 v24, v124, v125
    v_cvt_pk_bf16_f32 v25, v126, v127
    buffer_store_dwordx2 v[24:25], v20, s[56:59], s74 offen offset:96
    s_barrier
    s_add_u32 s83, s83, 212
    s_branch L_k2_g
L_k2_gdone:
    s_waitcnt vmcnt(0)
    s_barrier
    v_cmp_eq_u32 vcc, 0, v0
    s_and_saveexec_b64 s[80:81], vcc
    s_cbranch_execz arr_34
    buffer_wbl2 sc1
    s_waitcnt vmcnt(0)
    v_mov_b32 v1, 0
    v_mov_b32 v2, 1
    buffer_atomic_add v2, v1, s[84:87], 0 offen
    s_waitcnt vmcnt(0)
arr_34:
    s_mov_b64 exec, s[80:81]
    v_mov_b32 v1, 0
wt_35:
    buffer_load_dword v2, v1, s[84:87], 0 offen sc1
    s_waitcnt vmcnt(0)
    v_cmp_gt_u32 vcc, 212, v2
    s_cbranch_vccnz wt_35
    buffer_inv sc1
    s_waitcnt vmcnt(0)
    s_barrier
    s_mov_b32 s48, s46
    s_mov_b32 s49, s47
    s_mov_b32 s50, 0x7fffffff
    s_mov_b32 s51, 0x00020000
    s_mov_b32 s83, s82
    v_and_b32 v1, 63, v0
    v_lshrrev_b32 v2, 6, v0
    s_nop 1
    v_readfirstlane_b32 s3, v2
    v_and_b32 v3, 15, v1
    v_lshrrev_b32 v4, 4, v1
    s_lshr_b32 s4, s83, 4
    s_sub_u32 s4, 15, s4
    s_and_b32 s6, s83, 15
    s_lshl_b32 s7, s6, 9
    v_xor_b32 v5, 16, v1
    v_lshlrev_b32 v5, 2, v5
    v_xor_b32 v6, 32, v1
    v_lshlrev_b32 v6, 2, v6
    v_lshlrev_b32 v7, 13, v3
    v_lshlrev_b32 v8, 4, v4
    v_add_u32 v7, v7, v8
    s_lshl_b32 s8, s4, 20
    s_lshl_b32 s9, s3, 18
    s_add_u32 s8, s8, s9
    s_add_u32 s8, s8, s7
    v_lshrrev_b32 v9, 5, v0
    v_and_b32 v10, 31, v0
    v_lshlrev_b32 v10, 4, v10
    v_lshlrev_b32 v11, 13, v9
    v_add_u32 v11, v11, v10
    v_mul_u32_u24 v12, 528, v9
    v_add_u32 v12, v12, v10
    v_mul_u32_u24 v13, 528, v3
    v_add_u32 v13, v13, v8
    v_lshlrev_b32 v17, 2, v4
    v_lshrrev_b32 v14, 2, v3
    v_add_u32 v14, v14, v17
    v_mul_u32_u24 v14, 528, v14
    v_and_b32 v15, 3, v3
    v_lshlrev_b32 v15, 3, v15
    v_add_u32 v14, v14, v15
    v_add_u32 v14, 16896, v14
    s_lshl_b32 s10, s4, 7
    s_lshl_b32 s11, s3, 5
    s_add_u32 s10, s10, s11
    v_add_u32 v15, s10, v3
    v_sub_u32 v15, v15, v17
    s_add_u32 s12, s4, 1
    s_lshl_b32 s12, s12, 2
    s_lshl_b32 s13, s4, 2
    s_add_u32 s14, s8, 50331648
    buffer_load_dwordx4 v[64:67], v7, s[48:51], s14 offen offset:0
    buffer_load_dwordx4 v[68:71], v7, s[48:51], s14 offen offset:64
    buffer_load_dwordx4 v[72:75], v7, s[48:51], s14 offen offset:128
    buffer_load_dwordx4 v[76:79], v7, s[48:51], s14 offen offset:192
    buffer_load_dwordx4 v[80:83], v7, s[48:51], s14 offen offset:256
    buffer_load_dwordx4 v[84:87], v7, s[48:51], s14 offen offset:320
    buffer_load_dwordx4 v[88:91], v7, s[48:51], s14 offen offset:384
    buffer_load_dwordx4 v[92:95], v7, s[48:51], s14 offen offset:448
    s_waitcnt vmcnt(0)
    v_accvgpr_write_b32 a0, v64
    v_accvgpr_write_b32 a1, v65
    v_accvgpr_write_b32 a2, v66
    v_accvgpr_write_b32 a3, v67
    v_accvgpr_write_b32 a4, v68
    v_accvgpr_write_b32 a5, v69
    v_accvgpr_write_b32 a6, v70
    v_accvgpr_write_b32 a7, v71
    v_accvgpr_write_b32 a8, v72
    v_accvgpr_write_b32 a9, v73
    v_accvgpr_write_b32 a10, v74
    v_accvgpr_write_b32 a11, v75
    v_accvgpr_write_b32 a12, v76
    v_accvgpr_write_b32 a13, v77
    v_accvgpr_write_b32 a14, v78
    v_accvgpr_write_b32 a15, v79
    v_accvgpr_write_b32 a16, v80
    v_accvgpr_write_b32 a17, v81
    v_accvgpr_write_b32 a18, v82
    v_accvgpr_write_b32 a19, v83
    v_accvgpr_write_b32 a20, v84
    v_accvgpr_write_b32 a21, v85
    v_accvgpr_write_b32 a22, v86
    v_accvgpr_write_b32 a23, v87
    v_accvgpr_write_b32 a24, v88
    v_accvgpr_write_b32 a25, v89
    v_accvgpr_write_b32 a26, v90
    v_accvgpr_write_b32 a27, v91
    v_accvgpr_write_b32 a28, v92
    v_accvgpr_write_b32 a29, v93
    v_accvgpr_write_b32 a30, v94
    v_accvgpr_write_b32 a31, v95
    s_add_u32 s14, s8, 50462720
    buffer_load_dwordx4 v[64:67], v7, s[48:51], s14 offen offset:0
    buffer_load_dwordx4 v[68:71], v7, s[48:51], s14 offen offset:64
    buffer_load_dwordx4 v[72:75], v7, s[48:51], s14 offen offset:128
    buffer_load_dwordx4 v[76:79], v7, s[48:51], s14 offen offset:192
    buffer_load_dwordx4 v[80:83], v7, s[48:51], s14 offen offset:256
    buffer_load_dwordx4 v[84:87], v7, s[48:51], s14 offen offset:320
    buffer_load_dwordx4 v[88:91], v7, s[48:51], s14 offen offset:384
    buffer_load_dwordx4 v[92:95], v7, s[48:51], s14 offen offset:448
    s_waitcnt vmcnt(0)
    v_accvgpr_write_b32 a32, v64
    v_accvgpr_write_b32 a33, v65
    v_accvgpr_write_b32 a34, v66
    v_accvgpr_write_b32 a35, v67
    v_accvgpr_write_b32 a36, v68
    v_accvgpr_write_b32 a37, v69
    v_accvgpr_write_b32 a38, v70
    v_accvgpr_write_b32 a39, v71
    v_accvgpr_write_b32 a40, v72
    v_accvgpr_write_b32 a41, v73
    v_accvgpr_write_b32 a42, v74
    v_accvgpr_write_b32 a43, v75
    v_accvgpr_write_b32 a44, v76
    v_accvgpr_write_b32 a45, v77
    v_accvgpr_write_b32 a46, v78
    v_accvgpr_write_b32 a47, v79
    v_accvgpr_write_b32 a48, v80
    v_accvgpr_write_b32 a49, v81
    v_accvgpr_write_b32 a50, v82
    v_accvgpr_write_b32 a51, v83
    v_accvgpr_write_b32 a52, v84
    v_accvgpr_write_b32 a53, v85
    v_accvgpr_write_b32 a54, v86
    v_accvgpr_write_b32 a55, v87
    v_accvgpr_write_b32 a56, v88
    v_accvgpr_write_b32 a57, v89
    v_accvgpr_write_b32 a58, v90
    v_accvgpr_write_b32 a59, v91
    v_accvgpr_write_b32 a60, v92
    v_accvgpr_write_b32 a61, v93
    v_accvgpr_write_b32 a62, v94
    v_accvgpr_write_b32 a63, v95
    v_mov_b32 v128, 0
    v_mov_b32 v129, 0
    v_mov_b32 v130, 0
    v_mov_b32 v131, 0
    v_mov_b32 v132, 0
    v_mov_b32 v133, 0
    v_mov_b32 v134, 0
    v_mov_b32 v135, 0
    v_mov_b32 v136, 0
    v_mov_b32 v137, 0
    v_mov_b32 v138, 0
    v_mov_b32 v139, 0
    v_mov_b32 v140, 0
    v_mov_b32 v141, 0
    v_mov_b32 v142, 0
    v_mov_b32 v143, 0
    v_mov_b32 v144, 0
    v_mov_b32 v145, 0
    v_mov_b32 v146, 0
    v_mov_b32 v147, 0
    v_mov_b32 v148, 0
    v_mov_b32 v149, 0
    v_mov_b32 v150, 0
    v_mov_b32 v151, 0
    v_mov_b32 v152, 0
    v_mov_b32 v153, 0
    v_mov_b32 v154, 0
    v_mov_b32 v155, 0
    v_mov_b32 v156, 0
    v_mov_b32 v157, 0
    v_mov_b32 v158, 0
    v_mov_b32 v159, 0
    v_mov_b32 v160, 0
    v_mov_b32 v161, 0
    v_mov_b32 v162, 0
    v_mov_b32 v163, 0
    v_mov_b32 v164, 0
    v_mov_b32 v165, 0
    v_mov_b32 v166, 0
    v_mov_b32 v167, 0
    v_mov_b32 v168, 0
    v_mov_b32 v169, 0
    v_mov_b32 v170, 0
    v_mov_b32 v171, 0
    v_mov_b32 v172, 0
    v_mov_b32 v173, 0
    v_mov_b32 v174, 0
    v_mov_b32 v175, 0
    v_mov_b32 v176, 0
    v_mov_b32 v177, 0
    v_mov_b32 v178, 0
    v_mov_b32 v179, 0
    v_mov_b32 v180, 0
    v_mov_b32 v181, 0
    v_mov_b32 v182, 0
    v_mov_b32 v183, 0
    v_mov_b32 v184, 0
    v_mov_b32 v185, 0
    v_mov_b32 v186, 0
    v_mov_b32 v187, 0
    v_mov_b32 v188, 0
    v_mov_b32 v189, 0
    v_mov_b32 v190, 0
    v_mov_b32 v191, 0
    v_mov_b32 v192, 0
    v_mov_b32 v193, 0
    v_mov_b32 v194, 0
    v_mov_b32 v195, 0
    v_mov_b32 v196, 0
    v_mov_b32 v197, 0
    v_mov_b32 v198, 0
    v_mov_b32 v199, 0
    v_mov_b32 v200, 0
    v_mov_b32 v201, 0
    v_mov_b32 v202, 0
    v_mov_b32 v203, 0
    v_mov_b32 v204, 0
    v_mov_b32 v205, 0
    v_mov_b32 v206, 0
    v_mov_b32 v207, 0
    v_mov_b32 v208, 0
    v_mov_b32 v209, 0
    v_mov_b32 v210, 0
    v_mov_b32 v211, 0
    v_mov_b32 v212, 0
    v_mov_b32 v213, 0
    v_mov_b32 v214, 0
    v_mov_b32 v215, 0
    v_mov_b32 v216, 0
    v_mov_b32 v217, 0
    v_mov_b32 v218, 0
    v_mov_b32 v219, 0
    v_mov_b32 v220, 0
    v_mov_b32 v221, 0
    v_mov_b32 v222, 0
    v_mov_b32 v223, 0
    v_mov_b32 v224, 0
    v_mov_b32 v225, 0
    v_mov_b32 v226, 0
    v_mov_b32 v227, 0
    v_mov_b32 v228, 0
    v_mov_b32 v229, 0
    v_mov_b32 v230, 0
    v_mov_b32 v231, 0
    v_mov_b32 v232, 0
    v_mov_b32 v233, 0
    v_mov_b32 v234, 0
    v_mov_b32 v235, 0
    v_mov_b32 v236, 0
    v_mov_b32 v237, 0
    v_mov_b32 v238, 0
    v_mov_b32 v239, 0
    v_mov_b32 v240, 0
    v_mov_b32 v241, 0
    v_mov_b32 v242, 0
    v_mov_b32 v243, 0
    v_mov_b32 v244, 0
    v_mov_b32 v245, 0
    v_mov_b32 v246, 0
    v_mov_b32 v247, 0
    v_mov_b32 v248, 0
    v_mov_b32 v249, 0
    v_mov_b32 v250, 0
    v_mov_b32 v251, 0
    v_mov_b32 v252, 0
    v_mov_b32 v253, 0
    v_mov_b32 v254, 0
    v_mov_b32 v255, 0
    s_mov_b32 s15, 0xff800000
    v_mov_b32 v120, s15
    v_mov_b32 v121, s15
    v_mov_b32 v122, 0
    v_mov_b32 v123, 0
    s_mov_b32 s18, 0
    s_lshl_b32 s16, s18, 18
    s_add_u32 s16, s16, s7
    s_add_u32 s17, s16, 67108864
    buffer_load_dwordx4 a[64:67], v11, s[48:51], s17 offen
    s_add_u32 s17, s16, 67174400
    buffer_load_dwordx4 a[68:71], v11, s[48:51], s17 offen
    s_add_u32 s17, s16, 67239936
    buffer_load_dwordx4 a[72:75], v11, s[48:51], s17 offen
    s_add_u32 s17, s16, 67305472
    buffer_load_dwordx4 a[76:79], v11, s[48:51], s17 offen
    s_add_u32 s17, s16, 83886080
    buffer_load_dwordx4 a[80:83], v11, s[48:51], s17 offen
    s_add_u32 s17, s16, 83951616
    buffer_load_dwordx4 a[84:87], v11, s[48:51], s17 offen
    s_add_u32 s17, s16, 84017152
    buffer_load_dwordx4 a[88:91], v11, s[48:51], s17 offen
    s_add_u32 s17, s16, 84082688
    buffer_load_dwordx4 a[92:95], v11, s[48:51], s17 offen
    s_waitcnt vmcnt(0)
    ds_write_b128 v12, a[64:67] offset:0
    ds_write_b128 v12, a[68:71] offset:4224
    ds_write_b128 v12, a[72:75] offset:8448
    ds_write_b128 v12, a[76:79] offset:12672
    ds_write_b128 v12, a[80:83] offset:16896
    ds_write_b128 v12, a[84:87] offset:21120
    ds_write_b128 v12, a[88:91] offset:25344
    ds_write_b128 v12, a[92:95] offset:29568
    s_waitcnt lgkmcnt(0)
    s_barrier
fl_36:
    s_add_u32 s19, s18, 1
    s_cmp_ge_u32 s19, s12
    s_cbranch_scc1 fnl_38
    s_lshl_b32 s16, s19, 18
    s_add_u32 s16, s16, s7
    s_add_u32 s17, s16, 67108864
    buffer_load_dwordx4 a[64:67], v11, s[48:51], s17 offen
    s_add_u32 s17, s16, 67174400
    buffer_load_dwordx4 a[68:71], v11, s[48:51], s17 offen
    s_add_u32 s17, s16, 67239936
    buffer_load_dwordx4 a[72:75], v11, s[48:51], s17 offen
    s_add_u32 s17, s16, 67305472
    buffer_load_dwordx4 a[76:79], v11, s[48:51], s17 offen
    s_add_u32 s17, s16, 83886080
    buffer_load_dwordx4 a[80:83], v11, s[48:51], s17 offen
    s_add_u32 s17, s16, 83951616
    buffer_load_dwordx4 a[84:87], v11, s[48:51], s17 offen
    s_add_u32 s17, s16, 84017152
    buffer_load_dwordx4 a[88:91], v11, s[48:51], s17 offen
    s_add_u32 s17, s16, 84082688
    buffer_load_dwordx4 a[92:95], v11, s[48:51], s17 offen
fnl_38:
    v_mov_b32 v96, 0
    v_mov_b32 v97, 0
    v_mov_b32 v98, 0
    v_mov_b32 v99, 0
    v_mov_b32 v100, 0
    v_mov_b32 v101, 0
    v_mov_b32 v102, 0
    v_mov_b32 v103, 0
    v_mov_b32 v104, 0
    v_mov_b32 v105, 0
    v_mov_b32 v106, 0
    v_mov_b32 v107, 0
    v_mov_b32 v108, 0
    v_mov_b32 v109, 0
    v_mov_b32 v110, 0
    v_mov_b32 v111, 0
    ds_read_b128 v[32:35], v13 offset:0
    ds_read_b128 v[36:39], v13 offset:8448
    ds_read_b128 v[40:43], v13 offset:64
    ds_read_b128 v[44:47], v13 offset:8512
    ds_read_b128 v[48:51], v13 offset:128
    ds_read_b128 v[52:55], v13 offset:8576
    ds_read_b128 v[56:59], v13 offset:192
    ds_read_b128 v[60:63], v13 offset:8640
    ds_read_b128 v[64:67], v13 offset:256
    ds_read_b128 v[68:71], v13 offset:8704
    ds_read_b128 v[72:75], v13 offset:320
    ds_read_b128 v[76:79], v13 offset:8768
    ds_read_b128 v[80:83], v13 offset:384
    ds_read_b128 v[84:87], v13 offset:8832
    ds_read_b128 v[88:91], v13 offset:448
    ds_read_b128 v[92:95], v13 offset:8896
    s_waitcnt lgkmcnt(14)
    v_mfma_f32_16x16x32_bf16 v[96:99], v[32:35], a[0:3], v[96:99]
    v_mfma_f32_16x16x32_bf16 v[100:103], v[32:35], a[32:35], v[100:103]
    v_mfma_f32_16x16x32_bf16 v[104:107], v[36:39], a[0:3], v[104:107]
    v_mfma_f32_16x16x32_bf16 v[108:111], v[36:39], a[32:35], v[108:111]
    s_waitcnt lgkmcnt(12)
    v_mfma_f32_16x16x32_bf16 v[96:99], v[40:43], a[4:7], v[96:99]
    v_mfma_f32_16x16x32_bf16 v[100:103], v[40:43], a[36:39], v[100:103]
    v_mfma_f32_16x16x32_bf16 v[104:107], v[44:47], a[4:7], v[104:107]
    v_mfma_f32_16x16x32_bf16 v[108:111], v[44:47], a[36:39], v[108:111]
    s_waitcnt lgkmcnt(10)
    v_mfma_f32_16x16x32_bf16 v[96:99], v[48:51], a[8:11], v[96:99]
    v_mfma_f32_16x16x32_bf16 v[100:103], v[48:51], a[40:43], v[100:103]
    v_mfma_f32_16x16x32_bf16 v[104:107], v[52:55], a[8:11], v[104:107]
    v_mfma_f32_16x16x32_bf16 v[108:111], v[52:55], a[40:43], v[108:111]
    s_waitcnt lgkmcnt(8)
    v_mfma_f32_16x16x32_bf16 v[96:99], v[56:59], a[12:15], v[96:99]
    v_mfma_f32_16x16x32_bf16 v[100:103], v[56:59], a[44:47], v[100:103]
    v_mfma_f32_16x16x32_bf16 v[104:107], v[60:63], a[12:15], v[104:107]
    v_mfma_f32_16x16x32_bf16 v[108:111], v[60:63], a[44:47], v[108:111]
    s_waitcnt lgkmcnt(6)
    v_mfma_f32_16x16x32_bf16 v[96:99], v[64:67], a[16:19], v[96:99]
    v_mfma_f32_16x16x32_bf16 v[100:103], v[64:67], a[48:51], v[100:103]
    v_mfma_f32_16x16x32_bf16 v[104:107], v[68:71], a[16:19], v[104:107]
    v_mfma_f32_16x16x32_bf16 v[108:111], v[68:71], a[48:51], v[108:111]
    s_waitcnt lgkmcnt(4)
    v_mfma_f32_16x16x32_bf16 v[96:99], v[72:75], a[20:23], v[96:99]
    v_mfma_f32_16x16x32_bf16 v[100:103], v[72:75], a[52:55], v[100:103]
    v_mfma_f32_16x16x32_bf16 v[104:107], v[76:79], a[20:23], v[104:107]
    v_mfma_f32_16x16x32_bf16 v[108:111], v[76:79], a[52:55], v[108:111]
    s_waitcnt lgkmcnt(2)
    v_mfma_f32_16x16x32_bf16 v[96:99], v[80:83], a[24:27], v[96:99]
    v_mfma_f32_16x16x32_bf16 v[100:103], v[80:83], a[56:59], v[100:103]
    v_mfma_f32_16x16x32_bf16 v[104:107], v[84:87], a[24:27], v[104:107]
    v_mfma_f32_16x16x32_bf16 v[108:111], v[84:87], a[56:59], v[108:111]
    s_waitcnt lgkmcnt(0)
    v_mfma_f32_16x16x32_bf16 v[96:99], v[88:91], a[28:31], v[96:99]
    v_mfma_f32_16x16x32_bf16 v[100:103], v[88:91], a[60:63], v[100:103]
    v_mfma_f32_16x16x32_bf16 v[104:107], v[92:95], a[28:31], v[104:107]
    v_mfma_f32_16x16x32_bf16 v[108:111], v[92:95], a[60:63], v[108:111]
    ds_read_b64_tr_b16 v[32:33], v14 offset:0
    ds_read_b64_tr_b16 v[34:35], v14 offset:8448
    ds_read_b64_tr_b16 v[36:37], v14 offset:32
    ds_read_b64_tr_b16 v[38:39], v14 offset:8480
    ds_read_b64_tr_b16 v[40:41], v14 offset:64
    ds_read_b64_tr_b16 v[42:43], v14 offset:8512
    ds_read_b64_tr_b16 v[44:45], v14 offset:96
    ds_read_b64_tr_b16 v[46:47], v14 offset:8544
    ds_read_b64_tr_b16 v[48:49], v14 offset:128
    ds_read_b64_tr_b16 v[50:51], v14 offset:8576
    ds_read_b64_tr_b16 v[52:53], v14 offset:160
    ds_read_b64_tr_b16 v[54:55], v14 offset:8608
    ds_read_b64_tr_b16 v[56:57], v14 offset:192
    ds_read_b64_tr_b16 v[58:59], v14 offset:8640
    ds_read_b64_tr_b16 v[60:61], v14 offset:224
    ds_read_b64_tr_b16 v[62:63], v14 offset:8672
    ds_read_b64_tr_b16 v[64:65], v14 offset:256
    ds_read_b64_tr_b16 v[66:67], v14 offset:8704
    ds_read_b64_tr_b16 v[68:69], v14 offset:288
    ds_read_b64_tr_b16 v[70:71], v14 offset:8736
    ds_read_b64_tr_b16 v[72:73], v14 offset:320
    ds_read_b64_tr_b16 v[74:75], v14 offset:8768
    ds_read_b64_tr_b16 v[76:77], v14 offset:352
    ds_read_b64_tr_b16 v[78:79], v14 offset:8800
    ds_read_b64_tr_b16 v[80:81], v14 offset:384
    ds_read_b64_tr_b16 v[82:83], v14 offset:8832
    ds_read_b64_tr_b16 v[84:85], v14 offset:416
    ds_read_b64_tr_b16 v[86:87], v14 offset:8864
    ds_read_b64_tr_b16 v[88:89], v14 offset:448
    ds_read_b64_tr_b16 v[90:91], v14 offset:8896
    ds_read_b64_tr_b16 v[92:93], v14 offset:480
    ds_read_b64_tr_b16 v[94:95], v14 offset:8928
    s_nop 7
    s_nop 1
    s_mov_b32 s20, 0x3db8aa3b
    v_cvt_pk_bf16_f32 v124, v96, v97
    v_lshlrev_b32 v96, 16, v124
    v_and_b32 v97, 0xffff0000, v124
    v_cvt_pk_bf16_f32 v124, v98, v99
    v_lshlrev_b32 v98, 16, v124
    v_and_b32 v99, 0xffff0000, v124
    v_cvt_pk_bf16_f32 v124, v100, v101
    v_lshlrev_b32 v100, 16, v124
    v_and_b32 v101, 0xffff0000, v124
    v_cvt_pk_bf16_f32 v124, v102, v103
    v_lshlrev_b32 v102, 16, v124
    v_and_b32 v103, 0xffff0000, v124
    v_cvt_pk_bf16_f32 v124, v104, v105
    v_lshlrev_b32 v104, 16, v124
    v_and_b32 v105, 0xffff0000, v124
    v_cvt_pk_bf16_f32 v124, v106, v107
    v_lshlrev_b32 v106, 16, v124
    v_and_b32 v107, 0xffff0000, v124
    v_cvt_pk_bf16_f32 v124, v108, v109
    v_lshlrev_b32 v108, 16, v124
    v_and_b32 v109, 0xffff0000, v124
    v_cvt_pk_bf16_f32 v124, v110, v111
    v_lshlrev_b32 v110, 16, v124
    v_and_b32 v111, 0xffff0000, v124
    v_mul_f32 v96, s20, v96
    v_mul_f32 v97, s20, v97
    v_mul_f32 v98, s20, v98
    v_mul_f32 v99, s20, v99
    v_mul_f32 v100, s20, v100
    v_mul_f32 v101, s20, v101
    v_mul_f32 v102, s20, v102
    v_mul_f32 v103, s20, v103
    v_mul_f32 v104, s20, v104
    v_mul_f32 v105, s20, v105
    v_mul_f32 v106, s20, v106
    v_mul_f32 v107, s20, v107
    v_mul_f32 v108, s20, v108
    v_mul_f32 v109, s20, v109
    v_mul_f32 v110, s20, v110
    v_mul_f32 v111, s20, v111
    s_cmp_lt_u32 s18, s13
    s_cbranch_scc1 nomask_39
    s_lshl_b32 s21, s18, 5
    v_mov_b32 v125, s15
    s_add_u32 s22, s21, 0
    v_cmp_le_i32 vcc, s22, v15
    s_nop 1
    v_cndmask_b32 v96, v125, v96, vcc
    s_add_u32 s22, s21, 1
    v_cmp_le_i32 vcc, s22, v15
    s_nop 1
    v_cndmask_b32 v97, v125, v97, vcc
    s_add_u32 s22, s21, 2
    v_cmp_le_i32 vcc, s22, v15
    s_nop 1
    v_cndmask_b32 v98, v125, v98, vcc
    s_add_u32 s22, s21, 3
    v_cmp_le_i32 vcc, s22, v15
    s_nop 1
    v_cndmask_b32 v99, v125, v99, vcc
    s_add_u32 s22, s21, -16
    v_cmp_le_i32 vcc, s22, v15
    s_nop 1
    v_cndmask_b32 v100, v125, v100, vcc
    s_add_u32 s22, s21, -15
    v_cmp_le_i32 vcc, s22, v15
    s_nop 1
    v_cndmask_b32 v101, v125, v101, vcc
    s_add_u32 s22, s21, -14
    v_cmp_le_i32 vcc, s22, v15
    s_nop 1
    v_cndmask_b32 v102, v125, v102, vcc
    s_add_u32 s22, s21, -13
    v_cmp_le_i32 vcc, s22, v15
    s_nop 1
    v_cndmask_b32 v103, v125, v103, vcc
    s_add_u32 s22, s21, 16
    v_cmp_le_i32 vcc, s22, v15
    s_nop 1
    v_cndmask_b32 v104, v125, v104, vcc
    s_add_u32 s22, s21, 17
    v_cmp_le_i32 vcc, s22, v15
    s_nop 1
    v_cndmask_b32 v105, v125, v105, vcc
    s_add_u32 s22, s21, 18
    v_cmp_le_i32 vcc, s22, v15
    s_nop 1
    v_cndmask_b32 v106, v125, v106, vcc
    s_add_u32 s22, s21, 19
    v_cmp_le_i32 vcc, s22, v15
    s_nop 1
    v_cndmask_b32 v107, v125, v107, vcc
    s_add_u32 s22, s21, 0
    v_cmp_le_i32 vcc, s22, v15
    s_nop 1
    v_cndmask_b32 v108, v125, v108, vcc
    s_add_u32 s22, s21, 1
    v_cmp_le_i32 vcc, s22, v15
    s_nop 1
    v_cndmask_b32 v109, v125, v109, vcc
    s_add_u32 s22, s21, 2
    v_cmp_le_i32 vcc, s22, v15
    s_nop 1
    v_cndmask_b32 v110, v125, v110, vcc
    s_add_u32 s22, s21, 3
    v_cmp_le_i32 vcc, s22, v15
    s_nop 1
    v_cndmask_b32 v111, v125, v111, vcc
nomask_39:
    v_max3_f32 v126, v96, v97, v98
    v_max3_f32 v126, v126, v99, v104
    v_max3_f32 v126, v126, v105, v106
    v_max_f32 v126, v126, v107
    ds_bpermute_b32 v127, v5, v126
    s_waitcnt lgkmcnt(0)
    v_max_f32 v126, v126, v127
    ds_bpermute_b32 v127, v6, v126
    s_waitcnt lgkmcnt(0)
    v_max_f32 v126, v126, v127
    v_max_f32 v126, v126, v120
    v_sub_f32 v127, v120, v126
    v_exp_f32 v127, v127
    v_mov_b32 v120, v126
    v_sub_f32 v96, v96, v126
    v_exp_f32 v96, v96
    v_sub_f32 v97, v97, v126
    v_exp_f32 v97, v97
    v_sub_f32 v98, v98, v126
    v_exp_f32 v98, v98
    v_sub_f32 v99, v99, v126
    v_exp_f32 v99, v99
    v_sub_f32 v104, v104, v126
    v_exp_f32 v104, v104
    v_sub_f32 v105, v105, v126
    v_exp_f32 v105, v105
    v_sub_f32 v106, v106, v126
    v_exp_f32 v106, v106
    v_sub_f32 v107, v107, v126
    v_exp_f32 v107, v107
    s_nop 0
    v_mul_f32 v122, v122, v127
    v_add_f32 v122, v122, v96
    v_add_f32 v122, v122, v97
    v_add_f32 v122, v122, v98
    v_add_f32 v122, v122, v99
    v_add_f32 v122, v122, v104
    v_add_f32 v122, v122, v105
    v_add_f32 v122, v122, v106
    v_add_f32 v122, v122, v107
    v_cmp_neq_f32 vcc, 1.0, v127
    s_cbranch_vccz nors_40
    v_mul_f32 v128, v128, v127
    v_mul_f32 v129, v129, v127
    v_mul_f32 v130, v130, v127
    v_mul_f32 v131, v131, v127
    v_mul_f32 v136, v136, v127
    v_mul_f32 v137, v137, v127
    v_mul_f32 v138, v138, v127
    v_mul_f32 v139, v139, v127
    v_mul_f32 v144, v144, v127
    v_mul_f32 v145, v145, v127
    v_mul_f32 v146, v146, v127
    v_mul_f32 v147, v147, v127
    v_mul_f32 v152, v152, v127
    v_mul_f32 v153, v153, v127
    v_mul_f32 v154, v154, v127
    v_mul_f32 v155, v155, v127
    v_mul_f32 v160, v160, v127
    v_mul_f32 v161, v161, v127
    v_mul_f32 v162, v162, v127
    v_mul_f32 v163, v163, v127
    v_mul_f32 v168, v168, v127
    v_mul_f32 v169, v169, v127
    v_mul_f32 v170, v170, v127
    v_mul_f32 v171, v171, v127
    v_mul_f32 v176, v176, v127
    v_mul_f32 v177, v177, v127
    v_mul_f32 v178, v178, v127
    v_mul_f32 v179, v179, v127
    v_mul_f32 v184, v184, v127
    v_mul_f32 v185, v185, v127
    v_mul_f32 v186, v186, v127
    v_mul_f32 v187, v187, v127
    v_mul_f32 v192, v192, v127
    v_mul_f32 v193, v193, v127
    v_mul_f32 v194, v194, v127
    v_mul_f32 v195, v195, v127
    v_mul_f32 v200, v200, v127
    v_mul_f32 v201, v201, v127
    v_mul_f32 v202, v202, v127
    v_mul_f32 v203, v203, v127
    v_mul_f32 v208, v208, v127
    v_mul_f32 v209, v209, v127
    v_mul_f32 v210, v210, v127
    v_mul_f32 v211, v211, v127
    v_mul_f32 v216, v216, v127
    v_mul_f32 v217, v217, v127
    v_mul_f32 v218, v218, v127
    v_mul_f32 v219, v219, v127
    v_mul_f32 v224, v224, v127
    v_mul_f32 v225, v225, v127
    v_mul_f32 v226, v226, v127
    v_mul_f32 v227, v227, v127
    v_mul_f32 v232, v232, v127
    v_mul_f32 v233, v233, v127
    v_mul_f32 v234, v234, v127
    v_mul_f32 v235, v235, v127
    v_mul_f32 v240, v240, v127
    v_mul_f32 v241, v241, v127
    v_mul_f32 v242, v242, v127
    v_mul_f32 v243, v243, v127
    v_mul_f32 v248, v248, v127
    v_mul_f32 v249, v249, v127
    v_mul_f32 v250, v250, v127
    v_mul_f32 v251, v251, v127
nors_40:
    v_cvt_pk_bf16_f32 v112, v96, v97
    v_cvt_pk_bf16_f32 v113, v98, v99
    v_cvt_pk_bf16_f32 v114, v104, v105
    v_cvt_pk_bf16_f32 v115, v106, v107
    v_max3_f32 v126, v100, v101, v102
    v_max3_f32 v126, v126, v103, v108
    v_max3_f32 v126, v126, v109, v110
    v_max_f32 v126, v126, v111
    ds_bpermute_b32 v127, v5, v126
    s_waitcnt lgkmcnt(0)
    v_max_f32 v126, v126, v127
    ds_bpermute_b32 v127, v6, v126
    s_waitcnt lgkmcnt(0)
    v_max_f32 v126, v126, v127
    v_max_f32 v126, v126, v121
    v_sub_f32 v127, v121, v126
    v_exp_f32 v127, v127
    v_mov_b32 v121, v126
    v_sub_f32 v100, v100, v126
    v_exp_f32 v100, v100
    v_sub_f32 v101, v101, v126
    v_exp_f32 v101, v101
    v_sub_f32 v102, v102, v126
    v_exp_f32 v102, v102
    v_sub_f32 v103, v103, v126
    v_exp_f32 v103, v103
    v_sub_f32 v108, v108, v126
    v_exp_f32 v108, v108
    v_sub_f32 v109, v109, v126
    v_exp_f32 v109, v109
    v_sub_f32 v110, v110, v126
    v_exp_f32 v110, v110
    v_sub_f32 v111, v111, v126
    v_exp_f32 v111, v111
    s_nop 0
    v_mul_f32 v123, v123, v127
    v_add_f32 v123, v123, v100
    v_add_f32 v123, v123, v101
    v_add_f32 v123, v123, v102
    v_add_f32 v123, v123, v103
    v_add_f32 v123, v123, v108
    v_add_f32 v123, v123, v109
    v_add_f32 v123, v123, v110
    v_add_f32 v123, v123, v111
    v_cmp_neq_f32 vcc, 1.0, v127
    s_cbranch_vccz nors_41
    v_mul_f32 v132, v132, v127
    v_mul_f32 v133, v133, v127
    v_mul_f32 v134, v134, v127
    v_mul_f32 v135, v135, v127
    v_mul_f32 v140, v140, v127
    v_mul_f32 v141, v141, v127
    v_mul_f32 v142, v142, v127
    v_mul_f32 v143, v143, v127
    v_mul_f32 v148, v148, v127
    v_mul_f32 v149, v149, v127
    v_mul_f32 v150, v150, v127
    v_mul_f32 v151, v151, v127
    v_mul_f32 v156, v156, v127
    v_mul_f32 v157, v157, v127
    v_mul_f32 v158, v158, v127
    v_mul_f32 v159, v159, v127
    v_mul_f32 v164, v164, v127
    v_mul_f32 v165, v165, v127
    v_mul_f32 v166, v166, v127
    v_mul_f32 v167, v167, v127
    v_mul_f32 v172, v172, v127
    v_mul_f32 v173, v173, v127
    v_mul_f32 v174, v174, v127
    v_mul_f32 v175, v175, v127
    v_mul_f32 v180, v180, v127
    v_mul_f32 v181, v181, v127
    v_mul_f32 v182, v182, v127
    v_mul_f32 v183, v183, v127
    v_mul_f32 v188, v188, v127
    v_mul_f32 v189, v189, v127
    v_mul_f32 v190, v190, v127
    v_mul_f32 v191, v191, v127
    v_mul_f32 v196, v196, v127
    v_mul_f32 v197, v197, v127
    v_mul_f32 v198, v198, v127
    v_mul_f32 v199, v199, v127
    v_mul_f32 v204, v204, v127
    v_mul_f32 v205, v205, v127
    v_mul_f32 v206, v206, v127
    v_mul_f32 v207, v207, v127
    v_mul_f32 v212, v212, v127
    v_mul_f32 v213, v213, v127
    v_mul_f32 v214, v214, v127
    v_mul_f32 v215, v215, v127
    v_mul_f32 v220, v220, v127
    v_mul_f32 v221, v221, v127
    v_mul_f32 v222, v222, v127
    v_mul_f32 v223, v223, v127
    v_mul_f32 v228, v228, v127
    v_mul_f32 v229, v229, v127
    v_mul_f32 v230, v230, v127
    v_mul_f32 v231, v231, v127
    v_mul_f32 v236, v236, v127
    v_mul_f32 v237, v237, v127
    v_mul_f32 v238, v238, v127
    v_mul_f32 v239, v239, v127
    v_mul_f32 v244, v244, v127
    v_mul_f32 v245, v245, v127
    v_mul_f32 v246, v246, v127
    v_mul_f32 v247, v247, v127
    v_mul_f32 v252, v252, v127
    v_mul_f32 v253, v253, v127
    v_mul_f32 v254, v254, v127
    v_mul_f32 v255, v255, v127
nors_41:
    v_cvt_pk_bf16_f32 v116, v100, v101
    v_cvt_pk_bf16_f32 v117, v102, v103
    v_cvt_pk_bf16_f32 v118, v108, v109
    v_cvt_pk_bf16_f32 v119, v110, v111
    s_waitcnt lgkmcnt(0)
    v_mfma_f32_16x16x32_bf16 v[128:131], v[32:35], v[112:115], v[128:131]
    v_mfma_f32_16x16x32_bf16 v[132:135], v[32:35], v[116:119], v[132:135]
    v_mfma_f32_16x16x32_bf16 v[136:139], v[36:39], v[112:115], v[136:139]
    v_mfma_f32_16x16x32_bf16 v[140:143], v[36:39], v[116:119], v[140:143]
    v_mfma_f32_16x16x32_bf16 v[144:147], v[40:43], v[112:115], v[144:147]
    v_mfma_f32_16x16x32_bf16 v[148:151], v[40:43], v[116:119], v[148:151]
    v_mfma_f32_16x16x32_bf16 v[152:155], v[44:47], v[112:115], v[152:155]
    v_mfma_f32_16x16x32_bf16 v[156:159], v[44:47], v[116:119], v[156:159]
    v_mfma_f32_16x16x32_bf16 v[160:163], v[48:51], v[112:115], v[160:163]
    v_mfma_f32_16x16x32_bf16 v[164:167], v[48:51], v[116:119], v[164:167]
    v_mfma_f32_16x16x32_bf16 v[168:171], v[52:55], v[112:115], v[168:171]
    v_mfma_f32_16x16x32_bf16 v[172:175], v[52:55], v[116:119], v[172:175]
    v_mfma_f32_16x16x32_bf16 v[176:179], v[56:59], v[112:115], v[176:179]
    v_mfma_f32_16x16x32_bf16 v[180:183], v[56:59], v[116:119], v[180:183]
    v_mfma_f32_16x16x32_bf16 v[184:187], v[60:63], v[112:115], v[184:187]
    v_mfma_f32_16x16x32_bf16 v[188:191], v[60:63], v[116:119], v[188:191]
    v_mfma_f32_16x16x32_bf16 v[192:195], v[64:67], v[112:115], v[192:195]
    v_mfma_f32_16x16x32_bf16 v[196:199], v[64:67], v[116:119], v[196:199]
    v_mfma_f32_16x16x32_bf16 v[200:203], v[68:71], v[112:115], v[200:203]
    v_mfma_f32_16x16x32_bf16 v[204:207], v[68:71], v[116:119], v[204:207]
    v_mfma_f32_16x16x32_bf16 v[208:211], v[72:75], v[112:115], v[208:211]
    v_mfma_f32_16x16x32_bf16 v[212:215], v[72:75], v[116:119], v[212:215]
    v_mfma_f32_16x16x32_bf16 v[216:219], v[76:79], v[112:115], v[216:219]
    v_mfma_f32_16x16x32_bf16 v[220:223], v[76:79], v[116:119], v[220:223]
    v_mfma_f32_16x16x32_bf16 v[224:227], v[80:83], v[112:115], v[224:227]
    v_mfma_f32_16x16x32_bf16 v[228:231], v[80:83], v[116:119], v[228:231]
    v_mfma_f32_16x16x32_bf16 v[232:235], v[84:87], v[112:115], v[232:235]
    v_mfma_f32_16x16x32_bf16 v[236:239], v[84:87], v[116:119], v[236:239]
    v_mfma_f32_16x16x32_bf16 v[240:243], v[88:91], v[112:115], v[240:243]
    v_mfma_f32_16x16x32_bf16 v[244:247], v[88:91], v[116:119], v[244:247]
    v_mfma_f32_16x16x32_bf16 v[248:251], v[92:95], v[112:115], v[248:251]
    v_mfma_f32_16x16x32_bf16 v[252:255], v[92:95], v[116:119], v[252:255]
    s_waitcnt vmcnt(0)
    ds_write_b128 v12, a[64:67] offset:33792
    ds_write_b128 v12, a[68:71] offset:38016
    ds_write_b128 v12, a[72:75] offset:42240
    ds_write_b128 v12, a[76:79] offset:46464
    ds_write_b128 v12, a[80:83] offset:50688
    ds_write_b128 v12, a[84:87] offset:54912
    ds_write_b128 v12, a[88:91] offset:59136
    ds_write_b128 v12, a[92:95] offset:63360
    s_waitcnt lgkmcnt(0)
    s_barrier
    s_add_u32 s18, s18, 1
    s_cmp_ge_u32 s18, s12
    s_cbranch_scc1 fdone_37
    s_add_u32 s19, s18, 1
    s_cmp_ge_u32 s19, s12
    s_cbranch_scc1 fnl_42
    s_lshl_b32 s16, s19, 18
    s_add_u32 s16, s16, s7
    s_add_u32 s17, s16, 67108864
    buffer_load_dwordx4 a[64:67], v11, s[48:51], s17 offen
    s_add_u32 s17, s16, 67174400
    buffer_load_dwordx4 a[68:71], v11, s[48:51], s17 offen
    s_add_u32 s17, s16, 67239936
    buffer_load_dwordx4 a[72:75], v11, s[48:51], s17 offen
    s_add_u32 s17, s16, 67305472
    buffer_load_dwordx4 a[76:79], v11, s[48:51], s17 offen
    s_add_u32 s17, s16, 83886080
    buffer_load_dwordx4 a[80:83], v11, s[48:51], s17 offen
    s_add_u32 s17, s16, 83951616
    buffer_load_dwordx4 a[84:87], v11, s[48:51], s17 offen
    s_add_u32 s17, s16, 84017152
    buffer_load_dwordx4 a[88:91], v11, s[48:51], s17 offen
    s_add_u32 s17, s16, 84082688
    buffer_load_dwordx4 a[92:95], v11, s[48:51], s17 offen
fnl_42:
    v_mov_b32 v96, 0
    v_mov_b32 v97, 0
    v_mov_b32 v98, 0
    v_mov_b32 v99, 0
    v_mov_b32 v100, 0
    v_mov_b32 v101, 0
    v_mov_b32 v102, 0
    v_mov_b32 v103, 0
    v_mov_b32 v104, 0
    v_mov_b32 v105, 0
    v_mov_b32 v106, 0
    v_mov_b32 v107, 0
    v_mov_b32 v108, 0
    v_mov_b32 v109, 0
    v_mov_b32 v110, 0
    v_mov_b32 v111, 0
    ds_read_b128 v[32:35], v13 offset:33792
    ds_read_b128 v[36:39], v13 offset:42240
    ds_read_b128 v[40:43], v13 offset:33856
    ds_read_b128 v[44:47], v13 offset:42304
    ds_read_b128 v[48:51], v13 offset:33920
    ds_read_b128 v[52:55], v13 offset:42368
    ds_read_b128 v[56:59], v13 offset:33984
    ds_read_b128 v[60:63], v13 offset:42432
    ds_read_b128 v[64:67], v13 offset:34048
    ds_read_b128 v[68:71], v13 offset:42496
    ds_read_b128 v[72:75], v13 offset:34112
    ds_read_b128 v[76:79], v13 offset:42560
    ds_read_b128 v[80:83], v13 offset:34176
    ds_read_b128 v[84:87], v13 offset:42624
    ds_read_b128 v[88:91], v13 offset:34240
    ds_read_b128 v[92:95], v13 offset:42688
    s_waitcnt lgkmcnt(14)
    v_mfma_f32_16x16x32_bf16 v[96:99], v[32:35], a[0:3], v[96:99]
    v_mfma_f32_16x16x32_bf16 v[100:103], v[32:35], a[32:35], v[100:103]
    v_mfma_f32_16x16x32_bf16 v[104:107], v[36:39], a[0:3], v[104:107]
    v_mfma_f32_16x16x32_bf16 v[108:111], v[36:39], a[32:35], v[108:111]
    s_waitcnt lgkmcnt(12)
    v_mfma_f32_16x16x32_bf16 v[96:99], v[40:43], a[4:7], v[96:99]
    v_mfma_f32_16x16x32_bf16 v[100:103], v[40:43], a[36:39], v[100:103]
    v_mfma_f32_16x16x32_bf16 v[104:107], v[44:47], a[4:7], v[104:107]
    v_mfma_f32_16x16x32_bf16 v[108:111], v[44:47], a[36:39], v[108:111]
    s_waitcnt lgkmcnt(10)
    v_mfma_f32_16x16x32_bf16 v[96:99], v[48:51], a[8:11], v[96:99]
    v_mfma_f32_16x16x32_bf16 v[100:103], v[48:51], a[40:43], v[100:103]
    v_mfma_f32_16x16x32_bf16 v[104:107], v[52:55], a[8:11], v[104:107]
    v_mfma_f32_16x16x32_bf16 v[108:111], v[52:55], a[40:43], v[108:111]
    s_waitcnt lgkmcnt(8)
    v_mfma_f32_16x16x32_bf16 v[96:99], v[56:59], a[12:15], v[96:99]
    v_mfma_f32_16x16x32_bf16 v[100:103], v[56:59], a[44:47], v[100:103]
    v_mfma_f32_16x16x32_bf16 v[104:107], v[60:63], a[12:15], v[104:107]
    v_mfma_f32_16x16x32_bf16 v[108:111], v[60:63], a[44:47], v[108:111]
    s_waitcnt lgkmcnt(6)
    v_mfma_f32_16x16x32_bf16 v[96:99], v[64:67], a[16:19], v[96:99]
    v_mfma_f32_16x16x32_bf16 v[100:103], v[64:67], a[48:51], v[100:103]
    v_mfma_f32_16x16x32_bf16 v[104:107], v[68:71], a[16:19], v[104:107]
    v_mfma_f32_16x16x32_bf16 v[108:111], v[68:71], a[48:51], v[108:111]
    s_waitcnt lgkmcnt(4)
    v_mfma_f32_16x16x32_bf16 v[96:99], v[72:75], a[20:23], v[96:99]
    v_mfma_f32_16x16x32_bf16 v[100:103], v[72:75], a[52:55], v[100:103]
    v_mfma_f32_16x16x32_bf16 v[104:107], v[76:79], a[20:23], v[104:107]
    v_mfma_f32_16x16x32_bf16 v[108:111], v[76:79], a[52:55], v[108:111]
    s_waitcnt lgkmcnt(2)
    v_mfma_f32_16x16x32_bf16 v[96:99], v[80:83], a[24:27], v[96:99]
    v_mfma_f32_16x16x32_bf16 v[100:103], v[80:83], a[56:59], v[100:103]
    v_mfma_f32_16x16x32_bf16 v[104:107], v[84:87], a[24:27], v[104:107]
    v_mfma_f32_16x16x32_bf16 v[108:111], v[84:87], a[56:59], v[108:111]
    s_waitcnt lgkmcnt(0)
    v_mfma_f32_16x16x32_bf16 v[96:99], v[88:91], a[28:31], v[96:99]
    v_mfma_f32_16x16x32_bf16 v[100:103], v[88:91], a[60:63], v[100:103]
    v_mfma_f32_16x16x32_bf16 v[104:107], v[92:95], a[28:31], v[104:107]
    v_mfma_f32_16x16x32_bf16 v[108:111], v[92:95], a[60:63], v[108:111]
    ds_read_b64_tr_b16 v[32:33], v14 offset:33792
    ds_read_b64_tr_b16 v[34:35], v14 offset:42240
    ds_read_b64_tr_b16 v[36:37], v14 offset:33824
    ds_read_b64_tr_b16 v[38:39], v14 offset:42272
    ds_read_b64_tr_b16 v[40:41], v14 offset:33856
    ds_read_b64_tr_b16 v[42:43], v14 offset:42304
    ds_read_b64_tr_b16 v[44:45], v14 offset:33888
    ds_read_b64_tr_b16 v[46:47], v14 offset:42336
    ds_read_b64_tr_b16 v[48:49], v14 offset:33920
    ds_read_b64_tr_b16 v[50:51], v14 offset:42368
    ds_read_b64_tr_b16 v[52:53], v14 offset:33952
    ds_read_b64_tr_b16 v[54:55], v14 offset:42400
    ds_read_b64_tr_b16 v[56:57], v14 offset:33984
    ds_read_b64_tr_b16 v[58:59], v14 offset:42432
    ds_read_b64_tr_b16 v[60:61], v14 offset:34016
    ds_read_b64_tr_b16 v[62:63], v14 offset:42464
    ds_read_b64_tr_b16 v[64:65], v14 offset:34048
    ds_read_b64_tr_b16 v[66:67], v14 offset:42496
    ds_read_b64_tr_b16 v[68:69], v14 offset:34080
    ds_read_b64_tr_b16 v[70:71], v14 offset:42528
    ds_read_b64_tr_b16 v[72:73], v14 offset:34112
    ds_read_b64_tr_b16 v[74:75], v14 offset:42560
    ds_read_b64_tr_b16 v[76:77], v14 offset:34144
    ds_read_b64_tr_b16 v[78:79], v14 offset:42592
    ds_read_b64_tr_b16 v[80:81], v14 offset:34176
    ds_read_b64_tr_b16 v[82:83], v14 offset:42624
    ds_read_b64_tr_b16 v[84:85], v14 offset:34208
    ds_read_b64_tr_b16 v[86:87], v14 offset:42656
    ds_read_b64_tr_b16 v[88:89], v14 offset:34240
    ds_read_b64_tr_b16 v[90:91], v14 offset:42688
    ds_read_b64_tr_b16 v[92:93], v14 offset:34272
    ds_read_b64_tr_b16 v[94:95], v14 offset:42720
    s_nop 7
    s_nop 1
    s_mov_b32 s20, 0x3db8aa3b
    v_cvt_pk_bf16_f32 v124, v96, v97
    v_lshlrev_b32 v96, 16, v124
    v_and_b32 v97, 0xffff0000, v124
    v_cvt_pk_bf16_f32 v124, v98, v99
    v_lshlrev_b32 v98, 16, v124
    v_and_b32 v99, 0xffff0000, v124
    v_cvt_pk_bf16_f32 v124, v100, v101
    v_lshlrev_b32 v100, 16, v124
    v_and_b32 v101, 0xffff0000, v124
    v_cvt_pk_bf16_f32 v124, v102, v103
    v_lshlrev_b32 v102, 16, v124
    v_and_b32 v103, 0xffff0000, v124
    v_cvt_pk_bf16_f32 v124, v104, v105
    v_lshlrev_b32 v104, 16, v124
    v_and_b32 v105, 0xffff0000, v124
    v_cvt_pk_bf16_f32 v124, v106, v107
    v_lshlrev_b32 v106, 16, v124
    v_and_b32 v107, 0xffff0000, v124
    v_cvt_pk_bf16_f32 v124, v108, v109
    v_lshlrev_b32 v108, 16, v124
    v_and_b32 v109, 0xffff0000, v124
    v_cvt_pk_bf16_f32 v124, v110, v111
    v_lshlrev_b32 v110, 16, v124
    v_and_b32 v111, 0xffff0000, v124
    v_mul_f32 v96, s20, v96
    v_mul_f32 v97, s20, v97
    v_mul_f32 v98, s20, v98
    v_mul_f32 v99, s20, v99
    v_mul_f32 v100, s20, v100
    v_mul_f32 v101, s20, v101
    v_mul_f32 v102, s20, v102
    v_mul_f32 v103, s20, v103
    v_mul_f32 v104, s20, v104
    v_mul_f32 v105, s20, v105
    v_mul_f32 v106, s20, v106
    v_mul_f32 v107, s20, v107
    v_mul_f32 v108, s20, v108
    v_mul_f32 v109, s20, v109
    v_mul_f32 v110, s20, v110
    v_mul_f32 v111, s20, v111
    s_cmp_lt_u32 s18, s13
    s_cbranch_scc1 nomask_43
    s_lshl_b32 s21, s18, 5
    v_mov_b32 v125, s15
    s_add_u32 s22, s21, 0
    v_cmp_le_i32 vcc, s22, v15
    s_nop 1
    v_cndmask_b32 v96, v125, v96, vcc
    s_add_u32 s22, s21, 1
    v_cmp_le_i32 vcc, s22, v15
    s_nop 1
    v_cndmask_b32 v97, v125, v97, vcc
    s_add_u32 s22, s21, 2
    v_cmp_le_i32 vcc, s22, v15
    s_nop 1
    v_cndmask_b32 v98, v125, v98, vcc
    s_add_u32 s22, s21, 3
    v_cmp_le_i32 vcc, s22, v15
    s_nop 1
    v_cndmask_b32 v99, v125, v99, vcc
    s_add_u32 s22, s21, -16
    v_cmp_le_i32 vcc, s22, v15
    s_nop 1
    v_cndmask_b32 v100, v125, v100, vcc
    s_add_u32 s22, s21, -15
    v_cmp_le_i32 vcc, s22, v15
    s_nop 1
    v_cndmask_b32 v101, v125, v101, vcc
    s_add_u32 s22, s21, -14
    v_cmp_le_i32 vcc, s22, v15
    s_nop 1
    v_cndmask_b32 v102, v125, v102, vcc
    s_add_u32 s22, s21, -13
    v_cmp_le_i32 vcc, s22, v15
    s_nop 1
    v_cndmask_b32 v103, v125, v103, vcc
    s_add_u32 s22, s21, 16
    v_cmp_le_i32 vcc, s22, v15
    s_nop 1
    v_cndmask_b32 v104, v125, v104, vcc
    s_add_u32 s22, s21, 17
    v_cmp_le_i32 vcc, s22, v15
    s_nop 1
    v_cndmask_b32 v105, v125, v105, vcc
    s_add_u32 s22, s21, 18
    v_cmp_le_i32 vcc, s22, v15
    s_nop 1
    v_cndmask_b32 v106, v125, v106, vcc
    s_add_u32 s22, s21, 19
    v_cmp_le_i32 vcc, s22, v15
    s_nop 1
    v_cndmask_b32 v107, v125, v107, vcc
    s_add_u32 s22, s21, 0
    v_cmp_le_i32 vcc, s22, v15
    s_nop 1
    v_cndmask_b32 v108, v125, v108, vcc
    s_add_u32 s22, s21, 1
    v_cmp_le_i32 vcc, s22, v15
    s_nop 1
    v_cndmask_b32 v109, v125, v109, vcc
    s_add_u32 s22, s21, 2
    v_cmp_le_i32 vcc, s22, v15
    s_nop 1
    v_cndmask_b32 v110, v125, v110, vcc
    s_add_u32 s22, s21, 3
    v_cmp_le_i32 vcc, s22, v15
    s_nop 1
    v_cndmask_b32 v111, v125, v111, vcc
nomask_43:
    v_max3_f32 v126, v96, v97, v98
    v_max3_f32 v126, v126, v99, v104
    v_max3_f32 v126, v126, v105, v106
    v_max_f32 v126, v126, v107
    ds_bpermute_b32 v127, v5, v126
    s_waitcnt lgkmcnt(0)
    v_max_f32 v126, v126, v127
    ds_bpermute_b32 v127, v6, v126
    s_waitcnt lgkmcnt(0)
    v_max_f32 v126, v126, v127
    v_max_f32 v126, v126, v120
    v_sub_f32 v127, v120, v126
    v_exp_f32 v127, v127
    v_mov_b32 v120, v126
    v_sub_f32 v96, v96, v126
    v_exp_f32 v96, v96
    v_sub_f32 v97, v97, v126
    v_exp_f32 v97, v97
    v_sub_f32 v98, v98, v126
    v_exp_f32 v98, v98
    v_sub_f32 v99, v99, v126
    v_exp_f32 v99, v99
    v_sub_f32 v104, v104, v126
    v_exp_f32 v104, v104
    v_sub_f32 v105, v105, v126
    v_exp_f32 v105, v105
    v_sub_f32 v106, v106, v126
    v_exp_f32 v106, v106
    v_sub_f32 v107, v107, v126
    v_exp_f32 v107, v107
    s_nop 0
    v_mul_f32 v122, v122, v127
    v_add_f32 v122, v122, v96
    v_add_f32 v122, v122, v97
    v_add_f32 v122, v122, v98
    v_add_f32 v122, v122, v99
    v_add_f32 v122, v122, v104
    v_add_f32 v122, v122, v105
    v_add_f32 v122, v122, v106
    v_add_f32 v122, v122, v107
    v_cmp_neq_f32 vcc, 1.0, v127
    s_cbranch_vccz nors_44
    v_mul_f32 v128, v128, v127
    v_mul_f32 v129, v129, v127
    v_mul_f32 v130, v130, v127
    v_mul_f32 v131, v131, v127
    v_mul_f32 v136, v136, v127
    v_mul_f32 v137, v137, v127
    v_mul_f32 v138, v138, v127
    v_mul_f32 v139, v139, v127
    v_mul_f32 v144, v144, v127
    v_mul_f32 v145, v145, v127
    v_mul_f32 v146, v146, v127
    v_mul_f32 v147, v147, v127
    v_mul_f32 v152, v152, v127
    v_mul_f32 v153, v153, v127
    v_mul_f32 v154, v154, v127
    v_mul_f32 v155, v155, v127
    v_mul_f32 v160, v160, v127
    v_mul_f32 v161, v161, v127
    v_mul_f32 v162, v162, v127
    v_mul_f32 v163, v163, v127
    v_mul_f32 v168, v168, v127
    v_mul_f32 v169, v169, v127
    v_mul_f32 v170, v170, v127
    v_mul_f32 v171, v171, v127
    v_mul_f32 v176, v176, v127
    v_mul_f32 v177, v177, v127
    v_mul_f32 v178, v178, v127
    v_mul_f32 v179, v179, v127
    v_mul_f32 v184, v184, v127
    v_mul_f32 v185, v185, v127
    v_mul_f32 v186, v186, v127
    v_mul_f32 v187, v187, v127
    v_mul_f32 v192, v192, v127
    v_mul_f32 v193, v193, v127
    v_mul_f32 v194, v194, v127
    v_mul_f32 v195, v195, v127
    v_mul_f32 v200, v200, v127
    v_mul_f32 v201, v201, v127
    v_mul_f32 v202, v202, v127
    v_mul_f32 v203, v203, v127
    v_mul_f32 v208, v208, v127
    v_mul_f32 v209, v209, v127
    v_mul_f32 v210, v210, v127
    v_mul_f32 v211, v211, v127
    v_mul_f32 v216, v216, v127
    v_mul_f32 v217, v217, v127
    v_mul_f32 v218, v218, v127
    v_mul_f32 v219, v219, v127
    v_mul_f32 v224, v224, v127
    v_mul_f32 v225, v225, v127
    v_mul_f32 v226, v226, v127
    v_mul_f32 v227, v227, v127
    v_mul_f32 v232, v232, v127
    v_mul_f32 v233, v233, v127
    v_mul_f32 v234, v234, v127
    v_mul_f32 v235, v235, v127
    v_mul_f32 v240, v240, v127
    v_mul_f32 v241, v241, v127
    v_mul_f32 v242, v242, v127
    v_mul_f32 v243, v243, v127
    v_mul_f32 v248, v248, v127
    v_mul_f32 v249, v249, v127
    v_mul_f32 v250, v250, v127
    v_mul_f32 v251, v251, v127
nors_44:
    v_cvt_pk_bf16_f32 v112, v96, v97
    v_cvt_pk_bf16_f32 v113, v98, v99
    v_cvt_pk_bf16_f32 v114, v104, v105
    v_cvt_pk_bf16_f32 v115, v106, v107
    v_max3_f32 v126, v100, v101, v102
    v_max3_f32 v126, v126, v103, v108
    v_max3_f32 v126, v126, v109, v110
    v_max_f32 v126, v126, v111
    ds_bpermute_b32 v127, v5, v126
    s_waitcnt lgkmcnt(0)
    v_max_f32 v126, v126, v127
    ds_bpermute_b32 v127, v6, v126
    s_waitcnt lgkmcnt(0)
    v_max_f32 v126, v126, v127
    v_max_f32 v126, v126, v121
    v_sub_f32 v127, v121, v126
    v_exp_f32 v127, v127
    v_mov_b32 v121, v126
    v_sub_f32 v100, v100, v126
    v_exp_f32 v100, v100
    v_sub_f32 v101, v101, v126
    v_exp_f32 v101, v101
    v_sub_f32 v102, v102, v126
    v_exp_f32 v102, v102
    v_sub_f32 v103, v103, v126
    v_exp_f32 v103, v103
    v_sub_f32 v108, v108, v126
    v_exp_f32 v108, v108
    v_sub_f32 v109, v109, v126
    v_exp_f32 v109, v109
    v_sub_f32 v110, v110, v126
    v_exp_f32 v110, v110
    v_sub_f32 v111, v111, v126
    v_exp_f32 v111, v111
    s_nop 0
    v_mul_f32 v123, v123, v127
    v_add_f32 v123, v123, v100
    v_add_f32 v123, v123, v101
    v_add_f32 v123, v123, v102
    v_add_f32 v123, v123, v103
    v_add_f32 v123, v123, v108
    v_add_f32 v123, v123, v109
    v_add_f32 v123, v123, v110
    v_add_f32 v123, v123, v111
    v_cmp_neq_f32 vcc, 1.0, v127
    s_cbranch_vccz nors_45
    v_mul_f32 v132, v132, v127
    v_mul_f32 v133, v133, v127
    v_mul_f32 v134, v134, v127
    v_mul_f32 v135, v135, v127
    v_mul_f32 v140, v140, v127
    v_mul_f32 v141, v141, v127
    v_mul_f32 v142, v142, v127
    v_mul_f32 v143, v143, v127
    v_mul_f32 v148, v148, v127
    v_mul_f32 v149, v149, v127
    v_mul_f32 v150, v150, v127
    v_mul_f32 v151, v151, v127
    v_mul_f32 v156, v156, v127
    v_mul_f32 v157, v157, v127
    v_mul_f32 v158, v158, v127
    v_mul_f32 v159, v159, v127
    v_mul_f32 v164, v164, v127
    v_mul_f32 v165, v165, v127
    v_mul_f32 v166, v166, v127
    v_mul_f32 v167, v167, v127
    v_mul_f32 v172, v172, v127
    v_mul_f32 v173, v173, v127
    v_mul_f32 v174, v174, v127
    v_mul_f32 v175, v175, v127
    v_mul_f32 v180, v180, v127
    v_mul_f32 v181, v181, v127
    v_mul_f32 v182, v182, v127
    v_mul_f32 v183, v183, v127
    v_mul_f32 v188, v188, v127
    v_mul_f32 v189, v189, v127
    v_mul_f32 v190, v190, v127
    v_mul_f32 v191, v191, v127
    v_mul_f32 v196, v196, v127
    v_mul_f32 v197, v197, v127
    v_mul_f32 v198, v198, v127
    v_mul_f32 v199, v199, v127
    v_mul_f32 v204, v204, v127
    v_mul_f32 v205, v205, v127
    v_mul_f32 v206, v206, v127
    v_mul_f32 v207, v207, v127
    v_mul_f32 v212, v212, v127
    v_mul_f32 v213, v213, v127
    v_mul_f32 v214, v214, v127
    v_mul_f32 v215, v215, v127
    v_mul_f32 v220, v220, v127
    v_mul_f32 v221, v221, v127
    v_mul_f32 v222, v222, v127
    v_mul_f32 v223, v223, v127
    v_mul_f32 v228, v228, v127
    v_mul_f32 v229, v229, v127
    v_mul_f32 v230, v230, v127
    v_mul_f32 v231, v231, v127
    v_mul_f32 v236, v236, v127
    v_mul_f32 v237, v237, v127
    v_mul_f32 v238, v238, v127
    v_mul_f32 v239, v239, v127
    v_mul_f32 v244, v244, v127
    v_mul_f32 v245, v245, v127
    v_mul_f32 v246, v246, v127
    v_mul_f32 v247, v247, v127
    v_mul_f32 v252, v252, v127
    v_mul_f32 v253, v253, v127
    v_mul_f32 v254, v254, v127
    v_mul_f32 v255, v255, v127
nors_45:
    v_cvt_pk_bf16_f32 v116, v100, v101
    v_cvt_pk_bf16_f32 v117, v102, v103
    v_cvt_pk_bf16_f32 v118, v108, v109
    v_cvt_pk_bf16_f32 v119, v110, v111
    s_waitcnt lgkmcnt(0)
    v_mfma_f32_16x16x32_bf16 v[128:131], v[32:35], v[112:115], v[128:131]
    v_mfma_f32_16x16x32_bf16 v[132:135], v[32:35], v[116:119], v[132:135]
    v_mfma_f32_16x16x32_bf16 v[136:139], v[36:39], v[112:115], v[136:139]
    v_mfma_f32_16x16x32_bf16 v[140:143], v[36:39], v[116:119], v[140:143]
    v_mfma_f32_16x16x32_bf16 v[144:147], v[40:43], v[112:115], v[144:147]
    v_mfma_f32_16x16x32_bf16 v[148:151], v[40:43], v[116:119], v[148:151]
    v_mfma_f32_16x16x32_bf16 v[152:155], v[44:47], v[112:115], v[152:155]
    v_mfma_f32_16x16x32_bf16 v[156:159], v[44:47], v[116:119], v[156:159]
    v_mfma_f32_16x16x32_bf16 v[160:163], v[48:51], v[112:115], v[160:163]
    v_mfma_f32_16x16x32_bf16 v[164:167], v[48:51], v[116:119], v[164:167]
    v_mfma_f32_16x16x32_bf16 v[168:171], v[52:55], v[112:115], v[168:171]
    v_mfma_f32_16x16x32_bf16 v[172:175], v[52:55], v[116:119], v[172:175]
    v_mfma_f32_16x16x32_bf16 v[176:179], v[56:59], v[112:115], v[176:179]
    v_mfma_f32_16x16x32_bf16 v[180:183], v[56:59], v[116:119], v[180:183]
    v_mfma_f32_16x16x32_bf16 v[184:187], v[60:63], v[112:115], v[184:187]
    v_mfma_f32_16x16x32_bf16 v[188:191], v[60:63], v[116:119], v[188:191]
    v_mfma_f32_16x16x32_bf16 v[192:195], v[64:67], v[112:115], v[192:195]
    v_mfma_f32_16x16x32_bf16 v[196:199], v[64:67], v[116:119], v[196:199]
    v_mfma_f32_16x16x32_bf16 v[200:203], v[68:71], v[112:115], v[200:203]
    v_mfma_f32_16x16x32_bf16 v[204:207], v[68:71], v[116:119], v[204:207]
    v_mfma_f32_16x16x32_bf16 v[208:211], v[72:75], v[112:115], v[208:211]
    v_mfma_f32_16x16x32_bf16 v[212:215], v[72:75], v[116:119], v[212:215]
    v_mfma_f32_16x16x32_bf16 v[216:219], v[76:79], v[112:115], v[216:219]
    v_mfma_f32_16x16x32_bf16 v[220:223], v[76:79], v[116:119], v[220:223]
    v_mfma_f32_16x16x32_bf16 v[224:227], v[80:83], v[112:115], v[224:227]
    v_mfma_f32_16x16x32_bf16 v[228:231], v[80:83], v[116:119], v[228:231]
    v_mfma_f32_16x16x32_bf16 v[232:235], v[84:87], v[112:115], v[232:235]
    v_mfma_f32_16x16x32_bf16 v[236:239], v[84:87], v[116:119], v[236:239]
    v_mfma_f32_16x16x32_bf16 v[240:243], v[88:91], v[112:115], v[240:243]
    v_mfma_f32_16x16x32_bf16 v[244:247], v[88:91], v[116:119], v[244:247]
    v_mfma_f32_16x16x32_bf16 v[248:251], v[92:95], v[112:115], v[248:251]
    v_mfma_f32_16x16x32_bf16 v[252:255], v[92:95], v[116:119], v[252:255]
    s_waitcnt vmcnt(0)
    ds_write_b128 v12, a[64:67] offset:0
    ds_write_b128 v12, a[68:71] offset:4224
    ds_write_b128 v12, a[72:75] offset:8448
    ds_write_b128 v12, a[76:79] offset:12672
    ds_write_b128 v12, a[80:83] offset:16896
    ds_write_b128 v12, a[84:87] offset:21120
    ds_write_b128 v12, a[88:91] offset:25344
    ds_write_b128 v12, a[92:95] offset:29568
    s_waitcnt lgkmcnt(0)
    s_barrier
    s_add_u32 s18, s18, 1
    s_cmp_ge_u32 s18, s12
    s_cbranch_scc1 fdone_37
    s_branch fl_36
fdone_37:
    s_nop 7
    s_nop 1
    v_lshlrev_b32 v19, 13, v3
    v_lshlrev_b32 v20, 3, v4
    v_add_u32 v19, v19, v20
    ds_bpermute_b32 v36, v5, v122
    s_waitcnt lgkmcnt(0)
    v_add_f32 v122, v122, v36
    ds_bpermute_b32 v36, v6, v122
    s_waitcnt lgkmcnt(0)
    v_add_f32 v122, v122, v36
    v_rcp_f32 v122, v122
    s_nop 0
    s_add_u32 s14, s8, 117440512
    v_mul_f32 v128, v128, v122
    v_mul_f32 v129, v129, v122
    v_mul_f32 v130, v130, v122
    v_mul_f32 v131, v131, v122
    v_cvt_pk_bf16_f32 v56, v128, v129
    v_cvt_pk_bf16_f32 v57, v130, v131
    buffer_store_dwordx2 v[56:57], v19, s[48:51], s14 offen offset:0
    s_nop 0
    v_mul_f32 v136, v136, v122
    v_mul_f32 v137, v137, v122
    v_mul_f32 v138, v138, v122
    v_mul_f32 v139, v139, v122
    v_cvt_pk_bf16_f32 v56, v136, v137
    v_cvt_pk_bf16_f32 v57, v138, v139
    buffer_store_dwordx2 v[56:57], v19, s[48:51], s14 offen offset:32
    s_nop 0
    v_mul_f32 v144, v144, v122
    v_mul_f32 v145, v145, v122
    v_mul_f32 v146, v146, v122
    v_mul_f32 v147, v147, v122
    v_cvt_pk_bf16_f32 v56, v144, v145
    v_cvt_pk_bf16_f32 v57, v146, v147
    buffer_store_dwordx2 v[56:57], v19, s[48:51], s14 offen offset:64
    s_nop 0
    v_mul_f32 v152, v152, v122
    v_mul_f32 v153, v153, v122
    v_mul_f32 v154, v154, v122
    v_mul_f32 v155, v155, v122
    v_cvt_pk_bf16_f32 v56, v152, v153
    v_cvt_pk_bf16_f32 v57, v154, v155
    buffer_store_dwordx2 v[56:57], v19, s[48:51], s14 offen offset:96
    s_nop 0
    v_mul_f32 v160, v160, v122
    v_mul_f32 v161, v161, v122
    v_mul_f32 v162, v162, v122
    v_mul_f32 v163, v163, v122
    v_cvt_pk_bf16_f32 v56, v160, v161
    v_cvt_pk_bf16_f32 v57, v162, v163
    buffer_store_dwordx2 v[56:57], v19, s[48:51], s14 offen offset:128
    s_nop 0
    v_mul_f32 v168, v168, v122
    v_mul_f32 v169, v169, v122
    v_mul_f32 v170, v170, v122
    v_mul_f32 v171, v171, v122
    v_cvt_pk_bf16_f32 v56, v168, v169
    v_cvt_pk_bf16_f32 v57, v170, v171
    buffer_store_dwordx2 v[56:57], v19, s[48:51], s14 offen offset:160
    s_nop 0
    v_mul_f32 v176, v176, v122
    v_mul_f32 v177, v177, v122
    v_mul_f32 v178, v178, v122
    v_mul_f32 v179, v179, v122
    v_cvt_pk_bf16_f32 v56, v176, v177
    v_cvt_pk_bf16_f32 v57, v178, v179
    buffer_store_dwordx2 v[56:57], v19, s[48:51], s14 offen offset:192
    s_nop 0
    v_mul_f32 v184, v184, v122
    v_mul_f32 v185, v185, v122
    v_mul_f32 v186, v186, v122
    v_mul_f32 v187, v187, v122
    v_cvt_pk_bf16_f32 v56, v184, v185
    v_cvt_pk_bf16_f32 v57, v186, v187
    buffer_store_dwordx2 v[56:57], v19, s[48:51], s14 offen offset:224
    s_nop 0
    v_mul_f32 v192, v192, v122
    v_mul_f32 v193, v193, v122
    v_mul_f32 v194, v194, v122
    v_mul_f32 v195, v195, v122
    v_cvt_pk_bf16_f32 v56, v192, v193
    v_cvt_pk_bf16_f32 v57, v194, v195
    buffer_store_dwordx2 v[56:57], v19, s[48:51], s14 offen offset:256
    s_nop 0
    v_mul_f32 v200, v200, v122
    v_mul_f32 v201, v201, v122
    v_mul_f32 v202, v202, v122
    v_mul_f32 v203, v203, v122
    v_cvt_pk_bf16_f32 v56, v200, v201
    v_cvt_pk_bf16_f32 v57, v202, v203
    buffer_store_dwordx2 v[56:57], v19, s[48:51], s14 offen offset:288
    s_nop 0
    v_mul_f32 v208, v208, v122
    v_mul_f32 v209, v209, v122
    v_mul_f32 v210, v210, v122
    v_mul_f32 v211, v211, v122
    v_cvt_pk_bf16_f32 v56, v208, v209
    v_cvt_pk_bf16_f32 v57, v210, v211
    buffer_store_dwordx2 v[56:57], v19, s[48:51], s14 offen offset:320
    s_nop 0
    v_mul_f32 v216, v216, v122
    v_mul_f32 v217, v217, v122
    v_mul_f32 v218, v218, v122
    v_mul_f32 v219, v219, v122
    v_cvt_pk_bf16_f32 v56, v216, v217
    v_cvt_pk_bf16_f32 v57, v218, v219
    buffer_store_dwordx2 v[56:57], v19, s[48:51], s14 offen offset:352
    s_nop 0
    v_mul_f32 v224, v224, v122
    v_mul_f32 v225, v225, v122
    v_mul_f32 v226, v226, v122
    v_mul_f32 v227, v227, v122
    v_cvt_pk_bf16_f32 v56, v224, v225
    v_cvt_pk_bf16_f32 v57, v226, v227
    buffer_store_dwordx2 v[56:57], v19, s[48:51], s14 offen offset:384
    s_nop 0
    v_mul_f32 v232, v232, v122
    v_mul_f32 v233, v233, v122
    v_mul_f32 v234, v234, v122
    v_mul_f32 v235, v235, v122
    v_cvt_pk_bf16_f32 v56, v232, v233
    v_cvt_pk_bf16_f32 v57, v234, v235
    buffer_store_dwordx2 v[56:57], v19, s[48:51], s14 offen offset:416
    s_nop 0
    v_mul_f32 v240, v240, v122
    v_mul_f32 v241, v241, v122
    v_mul_f32 v242, v242, v122
    v_mul_f32 v243, v243, v122
    v_cvt_pk_bf16_f32 v56, v240, v241
    v_cvt_pk_bf16_f32 v57, v242, v243
    buffer_store_dwordx2 v[56:57], v19, s[48:51], s14 offen offset:448
    s_nop 0
    v_mul_f32 v248, v248, v122
    v_mul_f32 v249, v249, v122
    v_mul_f32 v250, v250, v122
    v_mul_f32 v251, v251, v122
    v_cvt_pk_bf16_f32 v56, v248, v249
    v_cvt_pk_bf16_f32 v57, v250, v251
    buffer_store_dwordx2 v[56:57], v19, s[48:51], s14 offen offset:480
    s_nop 0
    ds_bpermute_b32 v36, v5, v123
    s_waitcnt lgkmcnt(0)
    v_add_f32 v123, v123, v36
    ds_bpermute_b32 v36, v6, v123
    s_waitcnt lgkmcnt(0)
    v_add_f32 v123, v123, v36
    v_rcp_f32 v123, v123
    s_nop 0
    s_add_u32 s14, s8, 117571584
    v_mul_f32 v132, v132, v123
    v_mul_f32 v133, v133, v123
    v_mul_f32 v134, v134, v123
    v_mul_f32 v135, v135, v123
    v_cvt_pk_bf16_f32 v56, v132, v133
    v_cvt_pk_bf16_f32 v57, v134, v135
    buffer_store_dwordx2 v[56:57], v19, s[48:51], s14 offen offset:0
    s_nop 0
    v_mul_f32 v140, v140, v123
    v_mul_f32 v141, v141, v123
    v_mul_f32 v142, v142, v123
    v_mul_f32 v143, v143, v123
    v_cvt_pk_bf16_f32 v56, v140, v141
    v_cvt_pk_bf16_f32 v57, v142, v143
    buffer_store_dwordx2 v[56:57], v19, s[48:51], s14 offen offset:32
    s_nop 0
    v_mul_f32 v148, v148, v123
    v_mul_f32 v149, v149, v123
    v_mul_f32 v150, v150, v123
    v_mul_f32 v151, v151, v123
    v_cvt_pk_bf16_f32 v56, v148, v149
    v_cvt_pk_bf16_f32 v57, v150, v151
    buffer_store_dwordx2 v[56:57], v19, s[48:51], s14 offen offset:64
    s_nop 0
    v_mul_f32 v156, v156, v123
    v_mul_f32 v157, v157, v123
    v_mul_f32 v158, v158, v123
    v_mul_f32 v159, v159, v123
    v_cvt_pk_bf16_f32 v56, v156, v157
    v_cvt_pk_bf16_f32 v57, v158, v159
    buffer_store_dwordx2 v[56:57], v19, s[48:51], s14 offen offset:96
    s_nop 0
    v_mul_f32 v164, v164, v123
    v_mul_f32 v165, v165, v123
    v_mul_f32 v166, v166, v123
    v_mul_f32 v167, v167, v123
    v_cvt_pk_bf16_f32 v56, v164, v165
    v_cvt_pk_bf16_f32 v57, v166, v167
    buffer_store_dwordx2 v[56:57], v19, s[48:51], s14 offen offset:128
    s_nop 0
    v_mul_f32 v172, v172, v123
    v_mul_f32 v173, v173, v123
    v_mul_f32 v174, v174, v123
    v_mul_f32 v175, v175, v123
    v_cvt_pk_bf16_f32 v56, v172, v173
    v_cvt_pk_bf16_f32 v57, v174, v175
    buffer_store_dwordx2 v[56:57], v19, s[48:51], s14 offen offset:160
    s_nop 0
    v_mul_f32 v180, v180, v123
    v_mul_f32 v181, v181, v123
    v_mul_f32 v182, v182, v123
    v_mul_f32 v183, v183, v123
    v_cvt_pk_bf16_f32 v56, v180, v181
    v_cvt_pk_bf16_f32 v57, v182, v183
    buffer_store_dwordx2 v[56:57], v19, s[48:51], s14 offen offset:192
    s_nop 0
    v_mul_f32 v188, v188, v123
    v_mul_f32 v189, v189, v123
    v_mul_f32 v190, v190, v123
    v_mul_f32 v191, v191, v123
    v_cvt_pk_bf16_f32 v56, v188, v189
    v_cvt_pk_bf16_f32 v57, v190, v191
    buffer_store_dwordx2 v[56:57], v19, s[48:51], s14 offen offset:224
    s_nop 0
    v_mul_f32 v196, v196, v123
    v_mul_f32 v197, v197, v123
    v_mul_f32 v198, v198, v123
    v_mul_f32 v199, v199, v123
    v_cvt_pk_bf16_f32 v56, v196, v197
    v_cvt_pk_bf16_f32 v57, v198, v199
    buffer_store_dwordx2 v[56:57], v19, s[48:51], s14 offen offset:256
    s_nop 0
    v_mul_f32 v204, v204, v123
    v_mul_f32 v205, v205, v123
    v_mul_f32 v206, v206, v123
    v_mul_f32 v207, v207, v123
    v_cvt_pk_bf16_f32 v56, v204, v205
    v_cvt_pk_bf16_f32 v57, v206, v207
    buffer_store_dwordx2 v[56:57], v19, s[48:51], s14 offen offset:288
    s_nop 0
    v_mul_f32 v212, v212, v123
    v_mul_f32 v213, v213, v123
    v_mul_f32 v214, v214, v123
    v_mul_f32 v215, v215, v123
    v_cvt_pk_bf16_f32 v56, v212, v213
    v_cvt_pk_bf16_f32 v57, v214, v215
    buffer_store_dwordx2 v[56:57], v19, s[48:51], s14 offen offset:320
    s_nop 0
    v_mul_f32 v220, v220, v123
    v_mul_f32 v221, v221, v123
    v_mul_f32 v222, v222, v123
    v_mul_f32 v223, v223, v123
    v_cvt_pk_bf16_f32 v56, v220, v221
    v_cvt_pk_bf16_f32 v57, v222, v223
    buffer_store_dwordx2 v[56:57], v19, s[48:51], s14 offen offset:352
    s_nop 0
    v_mul_f32 v228, v228, v123
    v_mul_f32 v229, v229, v123
    v_mul_f32 v230, v230, v123
    v_mul_f32 v231, v231, v123
    v_cvt_pk_bf16_f32 v56, v228, v229
    v_cvt_pk_bf16_f32 v57, v230, v231
    buffer_store_dwordx2 v[56:57], v19, s[48:51], s14 offen offset:384
    s_nop 0
    v_mul_f32 v236, v236, v123
    v_mul_f32 v237, v237, v123
    v_mul_f32 v238, v238, v123
    v_mul_f32 v239, v239, v123
    v_cvt_pk_bf16_f32 v56, v236, v237
    v_cvt_pk_bf16_f32 v57, v238, v239
    buffer_store_dwordx2 v[56:57], v19, s[48:51], s14 offen offset:416
    s_nop 0
    v_mul_f32 v244, v244, v123
    v_mul_f32 v245, v245, v123
    v_mul_f32 v246, v246, v123
    v_mul_f32 v247, v247, v123
    v_cvt_pk_bf16_f32 v56, v244, v245
    v_cvt_pk_bf16_f32 v57, v246, v247
    buffer_store_dwordx2 v[56:57], v19, s[48:51], s14 offen offset:448
    s_nop 0
    v_mul_f32 v252, v252, v123
    v_mul_f32 v253, v253, v123
    v_mul_f32 v254, v254, v123
    v_mul_f32 v255, v255, v123
    v_cvt_pk_bf16_f32 v56, v252, v253
    v_cvt_pk_bf16_f32 v57, v254, v255
    buffer_store_dwordx2 v[56:57], v19, s[48:51], s14 offen offset:480
    s_nop 0
    s_cmp_lt_u32 s82, 168
    s_cbranch_scc1 L_k2_f2
    s_barrier
    s_sub_u32 s83, 423, s82
    v_and_b32 v1, 63, v0
    v_lshrrev_b32 v2, 6, v0
    s_nop 1
    v_readfirstlane_b32 s3, v2
    v_and_b32 v3, 15, v1
    v_lshrrev_b32 v4, 4, v1
    s_lshr_b32 s4, s83, 4
    s_sub_u32 s4, 15, s4
    s_and_b32 s6, s83, 15
    s_lshl_b32 s7, s6, 9
    v_xor_b32 v5, 16, v1
    v_lshlrev_b32 v5, 2, v5
    v_xor_b32 v6, 32, v1
    v_lshlrev_b32 v6, 2, v6
    v_lshlrev_b32 v7, 13, v3
    v_lshlrev_b32 v8, 4, v4
    v_add_u32 v7, v7, v8
    s_lshl_b32 s8, s4, 20
    s_lshl_b32 s9, s3, 18
    s_add_u32 s8, s8, s9
    s_add_u32 s8, s8, s7
    v_lshrrev_b32 v9, 5, v0
    v_and_b32 v10, 31, v0
    v_lshlrev_b32 v10, 4, v10
    v_lshlrev_b32 v11, 13, v9
    v_add_u32 v11, v11, v10
    v_mul_u32_u24 v12, 528, v9
    v_add_u32 v12, v12, v10
    v_mul_u32_u24 v13, 528, v3
    v_add_u32 v13, v13, v8
    v_lshlrev_b32 v17, 2, v4
    v_lshrrev_b32 v14, 2, v3
    v_add_u32 v14, v14, v17
    v_mul_u32_u24 v14, 528, v14
    v_and_b32 v15, 3, v3
    v_lshlrev_b32 v15, 3, v15
    v_add_u32 v14, v14, v15
    v_add_u32 v14, 16896, v14
    s_lshl_b32 s10, s4, 7
    s_lshl_b32 s11, s3, 5
    s_add_u32 s10, s10, s11
    v_add_u32 v15, s10, v3
    v_sub_u32 v15, v15, v17
    s_add_u32 s12, s4, 1
    s_lshl_b32 s12, s12, 2
    s_lshl_b32 s13, s4, 2
    s_add_u32 s14, s8, 50331648
    buffer_load_dwordx4 v[64:67], v7, s[48:51], s14 offen offset:0
    buffer_load_dwordx4 v[68:71], v7, s[48:51], s14 offen offset:64
    buffer_load_dwordx4 v[72:75], v7, s[48:51], s14 offen offset:128
    buffer_load_dwordx4 v[76:79], v7, s[48:51], s14 offen offset:192
    buffer_load_dwordx4 v[80:83], v7, s[48:51], s14 offen offset:256
    buffer_load_dwordx4 v[84:87], v7, s[48:51], s14 offen offset:320
    buffer_load_dwordx4 v[88:91], v7, s[48:51], s14 offen offset:384
    buffer_load_dwordx4 v[92:95], v7, s[48:51], s14 offen offset:448
    s_waitcnt vmcnt(0)
    v_accvgpr_write_b32 a0, v64
    v_accvgpr_write_b32 a1, v65
    v_accvgpr_write_b32 a2, v66
    v_accvgpr_write_b32 a3, v67
    v_accvgpr_write_b32 a4, v68
    v_accvgpr_write_b32 a5, v69
    v_accvgpr_write_b32 a6, v70
    v_accvgpr_write_b32 a7, v71
    v_accvgpr_write_b32 a8, v72
    v_accvgpr_write_b32 a9, v73
    v_accvgpr_write_b32 a10, v74
    v_accvgpr_write_b32 a11, v75
    v_accvgpr_write_b32 a12, v76
    v_accvgpr_write_b32 a13, v77
    v_accvgpr_write_b32 a14, v78
    v_accvgpr_write_b32 a15, v79
    v_accvgpr_write_b32 a16, v80
    v_accvgpr_write_b32 a17, v81
    v_accvgpr_write_b32 a18, v82
    v_accvgpr_write_b32 a19, v83
    v_accvgpr_write_b32 a20, v84
    v_accvgpr_write_b32 a21, v85
    v_accvgpr_write_b32 a22, v86
    v_accvgpr_write_b32 a23, v87
    v_accvgpr_write_b32 a24, v88
    v_accvgpr_write_b32 a25, v89
    v_accvgpr_write_b32 a26, v90
    v_accvgpr_write_b32 a27, v91
    v_accvgpr_write_b32 a28, v92
    v_accvgpr_write_b32 a29, v93
    v_accvgpr_write_b32 a30, v94
    v_accvgpr_write_b32 a31, v95
    s_add_u32 s14, s8, 50462720
    buffer_load_dwordx4 v[64:67], v7, s[48:51], s14 offen offset:0
    buffer_load_dwordx4 v[68:71], v7, s[48:51], s14 offen offset:64
    buffer_load_dwordx4 v[72:75], v7, s[48:51], s14 offen offset:128
    buffer_load_dwordx4 v[76:79], v7, s[48:51], s14 offen offset:192
    buffer_load_dwordx4 v[80:83], v7, s[48:51], s14 offen offset:256
    buffer_load_dwordx4 v[84:87], v7, s[48:51], s14 offen offset:320
    buffer_load_dwordx4 v[88:91], v7, s[48:51], s14 offen offset:384
    buffer_load_dwordx4 v[92:95], v7, s[48:51], s14 offen offset:448
    s_waitcnt vmcnt(0)
    v_accvgpr_write_b32 a32, v64
    v_accvgpr_write_b32 a33, v65
    v_accvgpr_write_b32 a34, v66
    v_accvgpr_write_b32 a35, v67
    v_accvgpr_write_b32 a36, v68
    v_accvgpr_write_b32 a37, v69
    v_accvgpr_write_b32 a38, v70
    v_accvgpr_write_b32 a39, v71
    v_accvgpr_write_b32 a40, v72
    v_accvgpr_write_b32 a41, v73
    v_accvgpr_write_b32 a42, v74
    v_accvgpr_write_b32 a43, v75
    v_accvgpr_write_b32 a44, v76
    v_accvgpr_write_b32 a45, v77
    v_accvgpr_write_b32 a46, v78
    v_accvgpr_write_b32 a47, v79
    v_accvgpr_write_b32 a48, v80
    v_accvgpr_write_b32 a49, v81
    v_accvgpr_write_b32 a50, v82
    v_accvgpr_write_b32 a51, v83
    v_accvgpr_write_b32 a52, v84
    v_accvgpr_write_b32 a53, v85
    v_accvgpr_write_b32 a54, v86
    v_accvgpr_write_b32 a55, v87
    v_accvgpr_write_b32 a56, v88
    v_accvgpr_write_b32 a57, v89
    v_accvgpr_write_b32 a58, v90
    v_accvgpr_write_b32 a59, v91
    v_accvgpr_write_b32 a60, v92
    v_accvgpr_write_b32 a61, v93
    v_accvgpr_write_b32 a62, v94
    v_accvgpr_write_b32 a63, v95
    v_mov_b32 v128, 0
    v_mov_b32 v129, 0
    v_mov_b32 v130, 0
    v_mov_b32 v131, 0
    v_mov_b32 v132, 0
    v_mov_b32 v133, 0
    v_mov_b32 v134, 0
    v_mov_b32 v135, 0
    v_mov_b32 v136, 0
    v_mov_b32 v137, 0
    v_mov_b32 v138, 0
    v_mov_b32 v139, 0
    v_mov_b32 v140, 0
    v_mov_b32 v141, 0
    v_mov_b32 v142, 0
    v_mov_b32 v143, 0
    v_mov_b32 v144, 0
    v_mov_b32 v145, 0
    v_mov_b32 v146, 0
    v_mov_b32 v147, 0
    v_mov_b32 v148, 0
    v_mov_b32 v149, 0
    v_mov_b32 v150, 0
    v_mov_b32 v151, 0
    v_mov_b32 v152, 0
    v_mov_b32 v153, 0
    v_mov_b32 v154, 0
    v_mov_b32 v155, 0
    v_mov_b32 v156, 0
    v_mov_b32 v157, 0
    v_mov_b32 v158, 0
    v_mov_b32 v159, 0
    v_mov_b32 v160, 0
    v_mov_b32 v161, 0
    v_mov_b32 v162, 0
    v_mov_b32 v163, 0
    v_mov_b32 v164, 0
    v_mov_b32 v165, 0
    v_mov_b32 v166, 0
    v_mov_b32 v167, 0
    v_mov_b32 v168, 0
    v_mov_b32 v169, 0
    v_mov_b32 v170, 0
    v_mov_b32 v171, 0
    v_mov_b32 v172, 0
    v_mov_b32 v173, 0
    v_mov_b32 v174, 0
    v_mov_b32 v175, 0
    v_mov_b32 v176, 0
    v_mov_b32 v177, 0
    v_mov_b32 v178, 0
    v_mov_b32 v179, 0
    v_mov_b32 v180, 0
    v_mov_b32 v181, 0
    v_mov_b32 v182, 0
    v_mov_b32 v183, 0
    v_mov_b32 v184, 0
    v_mov_b32 v185, 0
    v_mov_b32 v186, 0
    v_mov_b32 v187, 0
    v_mov_b32 v188, 0
    v_mov_b32 v189, 0
    v_mov_b32 v190, 0
    v_mov_b32 v191, 0
    v_mov_b32 v192, 0
    v_mov_b32 v193, 0
    v_mov_b32 v194, 0
    v_mov_b32 v195, 0
    v_mov_b32 v196, 0
    v_mov_b32 v197, 0
    v_mov_b32 v198, 0
    v_mov_b32 v199, 0
    v_mov_b32 v200, 0
    v_mov_b32 v201, 0
    v_mov_b32 v202, 0
    v_mov_b32 v203, 0
    v_mov_b32 v204, 0
    v_mov_b32 v205, 0
    v_mov_b32 v206, 0
    v_mov_b32 v207, 0
    v_mov_b32 v208, 0
    v_mov_b32 v209, 0
    v_mov_b32 v210, 0
    v_mov_b32 v211, 0
    v_mov_b32 v212, 0
    v_mov_b32 v213, 0
    v_mov_b32 v214, 0
    v_mov_b32 v215, 0
    v_mov_b32 v216, 0
    v_mov_b32 v217, 0
    v_mov_b32 v218, 0
    v_mov_b32 v219, 0
    v_mov_b32 v220, 0
    v_mov_b32 v221, 0
    v_mov_b32 v222, 0
    v_mov_b32 v223, 0
    v_mov_b32 v224, 0
    v_mov_b32 v225, 0
    v_mov_b32 v226, 0
    v_mov_b32 v227, 0
    v_mov_b32 v228, 0
    v_mov_b32 v229, 0
    v_mov_b32 v230, 0
    v_mov_b32 v231, 0
    v_mov_b32 v232, 0
    v_mov_b32 v233, 0
    v_mov_b32 v234, 0
    v_mov_b32 v235, 0
    v_mov_b32 v236, 0
    v_mov_b32 v237, 0
    v_mov_b32 v238, 0
    v_mov_b32 v239, 0
    v_mov_b32 v240, 0
    v_mov_b32 v241, 0
    v_mov_b32 v242, 0
    v_mov_b32 v243, 0
    v_mov_b32 v244, 0
    v_mov_b32 v245, 0
    v_mov_b32 v246, 0
    v_mov_b32 v247, 0
    v_mov_b32 v248, 0
    v_mov_b32 v249, 0
    v_mov_b32 v250, 0
    v_mov_b32 v251, 0
    v_mov_b32 v252, 0
    v_mov_b32 v253, 0
    v_mov_b32 v254, 0
    v_mov_b32 v255, 0
    s_mov_b32 s15, 0xff800000
    v_mov_b32 v120, s15
    v_mov_b32 v121, s15
    v_mov_b32 v122, 0
    v_mov_b32 v123, 0
    s_mov_b32 s18, 0
    s_lshl_b32 s16, s18, 18
    s_add_u32 s16, s16, s7
    s_add_u32 s17, s16, 67108864
    buffer_load_dwordx4 a[64:67], v11, s[48:51], s17 offen
    s_add_u32 s17, s16, 67174400
    buffer_load_dwordx4 a[68:71], v11, s[48:51], s17 offen
    s_add_u32 s17, s16, 67239936
    buffer_load_dwordx4 a[72:75], v11, s[48:51], s17 offen
    s_add_u32 s17, s16, 67305472
    buffer_load_dwordx4 a[76:79], v11, s[48:51], s17 offen
    s_add_u32 s17, s16, 83886080
    buffer_load_dwordx4 a[80:83], v11, s[48:51], s17 offen
    s_add_u32 s17, s16, 83951616
    buffer_load_dwordx4 a[84:87], v11, s[48:51], s17 offen
    s_add_u32 s17, s16, 84017152
    buffer_load_dwordx4 a[88:91], v11, s[48:51], s17 offen
    s_add_u32 s17, s16, 84082688
    buffer_load_dwordx4 a[92:95], v11, s[48:51], s17 offen
    s_waitcnt vmcnt(0)
    ds_write_b128 v12, a[64:67] offset:0
    ds_write_b128 v12, a[68:71] offset:4224
    ds_write_b128 v12, a[72:75] offset:8448
    ds_write_b128 v12, a[76:79] offset:12672
    ds_write_b128 v12, a[80:83] offset:16896
    ds_write_b128 v12, a[84:87] offset:21120
    ds_write_b128 v12, a[88:91] offset:25344
    ds_write_b128 v12, a[92:95] offset:29568
    s_waitcnt lgkmcnt(0)
    s_barrier
fl_46:
    s_add_u32 s19, s18, 1
    s_cmp_ge_u32 s19, s12
    s_cbranch_scc1 fnl_48
    s_lshl_b32 s16, s19, 18
    s_add_u32 s16, s16, s7
    s_add_u32 s17, s16, 67108864
    buffer_load_dwordx4 a[64:67], v11, s[48:51], s17 offen
    s_add_u32 s17, s16, 67174400
    buffer_load_dwordx4 a[68:71], v11, s[48:51], s17 offen
    s_add_u32 s17, s16, 67239936
    buffer_load_dwordx4 a[72:75], v11, s[48:51], s17 offen
    s_add_u32 s17, s16, 67305472
    buffer_load_dwordx4 a[76:79], v11, s[48:51], s17 offen
    s_add_u32 s17, s16, 83886080
    buffer_load_dwordx4 a[80:83], v11, s[48:51], s17 offen
    s_add_u32 s17, s16, 83951616
    buffer_load_dwordx4 a[84:87], v11, s[48:51], s17 offen
    s_add_u32 s17, s16, 84017152
    buffer_load_dwordx4 a[88:91], v11, s[48:51], s17 offen
    s_add_u32 s17, s16, 84082688
    buffer_load_dwordx4 a[92:95], v11, s[48:51], s17 offen
fnl_48:
    v_mov_b32 v96, 0
    v_mov_b32 v97, 0
    v_mov_b32 v98, 0
    v_mov_b32 v99, 0
    v_mov_b32 v100, 0
    v_mov_b32 v101, 0
    v_mov_b32 v102, 0
    v_mov_b32 v103, 0
    v_mov_b32 v104, 0
    v_mov_b32 v105, 0
    v_mov_b32 v106, 0
    v_mov_b32 v107, 0
    v_mov_b32 v108, 0
    v_mov_b32 v109, 0
    v_mov_b32 v110, 0
    v_mov_b32 v111, 0
    ds_read_b128 v[32:35], v13 offset:0
    ds_read_b128 v[36:39], v13 offset:8448
    ds_read_b128 v[40:43], v13 offset:64
    ds_read_b128 v[44:47], v13 offset:8512
    ds_read_b128 v[48:51], v13 offset:128
    ds_read_b128 v[52:55], v13 offset:8576
    ds_read_b128 v[56:59], v13 offset:192
    ds_read_b128 v[60:63], v13 offset:8640
    ds_read_b128 v[64:67], v13 offset:256
    ds_read_b128 v[68:71], v13 offset:8704
    ds_read_b128 v[72:75], v13 offset:320
    ds_read_b128 v[76:79], v13 offset:8768
    ds_read_b128 v[80:83], v13 offset:384
    ds_read_b128 v[84:87], v13 offset:8832
    ds_read_b128 v[88:91], v13 offset:448
    ds_read_b128 v[92:95], v13 offset:8896
    s_waitcnt lgkmcnt(14)
    v_mfma_f32_16x16x32_bf16 v[96:99], v[32:35], a[0:3], v[96:99]
    v_mfma_f32_16x16x32_bf16 v[100:103], v[32:35], a[32:35], v[100:103]
    v_mfma_f32_16x16x32_bf16 v[104:107], v[36:39], a[0:3], v[104:107]
    v_mfma_f32_16x16x32_bf16 v[108:111], v[36:39], a[32:35], v[108:111]
    s_waitcnt lgkmcnt(12)
    v_mfma_f32_16x16x32_bf16 v[96:99], v[40:43], a[4:7], v[96:99]
    v_mfma_f32_16x16x32_bf16 v[100:103], v[40:43], a[36:39], v[100:103]
    v_mfma_f32_16x16x32_bf16 v[104:107], v[44:47], a[4:7], v[104:107]
    v_mfma_f32_16x16x32_bf16 v[108:111], v[44:47], a[36:39], v[108:111]
    s_waitcnt lgkmcnt(10)
    v_mfma_f32_16x16x32_bf16 v[96:99], v[48:51], a[8:11], v[96:99]
    v_mfma_f32_16x16x32_bf16 v[100:103], v[48:51], a[40:43], v[100:103]
    v_mfma_f32_16x16x32_bf16 v[104:107], v[52:55], a[8:11], v[104:107]
    v_mfma_f32_16x16x32_bf16 v[108:111], v[52:55], a[40:43], v[108:111]
    s_waitcnt lgkmcnt(8)
    v_mfma_f32_16x16x32_bf16 v[96:99], v[56:59], a[12:15], v[96:99]
    v_mfma_f32_16x16x32_bf16 v[100:103], v[56:59], a[44:47], v[100:103]
    v_mfma_f32_16x16x32_bf16 v[104:107], v[60:63], a[12:15], v[104:107]
    v_mfma_f32_16x16x32_bf16 v[108:111], v[60:63], a[44:47], v[108:111]
    s_waitcnt lgkmcnt(6)
    v_mfma_f32_16x16x32_bf16 v[96:99], v[64:67], a[16:19], v[96:99]
    v_mfma_f32_16x16x32_bf16 v[100:103], v[64:67], a[48:51], v[100:103]
    v_mfma_f32_16x16x32_bf16 v[104:107], v[68:71], a[16:19], v[104:107]
    v_mfma_f32_16x16x32_bf16 v[108:111], v[68:71], a[48:51], v[108:111]
    s_waitcnt lgkmcnt(4)
    v_mfma_f32_16x16x32_bf16 v[96:99], v[72:75], a[20:23], v[96:99]
    v_mfma_f32_16x16x32_bf16 v[100:103], v[72:75], a[52:55], v[100:103]
    v_mfma_f32_16x16x32_bf16 v[104:107], v[76:79], a[20:23], v[104:107]
    v_mfma_f32_16x16x32_bf16 v[108:111], v[76:79], a[52:55], v[108:111]
    s_waitcnt lgkmcnt(2)
    v_mfma_f32_16x16x32_bf16 v[96:99], v[80:83], a[24:27], v[96:99]
    v_mfma_f32_16x16x32_bf16 v[100:103], v[80:83], a[56:59], v[100:103]
    v_mfma_f32_16x16x32_bf16 v[104:107], v[84:87], a[24:27], v[104:107]
    v_mfma_f32_16x16x32_bf16 v[108:111], v[84:87], a[56:59], v[108:111]
    s_waitcnt lgkmcnt(0)
    v_mfma_f32_16x16x32_bf16 v[96:99], v[88:91], a[28:31], v[96:99]
    v_mfma_f32_16x16x32_bf16 v[100:103], v[88:91], a[60:63], v[100:103]
    v_mfma_f32_16x16x32_bf16 v[104:107], v[92:95], a[28:31], v[104:107]
    v_mfma_f32_16x16x32_bf16 v[108:111], v[92:95], a[60:63], v[108:111]
    ds_read_b64_tr_b16 v[32:33], v14 offset:0
    ds_read_b64_tr_b16 v[34:35], v14 offset:8448
    ds_read_b64_tr_b16 v[36:37], v14 offset:32
    ds_read_b64_tr_b16 v[38:39], v14 offset:8480
    ds_read_b64_tr_b16 v[40:41], v14 offset:64
    ds_read_b64_tr_b16 v[42:43], v14 offset:8512
    ds_read_b64_tr_b16 v[44:45], v14 offset:96
    ds_read_b64_tr_b16 v[46:47], v14 offset:8544
    ds_read_b64_tr_b16 v[48:49], v14 offset:128
    ds_read_b64_tr_b16 v[50:51], v14 offset:8576
    ds_read_b64_tr_b16 v[52:53], v14 offset:160
    ds_read_b64_tr_b16 v[54:55], v14 offset:8608
    ds_read_b64_tr_b16 v[56:57], v14 offset:192
    ds_read_b64_tr_b16 v[58:59], v14 offset:8640
    ds_read_b64_tr_b16 v[60:61], v14 offset:224
    ds_read_b64_tr_b16 v[62:63], v14 offset:8672
    ds_read_b64_tr_b16 v[64:65], v14 offset:256
    ds_read_b64_tr_b16 v[66:67], v14 offset:8704
    ds_read_b64_tr_b16 v[68:69], v14 offset:288
    ds_read_b64_tr_b16 v[70:71], v14 offset:8736
    ds_read_b64_tr_b16 v[72:73], v14 offset:320
    ds_read_b64_tr_b16 v[74:75], v14 offset:8768
    ds_read_b64_tr_b16 v[76:77], v14 offset:352
    ds_read_b64_tr_b16 v[78:79], v14 offset:8800
    ds_read_b64_tr_b16 v[80:81], v14 offset:384
    ds_read_b64_tr_b16 v[82:83], v14 offset:8832
    ds_read_b64_tr_b16 v[84:85], v14 offset:416
    ds_read_b64_tr_b16 v[86:87], v14 offset:8864
    ds_read_b64_tr_b16 v[88:89], v14 offset:448
    ds_read_b64_tr_b16 v[90:91], v14 offset:8896
    ds_read_b64_tr_b16 v[92:93], v14 offset:480
    ds_read_b64_tr_b16 v[94:95], v14 offset:8928
    s_nop 7
    s_nop 1
    s_mov_b32 s20, 0x3db8aa3b
    v_cvt_pk_bf16_f32 v124, v96, v97
    v_lshlrev_b32 v96, 16, v124
    v_and_b32 v97, 0xffff0000, v124
    v_cvt_pk_bf16_f32 v124, v98, v99
    v_lshlrev_b32 v98, 16, v124
    v_and_b32 v99, 0xffff0000, v124
    v_cvt_pk_bf16_f32 v124, v100, v101
    v_lshlrev_b32 v100, 16, v124
    v_and_b32 v101, 0xffff0000, v124
    v_cvt_pk_bf16_f32 v124, v102, v103
    v_lshlrev_b32 v102, 16, v124
    v_and_b32 v103, 0xffff0000, v124
    v_cvt_pk_bf16_f32 v124, v104, v105
    v_lshlrev_b32 v104, 16, v124
    v_and_b32 v105, 0xffff0000, v124
    v_cvt_pk_bf16_f32 v124, v106, v107
    v_lshlrev_b32 v106, 16, v124
    v_and_b32 v107, 0xffff0000, v124
    v_cvt_pk_bf16_f32 v124, v108, v109
    v_lshlrev_b32 v108, 16, v124
    v_and_b32 v109, 0xffff0000, v124
    v_cvt_pk_bf16_f32 v124, v110, v111
    v_lshlrev_b32 v110, 16, v124
    v_and_b32 v111, 0xffff0000, v124
    v_mul_f32 v96, s20, v96
    v_mul_f32 v97, s20, v97
    v_mul_f32 v98, s20, v98
    v_mul_f32 v99, s20, v99
    v_mul_f32 v100, s20, v100
    v_mul_f32 v101, s20, v101
    v_mul_f32 v102, s20, v102
    v_mul_f32 v103, s20, v103
    v_mul_f32 v104, s20, v104
    v_mul_f32 v105, s20, v105
    v_mul_f32 v106, s20, v106
    v_mul_f32 v107, s20, v107
    v_mul_f32 v108, s20, v108
    v_mul_f32 v109, s20, v109
    v_mul_f32 v110, s20, v110
    v_mul_f32 v111, s20, v111
    s_cmp_lt_u32 s18, s13
    s_cbranch_scc1 nomask_49
    s_lshl_b32 s21, s18, 5
    v_mov_b32 v125, s15
    s_add_u32 s22, s21, 0
    v_cmp_le_i32 vcc, s22, v15
    s_nop 1
    v_cndmask_b32 v96, v125, v96, vcc
    s_add_u32 s22, s21, 1
    v_cmp_le_i32 vcc, s22, v15
    s_nop 1
    v_cndmask_b32 v97, v125, v97, vcc
    s_add_u32 s22, s21, 2
    v_cmp_le_i32 vcc, s22, v15
    s_nop 1
    v_cndmask_b32 v98, v125, v98, vcc
    s_add_u32 s22, s21, 3
    v_cmp_le_i32 vcc, s22, v15
    s_nop 1
    v_cndmask_b32 v99, v125, v99, vcc
    s_add_u32 s22, s21, -16
    v_cmp_le_i32 vcc, s22, v15
    s_nop 1
    v_cndmask_b32 v100, v125, v100, vcc
    s_add_u32 s22, s21, -15
    v_cmp_le_i32 vcc, s22, v15
    s_nop 1
    v_cndmask_b32 v101, v125, v101, vcc
    s_add_u32 s22, s21, -14
    v_cmp_le_i32 vcc, s22, v15
    s_nop 1
    v_cndmask_b32 v102, v125, v102, vcc
    s_add_u32 s22, s21, -13
    v_cmp_le_i32 vcc, s22, v15
    s_nop 1
    v_cndmask_b32 v103, v125, v103, vcc
    s_add_u32 s22, s21, 16
    v_cmp_le_i32 vcc, s22, v15
    s_nop 1
    v_cndmask_b32 v104, v125, v104, vcc
    s_add_u32 s22, s21, 17
    v_cmp_le_i32 vcc, s22, v15
    s_nop 1
    v_cndmask_b32 v105, v125, v105, vcc
    s_add_u32 s22, s21, 18
    v_cmp_le_i32 vcc, s22, v15
    s_nop 1
    v_cndmask_b32 v106, v125, v106, vcc
    s_add_u32 s22, s21, 19
    v_cmp_le_i32 vcc, s22, v15
    s_nop 1
    v_cndmask_b32 v107, v125, v107, vcc
    s_add_u32 s22, s21, 0
    v_cmp_le_i32 vcc, s22, v15
    s_nop 1
    v_cndmask_b32 v108, v125, v108, vcc
    s_add_u32 s22, s21, 1
    v_cmp_le_i32 vcc, s22, v15
    s_nop 1
    v_cndmask_b32 v109, v125, v109, vcc
    s_add_u32 s22, s21, 2
    v_cmp_le_i32 vcc, s22, v15
    s_nop 1
    v_cndmask_b32 v110, v125, v110, vcc
    s_add_u32 s22, s21, 3
    v_cmp_le_i32 vcc, s22, v15
    s_nop 1
    v_cndmask_b32 v111, v125, v111, vcc
nomask_49:
    v_max3_f32 v126, v96, v97, v98
    v_max3_f32 v126, v126, v99, v104
    v_max3_f32 v126, v126, v105, v106
    v_max_f32 v126, v126, v107
    ds_bpermute_b32 v127, v5, v126
    s_waitcnt lgkmcnt(0)
    v_max_f32 v126, v126, v127
    ds_bpermute_b32 v127, v6, v126
    s_waitcnt lgkmcnt(0)
    v_max_f32 v126, v126, v127
    v_max_f32 v126, v126, v120
    v_sub_f32 v127, v120, v126
    v_exp_f32 v127, v127
    v_mov_b32 v120, v126
    v_sub_f32 v96, v96, v126
    v_exp_f32 v96, v96
    v_sub_f32 v97, v97, v126
    v_exp_f32 v97, v97
    v_sub_f32 v98, v98, v126
    v_exp_f32 v98, v98
    v_sub_f32 v99, v99, v126
    v_exp_f32 v99, v99
    v_sub_f32 v104, v104, v126
    v_exp_f32 v104, v104
    v_sub_f32 v105, v105, v126
    v_exp_f32 v105, v105
    v_sub_f32 v106, v106, v126
    v_exp_f32 v106, v106
    v_sub_f32 v107, v107, v126
    v_exp_f32 v107, v107
    s_nop 0
    v_mul_f32 v122, v122, v127
    v_add_f32 v122, v122, v96
    v_add_f32 v122, v122, v97
    v_add_f32 v122, v122, v98
    v_add_f32 v122, v122, v99
    v_add_f32 v122, v122, v104
    v_add_f32 v122, v122, v105
    v_add_f32 v122, v122, v106
    v_add_f32 v122, v122, v107
    v_cmp_neq_f32 vcc, 1.0, v127
    s_cbranch_vccz nors_50
    v_mul_f32 v128, v128, v127
    v_mul_f32 v129, v129, v127
    v_mul_f32 v130, v130, v127
    v_mul_f32 v131, v131, v127
    v_mul_f32 v136, v136, v127
    v_mul_f32 v137, v137, v127
    v_mul_f32 v138, v138, v127
    v_mul_f32 v139, v139, v127
    v_mul_f32 v144, v144, v127
    v_mul_f32 v145, v145, v127
    v_mul_f32 v146, v146, v127
    v_mul_f32 v147, v147, v127
    v_mul_f32 v152, v152, v127
    v_mul_f32 v153, v153, v127
    v_mul_f32 v154, v154, v127
    v_mul_f32 v155, v155, v127
    v_mul_f32 v160, v160, v127
    v_mul_f32 v161, v161, v127
    v_mul_f32 v162, v162, v127
    v_mul_f32 v163, v163, v127
    v_mul_f32 v168, v168, v127
    v_mul_f32 v169, v169, v127
    v_mul_f32 v170, v170, v127
    v_mul_f32 v171, v171, v127
    v_mul_f32 v176, v176, v127
    v_mul_f32 v177, v177, v127
    v_mul_f32 v178, v178, v127
    v_mul_f32 v179, v179, v127
    v_mul_f32 v184, v184, v127
    v_mul_f32 v185, v185, v127
    v_mul_f32 v186, v186, v127
    v_mul_f32 v187, v187, v127
    v_mul_f32 v192, v192, v127
    v_mul_f32 v193, v193, v127
    v_mul_f32 v194, v194, v127
    v_mul_f32 v195, v195, v127
    v_mul_f32 v200, v200, v127
    v_mul_f32 v201, v201, v127
    v_mul_f32 v202, v202, v127
    v_mul_f32 v203, v203, v127
    v_mul_f32 v208, v208, v127
    v_mul_f32 v209, v209, v127
    v_mul_f32 v210, v210, v127
    v_mul_f32 v211, v211, v127
    v_mul_f32 v216, v216, v127
    v_mul_f32 v217, v217, v127
    v_mul_f32 v218, v218, v127
    v_mul_f32 v219, v219, v127
    v_mul_f32 v224, v224, v127
    v_mul_f32 v225, v225, v127
    v_mul_f32 v226, v226, v127
    v_mul_f32 v227, v227, v127
    v_mul_f32 v232, v232, v127
    v_mul_f32 v233, v233, v127
    v_mul_f32 v234, v234, v127
    v_mul_f32 v235, v235, v127
    v_mul_f32 v240, v240, v127
    v_mul_f32 v241, v241, v127
    v_mul_f32 v242, v242, v127
    v_mul_f32 v243, v243, v127
    v_mul_f32 v248, v248, v127
    v_mul_f32 v249, v249, v127
    v_mul_f32 v250, v250, v127
    v_mul_f32 v251, v251, v127
nors_50:
    v_cvt_pk_bf16_f32 v112, v96, v97
    v_cvt_pk_bf16_f32 v113, v98, v99
    v_cvt_pk_bf16_f32 v114, v104, v105
    v_cvt_pk_bf16_f32 v115, v106, v107
    v_max3_f32 v126, v100, v101, v102
    v_max3_f32 v126, v126, v103, v108
    v_max3_f32 v126, v126, v109, v110
    v_max_f32 v126, v126, v111
    ds_bpermute_b32 v127, v5, v126
    s_waitcnt lgkmcnt(0)
    v_max_f32 v126, v126, v127
    ds_bpermute_b32 v127, v6, v126
    s_waitcnt lgkmcnt(0)
    v_max_f32 v126, v126, v127
    v_max_f32 v126, v126, v121
    v_sub_f32 v127, v121, v126
    v_exp_f32 v127, v127
    v_mov_b32 v121, v126
    v_sub_f32 v100, v100, v126
    v_exp_f32 v100, v100
    v_sub_f32 v101, v101, v126
    v_exp_f32 v101, v101
    v_sub_f32 v102, v102, v126
    v_exp_f32 v102, v102
    v_sub_f32 v103, v103, v126
    v_exp_f32 v103, v103
    v_sub_f32 v108, v108, v126
    v_exp_f32 v108, v108
    v_sub_f32 v109, v109, v126
    v_exp_f32 v109, v109
    v_sub_f32 v110, v110, v126
    v_exp_f32 v110, v110
    v_sub_f32 v111, v111, v126
    v_exp_f32 v111, v111
    s_nop 0
    v_mul_f32 v123, v123, v127
    v_add_f32 v123, v123, v100
    v_add_f32 v123, v123, v101
    v_add_f32 v123, v123, v102
    v_add_f32 v123, v123, v103
    v_add_f32 v123, v123, v108
    v_add_f32 v123, v123, v109
    v_add_f32 v123, v123, v110
    v_add_f32 v123, v123, v111
    v_cmp_neq_f32 vcc, 1.0, v127
    s_cbranch_vccz nors_51
    v_mul_f32 v132, v132, v127
    v_mul_f32 v133, v133, v127
    v_mul_f32 v134, v134, v127
    v_mul_f32 v135, v135, v127
    v_mul_f32 v140, v140, v127
    v_mul_f32 v141, v141, v127
    v_mul_f32 v142, v142, v127
    v_mul_f32 v143, v143, v127
    v_mul_f32 v148, v148, v127
    v_mul_f32 v149, v149, v127
    v_mul_f32 v150, v150, v127
    v_mul_f32 v151, v151, v127
    v_mul_f32 v156, v156, v127
    v_mul_f32 v157, v157, v127
    v_mul_f32 v158, v158, v127
    v_mul_f32 v159, v159, v127
    v_mul_f32 v164, v164, v127
    v_mul_f32 v165, v165, v127
    v_mul_f32 v166, v166, v127
    v_mul_f32 v167, v167, v127
    v_mul_f32 v172, v172, v127
    v_mul_f32 v173, v173, v127
    v_mul_f32 v174, v174, v127
    v_mul_f32 v175, v175, v127
    v_mul_f32 v180, v180, v127
    v_mul_f32 v181, v181, v127
    v_mul_f32 v182, v182, v127
    v_mul_f32 v183, v183, v127
    v_mul_f32 v188, v188, v127
    v_mul_f32 v189, v189, v127
    v_mul_f32 v190, v190, v127
    v_mul_f32 v191, v191, v127
    v_mul_f32 v196, v196, v127
    v_mul_f32 v197, v197, v127
    v_mul_f32 v198, v198, v127
    v_mul_f32 v199, v199, v127
    v_mul_f32 v204, v204, v127
    v_mul_f32 v205, v205, v127
    v_mul_f32 v206, v206, v127
    v_mul_f32 v207, v207, v127
    v_mul_f32 v212, v212, v127
    v_mul_f32 v213, v213, v127
    v_mul_f32 v214, v214, v127
    v_mul_f32 v215, v215, v127
    v_mul_f32 v220, v220, v127
    v_mul_f32 v221, v221, v127
    v_mul_f32 v222, v222, v127
    v_mul_f32 v223, v223, v127
    v_mul_f32 v228, v228, v127
    v_mul_f32 v229, v229, v127
    v_mul_f32 v230, v230, v127
    v_mul_f32 v231, v231, v127
    v_mul_f32 v236, v236, v127
    v_mul_f32 v237, v237, v127
    v_mul_f32 v238, v238, v127
    v_mul_f32 v239, v239, v127
    v_mul_f32 v244, v244, v127
    v_mul_f32 v245, v245, v127
    v_mul_f32 v246, v246, v127
    v_mul_f32 v247, v247, v127
    v_mul_f32 v252, v252, v127
    v_mul_f32 v253, v253, v127
    v_mul_f32 v254, v254, v127
    v_mul_f32 v255, v255, v127
nors_51:
    v_cvt_pk_bf16_f32 v116, v100, v101
    v_cvt_pk_bf16_f32 v117, v102, v103
    v_cvt_pk_bf16_f32 v118, v108, v109
    v_cvt_pk_bf16_f32 v119, v110, v111
    s_waitcnt lgkmcnt(0)
    v_mfma_f32_16x16x32_bf16 v[128:131], v[32:35], v[112:115], v[128:131]
    v_mfma_f32_16x16x32_bf16 v[132:135], v[32:35], v[116:119], v[132:135]
    v_mfma_f32_16x16x32_bf16 v[136:139], v[36:39], v[112:115], v[136:139]
    v_mfma_f32_16x16x32_bf16 v[140:143], v[36:39], v[116:119], v[140:143]
    v_mfma_f32_16x16x32_bf16 v[144:147], v[40:43], v[112:115], v[144:147]
    v_mfma_f32_16x16x32_bf16 v[148:151], v[40:43], v[116:119], v[148:151]
    v_mfma_f32_16x16x32_bf16 v[152:155], v[44:47], v[112:115], v[152:155]
    v_mfma_f32_16x16x32_bf16 v[156:159], v[44:47], v[116:119], v[156:159]
    v_mfma_f32_16x16x32_bf16 v[160:163], v[48:51], v[112:115], v[160:163]
    v_mfma_f32_16x16x32_bf16 v[164:167], v[48:51], v[116:119], v[164:167]
    v_mfma_f32_16x16x32_bf16 v[168:171], v[52:55], v[112:115], v[168:171]
    v_mfma_f32_16x16x32_bf16 v[172:175], v[52:55], v[116:119], v[172:175]
    v_mfma_f32_16x16x32_bf16 v[176:179], v[56:59], v[112:115], v[176:179]
    v_mfma_f32_16x16x32_bf16 v[180:183], v[56:59], v[116:119], v[180:183]
    v_mfma_f32_16x16x32_bf16 v[184:187], v[60:63], v[112:115], v[184:187]
    v_mfma_f32_16x16x32_bf16 v[188:191], v[60:63], v[116:119], v[188:191]
    v_mfma_f32_16x16x32_bf16 v[192:195], v[64:67], v[112:115], v[192:195]
    v_mfma_f32_16x16x32_bf16 v[196:199], v[64:67], v[116:119], v[196:199]
    v_mfma_f32_16x16x32_bf16 v[200:203], v[68:71], v[112:115], v[200:203]
    v_mfma_f32_16x16x32_bf16 v[204:207], v[68:71], v[116:119], v[204:207]
    v_mfma_f32_16x16x32_bf16 v[208:211], v[72:75], v[112:115], v[208:211]
    v_mfma_f32_16x16x32_bf16 v[212:215], v[72:75], v[116:119], v[212:215]
    v_mfma_f32_16x16x32_bf16 v[216:219], v[76:79], v[112:115], v[216:219]
    v_mfma_f32_16x16x32_bf16 v[220:223], v[76:79], v[116:119], v[220:223]
    v_mfma_f32_16x16x32_bf16 v[224:227], v[80:83], v[112:115], v[224:227]
    v_mfma_f32_16x16x32_bf16 v[228:231], v[80:83], v[116:119], v[228:231]
    v_mfma_f32_16x16x32_bf16 v[232:235], v[84:87], v[112:115], v[232:235]
    v_mfma_f32_16x16x32_bf16 v[236:239], v[84:87], v[116:119], v[236:239]
    v_mfma_f32_16x16x32_bf16 v[240:243], v[88:91], v[112:115], v[240:243]
    v_mfma_f32_16x16x32_bf16 v[244:247], v[88:91], v[116:119], v[244:247]
    v_mfma_f32_16x16x32_bf16 v[248:251], v[92:95], v[112:115], v[248:251]
    v_mfma_f32_16x16x32_bf16 v[252:255], v[92:95], v[116:119], v[252:255]
    s_waitcnt vmcnt(0)
    ds_write_b128 v12, a[64:67] offset:33792
    ds_write_b128 v12, a[68:71] offset:38016
    ds_write_b128 v12, a[72:75] offset:42240
    ds_write_b128 v12, a[76:79] offset:46464
    ds_write_b128 v12, a[80:83] offset:50688
    ds_write_b128 v12, a[84:87] offset:54912
    ds_write_b128 v12, a[88:91] offset:59136
    ds_write_b128 v12, a[92:95] offset:63360
    s_waitcnt lgkmcnt(0)
    s_barrier
    s_add_u32 s18, s18, 1
    s_cmp_ge_u32 s18, s12
    s_cbranch_scc1 fdone_47
    s_add_u32 s19, s18, 1
    s_cmp_ge_u32 s19, s12
    s_cbranch_scc1 fnl_52
    s_lshl_b32 s16, s19, 18
    s_add_u32 s16, s16, s7
    s_add_u32 s17, s16, 67108864
    buffer_load_dwordx4 a[64:67], v11, s[48:51], s17 offen
    s_add_u32 s17, s16, 67174400
    buffer_load_dwordx4 a[68:71], v11, s[48:51], s17 offen
    s_add_u32 s17, s16, 67239936
    buffer_load_dwordx4 a[72:75], v11, s[48:51], s17 offen
    s_add_u32 s17, s16, 67305472
    buffer_load_dwordx4 a[76:79], v11, s[48:51], s17 offen
    s_add_u32 s17, s16, 83886080
    buffer_load_dwordx4 a[80:83], v11, s[48:51], s17 offen
    s_add_u32 s17, s16, 83951616
    buffer_load_dwordx4 a[84:87], v11, s[48:51], s17 offen
    s_add_u32 s17, s16, 84017152
    buffer_load_dwordx4 a[88:91], v11, s[48:51], s17 offen
    s_add_u32 s17, s16, 84082688
    buffer_load_dwordx4 a[92:95], v11, s[48:51], s17 offen
fnl_52:
    v_mov_b32 v96, 0
    v_mov_b32 v97, 0
    v_mov_b32 v98, 0
    v_mov_b32 v99, 0
    v_mov_b32 v100, 0
    v_mov_b32 v101, 0
    v_mov_b32 v102, 0
    v_mov_b32 v103, 0
    v_mov_b32 v104, 0
    v_mov_b32 v105, 0
    v_mov_b32 v106, 0
    v_mov_b32 v107, 0
    v_mov_b32 v108, 0
    v_mov_b32 v109, 0
    v_mov_b32 v110, 0
    v_mov_b32 v111, 0
    ds_read_b128 v[32:35], v13 offset:33792
    ds_read_b128 v[36:39], v13 offset:42240
    ds_read_b128 v[40:43], v13 offset:33856
    ds_read_b128 v[44:47], v13 offset:42304
    ds_read_b128 v[48:51], v13 offset:33920
    ds_read_b128 v[52:55], v13 offset:42368
    ds_read_b128 v[56:59], v13 offset:33984
    ds_read_b128 v[60:63], v13 offset:42432
    ds_read_b128 v[64:67], v13 offset:34048
    ds_read_b128 v[68:71], v13 offset:42496
    ds_read_b128 v[72:75], v13 offset:34112
    ds_read_b128 v[76:79], v13 offset:42560
    ds_read_b128 v[80:83], v13 offset:34176
    ds_read_b128 v[84:87], v13 offset:42624
    ds_read_b128 v[88:91], v13 offset:34240
    ds_read_b128 v[92:95], v13 offset:42688
    s_waitcnt lgkmcnt(14)
    v_mfma_f32_16x16x32_bf16 v[96:99], v[32:35], a[0:3], v[96:99]
    v_mfma_f32_16x16x32_bf16 v[100:103], v[32:35], a[32:35], v[100:103]
    v_mfma_f32_16x16x32_bf16 v[104:107], v[36:39], a[0:3], v[104:107]
    v_mfma_f32_16x16x32_bf16 v[108:111], v[36:39], a[32:35], v[108:111]
    s_waitcnt lgkmcnt(12)
    v_mfma_f32_16x16x32_bf16 v[96:99], v[40:43], a[4:7], v[96:99]
    v_mfma_f32_16x16x32_bf16 v[100:103], v[40:43], a[36:39], v[100:103]
    v_mfma_f32_16x16x32_bf16 v[104:107], v[44:47], a[4:7], v[104:107]
    v_mfma_f32_16x16x32_bf16 v[108:111], v[44:47], a[36:39], v[108:111]
    s_waitcnt lgkmcnt(10)
    v_mfma_f32_16x16x32_bf16 v[96:99], v[48:51], a[8:11], v[96:99]
    v_mfma_f32_16x16x32_bf16 v[100:103], v[48:51], a[40:43], v[100:103]
    v_mfma_f32_16x16x32_bf16 v[104:107], v[52:55], a[8:11], v[104:107]
    v_mfma_f32_16x16x32_bf16 v[108:111], v[52:55], a[40:43], v[108:111]
    s_waitcnt lgkmcnt(8)
    v_mfma_f32_16x16x32_bf16 v[96:99], v[56:59], a[12:15], v[96:99]
    v_mfma_f32_16x16x32_bf16 v[100:103], v[56:59], a[44:47], v[100:103]
    v_mfma_f32_16x16x32_bf16 v[104:107], v[60:63], a[12:15], v[104:107]
    v_mfma_f32_16x16x32_bf16 v[108:111], v[60:63], a[44:47], v[108:111]
    s_waitcnt lgkmcnt(6)
    v_mfma_f32_16x16x32_bf16 v[96:99], v[64:67], a[16:19], v[96:99]
    v_mfma_f32_16x16x32_bf16 v[100:103], v[64:67], a[48:51], v[100:103]
    v_mfma_f32_16x16x32_bf16 v[104:107], v[68:71], a[16:19], v[104:107]
    v_mfma_f32_16x16x32_bf16 v[108:111], v[68:71], a[48:51], v[108:111]
    s_waitcnt lgkmcnt(4)
    v_mfma_f32_16x16x32_bf16 v[96:99], v[72:75], a[20:23], v[96:99]
    v_mfma_f32_16x16x32_bf16 v[100:103], v[72:75], a[52:55], v[100:103]
    v_mfma_f32_16x16x32_bf16 v[104:107], v[76:79], a[20:23], v[104:107]
    v_mfma_f32_16x16x32_bf16 v[108:111], v[76:79], a[52:55], v[108:111]
    s_waitcnt lgkmcnt(2)
    v_mfma_f32_16x16x32_bf16 v[96:99], v[80:83], a[24:27], v[96:99]
    v_mfma_f32_16x16x32_bf16 v[100:103], v[80:83], a[56:59], v[100:103]
    v_mfma_f32_16x16x32_bf16 v[104:107], v[84:87], a[24:27], v[104:107]
    v_mfma_f32_16x16x32_bf16 v[108:111], v[84:87], a[56:59], v[108:111]
    s_waitcnt lgkmcnt(0)
    v_mfma_f32_16x16x32_bf16 v[96:99], v[88:91], a[28:31], v[96:99]
    v_mfma_f32_16x16x32_bf16 v[100:103], v[88:91], a[60:63], v[100:103]
    v_mfma_f32_16x16x32_bf16 v[104:107], v[92:95], a[28:31], v[104:107]
    v_mfma_f32_16x16x32_bf16 v[108:111], v[92:95], a[60:63], v[108:111]
    ds_read_b64_tr_b16 v[32:33], v14 offset:33792
    ds_read_b64_tr_b16 v[34:35], v14 offset:42240
    ds_read_b64_tr_b16 v[36:37], v14 offset:33824
    ds_read_b64_tr_b16 v[38:39], v14 offset:42272
    ds_read_b64_tr_b16 v[40:41], v14 offset:33856
    ds_read_b64_tr_b16 v[42:43], v14 offset:42304
    ds_read_b64_tr_b16 v[44:45], v14 offset:33888
    ds_read_b64_tr_b16 v[46:47], v14 offset:42336
    ds_read_b64_tr_b16 v[48:49], v14 offset:33920
    ds_read_b64_tr_b16 v[50:51], v14 offset:42368
    ds_read_b64_tr_b16 v[52:53], v14 offset:33952
    ds_read_b64_tr_b16 v[54:55], v14 offset:42400
    ds_read_b64_tr_b16 v[56:57], v14 offset:33984
    ds_read_b64_tr_b16 v[58:59], v14 offset:42432
    ds_read_b64_tr_b16 v[60:61], v14 offset:34016
    ds_read_b64_tr_b16 v[62:63], v14 offset:42464
    ds_read_b64_tr_b16 v[64:65], v14 offset:34048
    ds_read_b64_tr_b16 v[66:67], v14 offset:42496
    ds_read_b64_tr_b16 v[68:69], v14 offset:34080
    ds_read_b64_tr_b16 v[70:71], v14 offset:42528
    ds_read_b64_tr_b16 v[72:73], v14 offset:34112
    ds_read_b64_tr_b16 v[74:75], v14 offset:42560
    ds_read_b64_tr_b16 v[76:77], v14 offset:34144
    ds_read_b64_tr_b16 v[78:79], v14 offset:42592
    ds_read_b64_tr_b16 v[80:81], v14 offset:34176
    ds_read_b64_tr_b16 v[82:83], v14 offset:42624
    ds_read_b64_tr_b16 v[84:85], v14 offset:34208
    ds_read_b64_tr_b16 v[86:87], v14 offset:42656
    ds_read_b64_tr_b16 v[88:89], v14 offset:34240
    ds_read_b64_tr_b16 v[90:91], v14 offset:42688
    ds_read_b64_tr_b16 v[92:93], v14 offset:34272
    ds_read_b64_tr_b16 v[94:95], v14 offset:42720
    s_nop 7
    s_nop 1
    s_mov_b32 s20, 0x3db8aa3b
    v_cvt_pk_bf16_f32 v124, v96, v97
    v_lshlrev_b32 v96, 16, v124
    v_and_b32 v97, 0xffff0000, v124
    v_cvt_pk_bf16_f32 v124, v98, v99
    v_lshlrev_b32 v98, 16, v124
    v_and_b32 v99, 0xffff0000, v124
    v_cvt_pk_bf16_f32 v124, v100, v101
    v_lshlrev_b32 v100, 16, v124
    v_and_b32 v101, 0xffff0000, v124
    v_cvt_pk_bf16_f32 v124, v102, v103
    v_lshlrev_b32 v102, 16, v124
    v_and_b32 v103, 0xffff0000, v124
    v_cvt_pk_bf16_f32 v124, v104, v105
    v_lshlrev_b32 v104, 16, v124
    v_and_b32 v105, 0xffff0000, v124
    v_cvt_pk_bf16_f32 v124, v106, v107
    v_lshlrev_b32 v106, 16, v124
    v_and_b32 v107, 0xffff0000, v124
    v_cvt_pk_bf16_f32 v124, v108, v109
    v_lshlrev_b32 v108, 16, v124
    v_and_b32 v109, 0xffff0000, v124
    v_cvt_pk_bf16_f32 v124, v110, v111
    v_lshlrev_b32 v110, 16, v124
    v_and_b32 v111, 0xffff0000, v124
    v_mul_f32 v96, s20, v96
    v_mul_f32 v97, s20, v97
    v_mul_f32 v98, s20, v98
    v_mul_f32 v99, s20, v99
    v_mul_f32 v100, s20, v100
    v_mul_f32 v101, s20, v101
    v_mul_f32 v102, s20, v102
    v_mul_f32 v103, s20, v103
    v_mul_f32 v104, s20, v104
    v_mul_f32 v105, s20, v105
    v_mul_f32 v106, s20, v106
    v_mul_f32 v107, s20, v107
    v_mul_f32 v108, s20, v108
    v_mul_f32 v109, s20, v109
    v_mul_f32 v110, s20, v110
    v_mul_f32 v111, s20, v111
    s_cmp_lt_u32 s18, s13
    s_cbranch_scc1 nomask_53
    s_lshl_b32 s21, s18, 5
    v_mov_b32 v125, s15
    s_add_u32 s22, s21, 0
    v_cmp_le_i32 vcc, s22, v15
    s_nop 1
    v_cndmask_b32 v96, v125, v96, vcc
    s_add_u32 s22, s21, 1
    v_cmp_le_i32 vcc, s22, v15
    s_nop 1
    v_cndmask_b32 v97, v125, v97, vcc
    s_add_u32 s22, s21, 2
    v_cmp_le_i32 vcc, s22, v15
    s_nop 1
    v_cndmask_b32 v98, v125, v98, vcc
    s_add_u32 s22, s21, 3
    v_cmp_le_i32 vcc, s22, v15
    s_nop 1
    v_cndmask_b32 v99, v125, v99, vcc
    s_add_u32 s22, s21, -16
    v_cmp_le_i32 vcc, s22, v15
    s_nop 1
    v_cndmask_b32 v100, v125, v100, vcc
    s_add_u32 s22, s21, -15
    v_cmp_le_i32 vcc, s22, v15
    s_nop 1
    v_cndmask_b32 v101, v125, v101, vcc
    s_add_u32 s22, s21, -14
    v_cmp_le_i32 vcc, s22, v15
    s_nop 1
    v_cndmask_b32 v102, v125, v102, vcc
    s_add_u32 s22, s21, -13
    v_cmp_le_i32 vcc, s22, v15
    s_nop 1
    v_cndmask_b32 v103, v125, v103, vcc
    s_add_u32 s22, s21, 16
    v_cmp_le_i32 vcc, s22, v15
    s_nop 1
    v_cndmask_b32 v104, v125, v104, vcc
    s_add_u32 s22, s21, 17
    v_cmp_le_i32 vcc, s22, v15
    s_nop 1
    v_cndmask_b32 v105, v125, v105, vcc
    s_add_u32 s22, s21, 18
    v_cmp_le_i32 vcc, s22, v15
    s_nop 1
    v_cndmask_b32 v106, v125, v106, vcc
    s_add_u32 s22, s21, 19
    v_cmp_le_i32 vcc, s22, v15
    s_nop 1
    v_cndmask_b32 v107, v125, v107, vcc
    s_add_u32 s22, s21, 0
    v_cmp_le_i32 vcc, s22, v15
    s_nop 1
    v_cndmask_b32 v108, v125, v108, vcc
    s_add_u32 s22, s21, 1
    v_cmp_le_i32 vcc, s22, v15
    s_nop 1
    v_cndmask_b32 v109, v125, v109, vcc
    s_add_u32 s22, s21, 2
    v_cmp_le_i32 vcc, s22, v15
    s_nop 1
    v_cndmask_b32 v110, v125, v110, vcc
    s_add_u32 s22, s21, 3
    v_cmp_le_i32 vcc, s22, v15
    s_nop 1
    v_cndmask_b32 v111, v125, v111, vcc
nomask_53:
    v_max3_f32 v126, v96, v97, v98
    v_max3_f32 v126, v126, v99, v104
    v_max3_f32 v126, v126, v105, v106
    v_max_f32 v126, v126, v107
    ds_bpermute_b32 v127, v5, v126
    s_waitcnt lgkmcnt(0)
    v_max_f32 v126, v126, v127
    ds_bpermute_b32 v127, v6, v126
    s_waitcnt lgkmcnt(0)
    v_max_f32 v126, v126, v127
    v_max_f32 v126, v126, v120
    v_sub_f32 v127, v120, v126
    v_exp_f32 v127, v127
    v_mov_b32 v120, v126
    v_sub_f32 v96, v96, v126
    v_exp_f32 v96, v96
    v_sub_f32 v97, v97, v126
    v_exp_f32 v97, v97
    v_sub_f32 v98, v98, v126
    v_exp_f32 v98, v98
    v_sub_f32 v99, v99, v126
    v_exp_f32 v99, v99
    v_sub_f32 v104, v104, v126
    v_exp_f32 v104, v104
    v_sub_f32 v105, v105, v126
    v_exp_f32 v105, v105
    v_sub_f32 v106, v106, v126
    v_exp_f32 v106, v106
    v_sub_f32 v107, v107, v126
    v_exp_f32 v107, v107
    s_nop 0
    v_mul_f32 v122, v122, v127
    v_add_f32 v122, v122, v96
    v_add_f32 v122, v122, v97
    v_add_f32 v122, v122, v98
    v_add_f32 v122, v122, v99
    v_add_f32 v122, v122, v104
    v_add_f32 v122, v122, v105
    v_add_f32 v122, v122, v106
    v_add_f32 v122, v122, v107
    v_cmp_neq_f32 vcc, 1.0, v127
    s_cbranch_vccz nors_54
    v_mul_f32 v128, v128, v127
    v_mul_f32 v129, v129, v127
    v_mul_f32 v130, v130, v127
    v_mul_f32 v131, v131, v127
    v_mul_f32 v136, v136, v127
    v_mul_f32 v137, v137, v127
    v_mul_f32 v138, v138, v127
    v_mul_f32 v139, v139, v127
    v_mul_f32 v144, v144, v127
    v_mul_f32 v145, v145, v127
    v_mul_f32 v146, v146, v127
    v_mul_f32 v147, v147, v127
    v_mul_f32 v152, v152, v127
    v_mul_f32 v153, v153, v127
    v_mul_f32 v154, v154, v127
    v_mul_f32 v155, v155, v127
    v_mul_f32 v160, v160, v127
    v_mul_f32 v161, v161, v127
    v_mul_f32 v162, v162, v127
    v_mul_f32 v163, v163, v127
    v_mul_f32 v168, v168, v127
    v_mul_f32 v169, v169, v127
    v_mul_f32 v170, v170, v127
    v_mul_f32 v171, v171, v127
    v_mul_f32 v176, v176, v127
    v_mul_f32 v177, v177, v127
    v_mul_f32 v178, v178, v127
    v_mul_f32 v179, v179, v127
    v_mul_f32 v184, v184, v127
    v_mul_f32 v185, v185, v127
    v_mul_f32 v186, v186, v127
    v_mul_f32 v187, v187, v127
    v_mul_f32 v192, v192, v127
    v_mul_f32 v193, v193, v127
    v_mul_f32 v194, v194, v127
    v_mul_f32 v195, v195, v127
    v_mul_f32 v200, v200, v127
    v_mul_f32 v201, v201, v127
    v_mul_f32 v202, v202, v127
    v_mul_f32 v203, v203, v127
    v_mul_f32 v208, v208, v127
    v_mul_f32 v209, v209, v127
    v_mul_f32 v210, v210, v127
    v_mul_f32 v211, v211, v127
    v_mul_f32 v216, v216, v127
    v_mul_f32 v217, v217, v127
    v_mul_f32 v218, v218, v127
    v_mul_f32 v219, v219, v127
    v_mul_f32 v224, v224, v127
    v_mul_f32 v225, v225, v127
    v_mul_f32 v226, v226, v127
    v_mul_f32 v227, v227, v127
    v_mul_f32 v232, v232, v127
    v_mul_f32 v233, v233, v127
    v_mul_f32 v234, v234, v127
    v_mul_f32 v235, v235, v127
    v_mul_f32 v240, v240, v127
    v_mul_f32 v241, v241, v127
    v_mul_f32 v242, v242, v127
    v_mul_f32 v243, v243, v127
    v_mul_f32 v248, v248, v127
    v_mul_f32 v249, v249, v127
    v_mul_f32 v250, v250, v127
    v_mul_f32 v251, v251, v127
nors_54:
    v_cvt_pk_bf16_f32 v112, v96, v97
    v_cvt_pk_bf16_f32 v113, v98, v99
    v_cvt_pk_bf16_f32 v114, v104, v105
    v_cvt_pk_bf16_f32 v115, v106, v107
    v_max3_f32 v126, v100, v101, v102
    v_max3_f32 v126, v126, v103, v108
    v_max3_f32 v126, v126, v109, v110
    v_max_f32 v126, v126, v111
    ds_bpermute_b32 v127, v5, v126
    s_waitcnt lgkmcnt(0)
    v_max_f32 v126, v126, v127
    ds_bpermute_b32 v127, v6, v126
    s_waitcnt lgkmcnt(0)
    v_max_f32 v126, v126, v127
    v_max_f32 v126, v126, v121
    v_sub_f32 v127, v121, v126
    v_exp_f32 v127, v127
    v_mov_b32 v121, v126
    v_sub_f32 v100, v100, v126
    v_exp_f32 v100, v100
    v_sub_f32 v101, v101, v126
    v_exp_f32 v101, v101
    v_sub_f32 v102, v102, v126
    v_exp_f32 v102, v102
    v_sub_f32 v103, v103, v126
    v_exp_f32 v103, v103
    v_sub_f32 v108, v108, v126
    v_exp_f32 v108, v108
    v_sub_f32 v109, v109, v126
    v_exp_f32 v109, v109
    v_sub_f32 v110, v110, v126
    v_exp_f32 v110, v110
    v_sub_f32 v111, v111, v126
    v_exp_f32 v111, v111
    s_nop 0
    v_mul_f32 v123, v123, v127
    v_add_f32 v123, v123, v100
    v_add_f32 v123, v123, v101
    v_add_f32 v123, v123, v102
    v_add_f32 v123, v123, v103
    v_add_f32 v123, v123, v108
    v_add_f32 v123, v123, v109
    v_add_f32 v123, v123, v110
    v_add_f32 v123, v123, v111
    v_cmp_neq_f32 vcc, 1.0, v127
    s_cbranch_vccz nors_55
    v_mul_f32 v132, v132, v127
    v_mul_f32 v133, v133, v127
    v_mul_f32 v134, v134, v127
    v_mul_f32 v135, v135, v127
    v_mul_f32 v140, v140, v127
    v_mul_f32 v141, v141, v127
    v_mul_f32 v142, v142, v127
    v_mul_f32 v143, v143, v127
    v_mul_f32 v148, v148, v127
    v_mul_f32 v149, v149, v127
    v_mul_f32 v150, v150, v127
    v_mul_f32 v151, v151, v127
    v_mul_f32 v156, v156, v127
    v_mul_f32 v157, v157, v127
    v_mul_f32 v158, v158, v127
    v_mul_f32 v159, v159, v127
    v_mul_f32 v164, v164, v127
    v_mul_f32 v165, v165, v127
    v_mul_f32 v166, v166, v127
    v_mul_f32 v167, v167, v127
    v_mul_f32 v172, v172, v127
    v_mul_f32 v173, v173, v127
    v_mul_f32 v174, v174, v127
    v_mul_f32 v175, v175, v127
    v_mul_f32 v180, v180, v127
    v_mul_f32 v181, v181, v127
    v_mul_f32 v182, v182, v127
    v_mul_f32 v183, v183, v127
    v_mul_f32 v188, v188, v127
    v_mul_f32 v189, v189, v127
    v_mul_f32 v190, v190, v127
    v_mul_f32 v191, v191, v127
    v_mul_f32 v196, v196, v127
    v_mul_f32 v197, v197, v127
    v_mul_f32 v198, v198, v127
    v_mul_f32 v199, v199, v127
    v_mul_f32 v204, v204, v127
    v_mul_f32 v205, v205, v127
    v_mul_f32 v206, v206, v127
    v_mul_f32 v207, v207, v127
    v_mul_f32 v212, v212, v127
    v_mul_f32 v213, v213, v127
    v_mul_f32 v214, v214, v127
    v_mul_f32 v215, v215, v127
    v_mul_f32 v220, v220, v127
    v_mul_f32 v221, v221, v127
    v_mul_f32 v222, v222, v127
    v_mul_f32 v223, v223, v127
    v_mul_f32 v228, v228, v127
    v_mul_f32 v229, v229, v127
    v_mul_f32 v230, v230, v127
    v_mul_f32 v231, v231, v127
    v_mul_f32 v236, v236, v127
    v_mul_f32 v237, v237, v127
    v_mul_f32 v238, v238, v127
    v_mul_f32 v239, v239, v127
    v_mul_f32 v244, v244, v127
    v_mul_f32 v245, v245, v127
    v_mul_f32 v246, v246, v127
    v_mul_f32 v247, v247, v127
    v_mul_f32 v252, v252, v127
    v_mul_f32 v253, v253, v127
    v_mul_f32 v254, v254, v127
    v_mul_f32 v255, v255, v127
nors_55:
    v_cvt_pk_bf16_f32 v116, v100, v101
    v_cvt_pk_bf16_f32 v117, v102, v103
    v_cvt_pk_bf16_f32 v118, v108, v109
    v_cvt_pk_bf16_f32 v119, v110, v111
    s_waitcnt lgkmcnt(0)
    v_mfma_f32_16x16x32_bf16 v[128:131], v[32:35], v[112:115], v[128:131]
    v_mfma_f32_16x16x32_bf16 v[132:135], v[32:35], v[116:119], v[132:135]
    v_mfma_f32_16x16x32_bf16 v[136:139], v[36:39], v[112:115], v[136:139]
    v_mfma_f32_16x16x32_bf16 v[140:143], v[36:39], v[116:119], v[140:143]
    v_mfma_f32_16x16x32_bf16 v[144:147], v[40:43], v[112:115], v[144:147]
    v_mfma_f32_16x16x32_bf16 v[148:151], v[40:43], v[116:119], v[148:151]
    v_mfma_f32_16x16x32_bf16 v[152:155], v[44:47], v[112:115], v[152:155]
    v_mfma_f32_16x16x32_bf16 v[156:159], v[44:47], v[116:119], v[156:159]
    v_mfma_f32_16x16x32_bf16 v[160:163], v[48:51], v[112:115], v[160:163]
    v_mfma_f32_16x16x32_bf16 v[164:167], v[48:51], v[116:119], v[164:167]
    v_mfma_f32_16x16x32_bf16 v[168:171], v[52:55], v[112:115], v[168:171]
    v_mfma_f32_16x16x32_bf16 v[172:175], v[52:55], v[116:119], v[172:175]
    v_mfma_f32_16x16x32_bf16 v[176:179], v[56:59], v[112:115], v[176:179]
    v_mfma_f32_16x16x32_bf16 v[180:183], v[56:59], v[116:119], v[180:183]
    v_mfma_f32_16x16x32_bf16 v[184:187], v[60:63], v[112:115], v[184:187]
    v_mfma_f32_16x16x32_bf16 v[188:191], v[60:63], v[116:119], v[188:191]
    v_mfma_f32_16x16x32_bf16 v[192:195], v[64:67], v[112:115], v[192:195]
    v_mfma_f32_16x16x32_bf16 v[196:199], v[64:67], v[116:119], v[196:199]
    v_mfma_f32_16x16x32_bf16 v[200:203], v[68:71], v[112:115], v[200:203]
    v_mfma_f32_16x16x32_bf16 v[204:207], v[68:71], v[116:119], v[204:207]
    v_mfma_f32_16x16x32_bf16 v[208:211], v[72:75], v[112:115], v[208:211]
    v_mfma_f32_16x16x32_bf16 v[212:215], v[72:75], v[116:119], v[212:215]
    v_mfma_f32_16x16x32_bf16 v[216:219], v[76:79], v[112:115], v[216:219]
    v_mfma_f32_16x16x32_bf16 v[220:223], v[76:79], v[116:119], v[220:223]
    v_mfma_f32_16x16x32_bf16 v[224:227], v[80:83], v[112:115], v[224:227]
    v_mfma_f32_16x16x32_bf16 v[228:231], v[80:83], v[116:119], v[228:231]
    v_mfma_f32_16x16x32_bf16 v[232:235], v[84:87], v[112:115], v[232:235]
    v_mfma_f32_16x16x32_bf16 v[236:239], v[84:87], v[116:119], v[236:239]
    v_mfma_f32_16x16x32_bf16 v[240:243], v[88:91], v[112:115], v[240:243]
    v_mfma_f32_16x16x32_bf16 v[244:247], v[88:91], v[116:119], v[244:247]
    v_mfma_f32_16x16x32_bf16 v[248:251], v[92:95], v[112:115], v[248:251]
    v_mfma_f32_16x16x32_bf16 v[252:255], v[92:95], v[116:119], v[252:255]
    s_waitcnt vmcnt(0)
    ds_write_b128 v12, a[64:67] offset:0
    ds_write_b128 v12, a[68:71] offset:4224
    ds_write_b128 v12, a[72:75] offset:8448
    ds_write_b128 v12, a[76:79] offset:12672
    ds_write_b128 v12, a[80:83] offset:16896
    ds_write_b128 v12, a[84:87] offset:21120
    ds_write_b128 v12, a[88:91] offset:25344
    ds_write_b128 v12, a[92:95] offset:29568
    s_waitcnt lgkmcnt(0)
    s_barrier
    s_add_u32 s18, s18, 1
    s_cmp_ge_u32 s18, s12
    s_cbranch_scc1 fdone_47
    s_branch fl_46
fdone_47:
    s_nop 7
    s_nop 1
    v_lshlrev_b32 v19, 13, v3
    v_lshlrev_b32 v20, 3, v4
    v_add_u32 v19, v19, v20
    ds_bpermute_b32 v36, v5, v122
    s_waitcnt lgkmcnt(0)
    v_add_f32 v122, v122, v36
    ds_bpermute_b32 v36, v6, v122
    s_waitcnt lgkmcnt(0)
    v_add_f32 v122, v122, v36
    v_rcp_f32 v122, v122
    s_nop 0
    s_add_u32 s14, s8, 117440512
    v_mul_f32 v128, v128, v122
    v_mul_f32 v129, v129, v122
    v_mul_f32 v130, v130, v122
    v_mul_f32 v131, v131, v122
    v_cvt_pk_bf16_f32 v56, v128, v129
    v_cvt_pk_bf16_f32 v57, v130, v131
    buffer_store_dwordx2 v[56:57], v19, s[48:51], s14 offen offset:0
    s_nop 0
    v_mul_f32 v136, v136, v122
    v_mul_f32 v137, v137, v122
    v_mul_f32 v138, v138, v122
    v_mul_f32 v139, v139, v122
    v_cvt_pk_bf16_f32 v56, v136, v137
    v_cvt_pk_bf16_f32 v57, v138, v139
    buffer_store_dwordx2 v[56:57], v19, s[48:51], s14 offen offset:32
    s_nop 0
    v_mul_f32 v144, v144, v122
    v_mul_f32 v145, v145, v122
    v_mul_f32 v146, v146, v122
    v_mul_f32 v147, v147, v122
    v_cvt_pk_bf16_f32 v56, v144, v145
    v_cvt_pk_bf16_f32 v57, v146, v147
    buffer_store_dwordx2 v[56:57], v19, s[48:51], s14 offen offset:64
    s_nop 0
    v_mul_f32 v152, v152, v122
    v_mul_f32 v153, v153, v122
    v_mul_f32 v154, v154, v122
    v_mul_f32 v155, v155, v122
    v_cvt_pk_bf16_f32 v56, v152, v153
    v_cvt_pk_bf16_f32 v57, v154, v155
    buffer_store_dwordx2 v[56:57], v19, s[48:51], s14 offen offset:96
    s_nop 0
    v_mul_f32 v160, v160, v122
    v_mul_f32 v161, v161, v122
    v_mul_f32 v162, v162, v122
    v_mul_f32 v163, v163, v122
    v_cvt_pk_bf16_f32 v56, v160, v161
    v_cvt_pk_bf16_f32 v57, v162, v163
    buffer_store_dwordx2 v[56:57], v19, s[48:51], s14 offen offset:128
    s_nop 0
    v_mul_f32 v168, v168, v122
    v_mul_f32 v169, v169, v122
    v_mul_f32 v170, v170, v122
    v_mul_f32 v171, v171, v122
    v_cvt_pk_bf16_f32 v56, v168, v169
    v_cvt_pk_bf16_f32 v57, v170, v171
    buffer_store_dwordx2 v[56:57], v19, s[48:51], s14 offen offset:160
    s_nop 0
    v_mul_f32 v176, v176, v122
    v_mul_f32 v177, v177, v122
    v_mul_f32 v178, v178, v122
    v_mul_f32 v179, v179, v122
    v_cvt_pk_bf16_f32 v56, v176, v177
    v_cvt_pk_bf16_f32 v57, v178, v179
    buffer_store_dwordx2 v[56:57], v19, s[48:51], s14 offen offset:192
    s_nop 0
    v_mul_f32 v184, v184, v122
    v_mul_f32 v185, v185, v122
    v_mul_f32 v186, v186, v122
    v_mul_f32 v187, v187, v122
    v_cvt_pk_bf16_f32 v56, v184, v185
    v_cvt_pk_bf16_f32 v57, v186, v187
    buffer_store_dwordx2 v[56:57], v19, s[48:51], s14 offen offset:224
    s_nop 0
    v_mul_f32 v192, v192, v122
    v_mul_f32 v193, v193, v122
    v_mul_f32 v194, v194, v122
    v_mul_f32 v195, v195, v122
    v_cvt_pk_bf16_f32 v56, v192, v193
    v_cvt_pk_bf16_f32 v57, v194, v195
    buffer_store_dwordx2 v[56:57], v19, s[48:51], s14 offen offset:256
    s_nop 0
    v_mul_f32 v200, v200, v122
    v_mul_f32 v201, v201, v122
    v_mul_f32 v202, v202, v122
    v_mul_f32 v203, v203, v122
    v_cvt_pk_bf16_f32 v56, v200, v201
    v_cvt_pk_bf16_f32 v57, v202, v203
    buffer_store_dwordx2 v[56:57], v19, s[48:51], s14 offen offset:288
    s_nop 0
    v_mul_f32 v208, v208, v122
    v_mul_f32 v209, v209, v122
    v_mul_f32 v210, v210, v122
    v_mul_f32 v211, v211, v122
    v_cvt_pk_bf16_f32 v56, v208, v209
    v_cvt_pk_bf16_f32 v57, v210, v211
    buffer_store_dwordx2 v[56:57], v19, s[48:51], s14 offen offset:320
    s_nop 0
    v_mul_f32 v216, v216, v122
    v_mul_f32 v217, v217, v122
    v_mul_f32 v218, v218, v122
    v_mul_f32 v219, v219, v122
    v_cvt_pk_bf16_f32 v56, v216, v217
    v_cvt_pk_bf16_f32 v57, v218, v219
    buffer_store_dwordx2 v[56:57], v19, s[48:51], s14 offen offset:352
    s_nop 0
    v_mul_f32 v224, v224, v122
    v_mul_f32 v225, v225, v122
    v_mul_f32 v226, v226, v122
    v_mul_f32 v227, v227, v122
    v_cvt_pk_bf16_f32 v56, v224, v225
    v_cvt_pk_bf16_f32 v57, v226, v227
    buffer_store_dwordx2 v[56:57], v19, s[48:51], s14 offen offset:384
    s_nop 0
    v_mul_f32 v232, v232, v122
    v_mul_f32 v233, v233, v122
    v_mul_f32 v234, v234, v122
    v_mul_f32 v235, v235, v122
    v_cvt_pk_bf16_f32 v56, v232, v233
    v_cvt_pk_bf16_f32 v57, v234, v235
    buffer_store_dwordx2 v[56:57], v19, s[48:51], s14 offen offset:416
    s_nop 0
    v_mul_f32 v240, v240, v122
    v_mul_f32 v241, v241, v122
    v_mul_f32 v242, v242, v122
    v_mul_f32 v243, v243, v122
    v_cvt_pk_bf16_f32 v56, v240, v241
    v_cvt_pk_bf16_f32 v57, v242, v243
    buffer_store_dwordx2 v[56:57], v19, s[48:51], s14 offen offset:448
    s_nop 0
    v_mul_f32 v248, v248, v122
    v_mul_f32 v249, v249, v122
    v_mul_f32 v250, v250, v122
    v_mul_f32 v251, v251, v122
    v_cvt_pk_bf16_f32 v56, v248, v249
    v_cvt_pk_bf16_f32 v57, v250, v251
    buffer_store_dwordx2 v[56:57], v19, s[48:51], s14 offen offset:480
    s_nop 0
    ds_bpermute_b32 v36, v5, v123
    s_waitcnt lgkmcnt(0)
    v_add_f32 v123, v123, v36
    ds_bpermute_b32 v36, v6, v123
    s_waitcnt lgkmcnt(0)
    v_add_f32 v123, v123, v36
    v_rcp_f32 v123, v123
    s_nop 0
    s_add_u32 s14, s8, 117571584
    v_mul_f32 v132, v132, v123
    v_mul_f32 v133, v133, v123
    v_mul_f32 v134, v134, v123
    v_mul_f32 v135, v135, v123
    v_cvt_pk_bf16_f32 v56, v132, v133
    v_cvt_pk_bf16_f32 v57, v134, v135
    buffer_store_dwordx2 v[56:57], v19, s[48:51], s14 offen offset:0
    s_nop 0
    v_mul_f32 v140, v140, v123
    v_mul_f32 v141, v141, v123
    v_mul_f32 v142, v142, v123
    v_mul_f32 v143, v143, v123
    v_cvt_pk_bf16_f32 v56, v140, v141
    v_cvt_pk_bf16_f32 v57, v142, v143
    buffer_store_dwordx2 v[56:57], v19, s[48:51], s14 offen offset:32
    s_nop 0
    v_mul_f32 v148, v148, v123
    v_mul_f32 v149, v149, v123
    v_mul_f32 v150, v150, v123
    v_mul_f32 v151, v151, v123
    v_cvt_pk_bf16_f32 v56, v148, v149
    v_cvt_pk_bf16_f32 v57, v150, v151
    buffer_store_dwordx2 v[56:57], v19, s[48:51], s14 offen offset:64
    s_nop 0
    v_mul_f32 v156, v156, v123
    v_mul_f32 v157, v157, v123
    v_mul_f32 v158, v158, v123
    v_mul_f32 v159, v159, v123
    v_cvt_pk_bf16_f32 v56, v156, v157
    v_cvt_pk_bf16_f32 v57, v158, v159
    buffer_store_dwordx2 v[56:57], v19, s[48:51], s14 offen offset:96
    s_nop 0
    v_mul_f32 v164, v164, v123
    v_mul_f32 v165, v165, v123
    v_mul_f32 v166, v166, v123
    v_mul_f32 v167, v167, v123
    v_cvt_pk_bf16_f32 v56, v164, v165
    v_cvt_pk_bf16_f32 v57, v166, v167
    buffer_store_dwordx2 v[56:57], v19, s[48:51], s14 offen offset:128
    s_nop 0
    v_mul_f32 v172, v172, v123
    v_mul_f32 v173, v173, v123
    v_mul_f32 v174, v174, v123
    v_mul_f32 v175, v175, v123
    v_cvt_pk_bf16_f32 v56, v172, v173
    v_cvt_pk_bf16_f32 v57, v174, v175
    buffer_store_dwordx2 v[56:57], v19, s[48:51], s14 offen offset:160
    s_nop 0
    v_mul_f32 v180, v180, v123
    v_mul_f32 v181, v181, v123
    v_mul_f32 v182, v182, v123
    v_mul_f32 v183, v183, v123
    v_cvt_pk_bf16_f32 v56, v180, v181
    v_cvt_pk_bf16_f32 v57, v182, v183
    buffer_store_dwordx2 v[56:57], v19, s[48:51], s14 offen offset:192
    s_nop 0
    v_mul_f32 v188, v188, v123
    v_mul_f32 v189, v189, v123
    v_mul_f32 v190, v190, v123
    v_mul_f32 v191, v191, v123
    v_cvt_pk_bf16_f32 v56, v188, v189
    v_cvt_pk_bf16_f32 v57, v190, v191
    buffer_store_dwordx2 v[56:57], v19, s[48:51], s14 offen offset:224
    s_nop 0
    v_mul_f32 v196, v196, v123
    v_mul_f32 v197, v197, v123
    v_mul_f32 v198, v198, v123
    v_mul_f32 v199, v199, v123
    v_cvt_pk_bf16_f32 v56, v196, v197
    v_cvt_pk_bf16_f32 v57, v198, v199
    buffer_store_dwordx2 v[56:57], v19, s[48:51], s14 offen offset:256
    s_nop 0
    v_mul_f32 v204, v204, v123
    v_mul_f32 v205, v205, v123
    v_mul_f32 v206, v206, v123
    v_mul_f32 v207, v207, v123
    v_cvt_pk_bf16_f32 v56, v204, v205
    v_cvt_pk_bf16_f32 v57, v206, v207
    buffer_store_dwordx2 v[56:57], v19, s[48:51], s14 offen offset:288
    s_nop 0
    v_mul_f32 v212, v212, v123
    v_mul_f32 v213, v213, v123
    v_mul_f32 v214, v214, v123
    v_mul_f32 v215, v215, v123
    v_cvt_pk_bf16_f32 v56, v212, v213
    v_cvt_pk_bf16_f32 v57, v214, v215
    buffer_store_dwordx2 v[56:57], v19, s[48:51], s14 offen offset:320
    s_nop 0
    v_mul_f32 v220, v220, v123
    v_mul_f32 v221, v221, v123
    v_mul_f32 v222, v222, v123
    v_mul_f32 v223, v223, v123
    v_cvt_pk_bf16_f32 v56, v220, v221
    v_cvt_pk_bf16_f32 v57, v222, v223
    buffer_store_dwordx2 v[56:57], v19, s[48:51], s14 offen offset:352
    s_nop 0
    v_mul_f32 v228, v228, v123
    v_mul_f32 v229, v229, v123
    v_mul_f32 v230, v230, v123
    v_mul_f32 v231, v231, v123
    v_cvt_pk_bf16_f32 v56, v228, v229
    v_cvt_pk_bf16_f32 v57, v230, v231
    buffer_store_dwordx2 v[56:57], v19, s[48:51], s14 offen offset:384
    s_nop 0
    v_mul_f32 v236, v236, v123
    v_mul_f32 v237, v237, v123
    v_mul_f32 v238, v238, v123
    v_mul_f32 v239, v239, v123
    v_cvt_pk_bf16_f32 v56, v236, v237
    v_cvt_pk_bf16_f32 v57, v238, v239
    buffer_store_dwordx2 v[56:57], v19, s[48:51], s14 offen offset:416
    s_nop 0
    v_mul_f32 v244, v244, v123
    v_mul_f32 v245, v245, v123
    v_mul_f32 v246, v246, v123
    v_mul_f32 v247, v247, v123
    v_cvt_pk_bf16_f32 v56, v244, v245
    v_cvt_pk_bf16_f32 v57, v246, v247
    buffer_store_dwordx2 v[56:57], v19, s[48:51], s14 offen offset:448
    s_nop 0
    v_mul_f32 v252, v252, v123
    v_mul_f32 v253, v253, v123
    v_mul_f32 v254, v254, v123
    v_mul_f32 v255, v255, v123
    v_cvt_pk_bf16_f32 v56, v252, v253
    v_cvt_pk_bf16_f32 v57, v254, v255
    buffer_store_dwordx2 v[56:57], v19, s[48:51], s14 offen offset:480
    s_nop 0
L_k2_f2:
    s_waitcnt vmcnt(0)
    s_barrier
    v_cmp_eq_u32 vcc, 0, v0
    s_and_saveexec_b64 s[80:81], vcc
    s_cbranch_execz arr_56
    buffer_wbl2 sc1
    s_waitcnt vmcnt(0)
    v_mov_b32 v1, 4
    v_mov_b32 v2, 1
    buffer_atomic_add v2, v1, s[84:87], 0 offen
    s_waitcnt vmcnt(0)
arr_56:
    s_mov_b64 exec, s[80:81]
    v_mov_b32 v1, 4
wt_57:
    buffer_load_dword v2, v1, s[84:87], 0 offen sc1
    s_waitcnt vmcnt(0)
    v_cmp_gt_u32 vcc, 212, v2
    s_cbranch_vccnz wt_57
    buffer_inv sc1
    s_waitcnt vmcnt(0)
    s_barrier
    s_mov_b32 s83, s82
L_k2_o:
    s_cmp_ge_u32 s83, 224
    s_cbranch_scc1 L_k2_end
    s_mul_hi_u32 s5, s83, 0x24924925
    s_mul_i32 s6, s5, 7
    s_sub_u32 s6, s83, s6
    s_lshl_b32 s10, s5, 6
    s_lshl_b32 s11, s6, 6
    s_add_u32 s48, s46, 117440512
    s_addc_u32 s49, s47, 0
    s_mov_b32 s52, s40
    s_mov_b32 s53, s41
    s_add_u32 s56, s42, 896
    s_addc_u32 s57, s43, 0
    s_mov_b32 s50, 0x7fffffff
    s_mov_b32 s51, 0x00020000
    s_mov_b32 s54, 0x7fffffff
    s_mov_b32 s55, 0x00020000
    s_mov_b32 s58, 0x7fffffff
    s_mov_b32 s59, 0x00020000
    s_mov_b32 s7, 8192
    s_mov_b32 s9, 896
    s_mov_b32 s13, 1792
    s_mov_b32 s8, 64
    v_lshrrev_b32 v1, 3, v0
    v_and_b32 v2, 7, v0
    v_mul_lo_u32 v3, v1, s7
    v_lshlrev_b32 v4, 4, v2
    v_add_u32 v3, v3, v4
    v_mul_u32_u24 v5, 144, v1
    v_add_u32 v5, v5, v4
    v_add_u32 v5, 0, v5
    v_lshrrev_b32 v6, 3, v0
    v_and_b32 v7, 7, v0
    v_lshlrev_b32 v8, 4, v7
    v_mul_lo_u32 v9, v6, s9
    v_add_u32 v9, v9, v8
    v_mul_u32_u24 v10, 144, v6
    v_add_u32 v10, v10, v8
    v_add_u32 v10, 9216, v10
    s_mul_i32 s60, s10, s7
    s_lshl_b32 s65, s7, 5
    s_add_u32 s61, s60, s65
    s_lshl_b32 s66, s11, 1
    s_mov_b32 s68, s66
    s_mul_i32 s65, s9, 32
    s_add_u32 s69, s68, s65
    s_lshl_b32 s67, s9, 6
    v_and_b32 v11, 63, v0
    v_lshrrev_b32 v12, 6, v0
    v_and_b32 v13, 15, v11
    v_lshrrev_b32 v14, 4, v11
    v_and_b32 v15, 1, v12
    v_lshrrev_b32 v16, 1, v12
    v_mul_u32_u24 v17, 32, v15
    v_add_u32 v17, v17, v13
    v_mul_u32_u24 v17, 144, v17
    v_lshlrev_b32 v18, 4, v14
    v_add_u32 v17, v17, v18
    v_add_u32 v17, 0, v17
    v_lshrrev_b32 v18, 2, v13
    v_lshlrev_b32 v19, 3, v14
    v_add_u32 v18, v18, v19
    v_mul_u32_u24 v18, 144, v18
    v_and_b32 v19, 3, v13
    v_lshlrev_b32 v19, 3, v19
    v_add_u32 v18, v18, v19
    v_mul_u32_u24 v19, 64, v16
    v_add_u32 v18, v18, v19
    v_add_u32 v18, 9216, v18
    v_mov_b32 v64, 0
    v_mov_b32 v65, 0
    v_mov_b32 v66, 0
    v_mov_b32 v67, 0
    v_mov_b32 v68, 0
    v_mov_b32 v69, 0
    v_mov_b32 v70, 0
    v_mov_b32 v71, 0
    v_mov_b32 v72, 0
    v_mov_b32 v73, 0
    v_mov_b32 v74, 0
    v_mov_b32 v75, 0
    v_mov_b32 v76, 0
    v_mov_b32 v77, 0
    v_mov_b32 v78, 0
    v_mov_b32 v79, 0
    buffer_load_dwordx4 v[128:131], v3, s[48:51], s60 offen
    buffer_load_dwordx4 v[132:135], v3, s[48:51], s61 offen
    buffer_load_dwordx4 v[144:147], v9, s[52:55], s68 offen
    buffer_load_dwordx4 v[148:151], v9, s[52:55], s69 offen
    v_add_u32 v3, 128, v3
    v_add_u32 v9, s67, v9
    s_waitcnt vmcnt(0)
    ds_write_b128 v5, v[128:131] offset:0
    ds_write_b128 v5, v[132:135] offset:4608
    ds_write_b128 v10, v[144:147] offset:0
    ds_write_b128 v10, v[148:151] offset:4608
    s_waitcnt lgkmcnt(0)
    s_barrier
    s_mov_b32 s72, 0
gk_58:
    s_add_u32 s73, s72, 1
    s_cmp_ge_u32 s73, s8
    s_cbranch_scc1 noload_60
    buffer_load_dwordx4 v[128:131], v3, s[48:51], s60 offen
    buffer_load_dwordx4 v[132:135], v3, s[48:51], s61 offen
    buffer_load_dwordx4 v[144:147], v9, s[52:55], s68 offen
    buffer_load_dwordx4 v[148:151], v9, s[52:55], s69 offen
    v_add_u32 v3, 128, v3
    v_add_u32 v9, s67, v9
noload_60:
    ds_read_b128 v[32:35], v17 offset:0
    ds_read_b128 v[36:39], v17 offset:2304
    ds_read_b64_tr_b16 v[48:49], v18 offset:0
    ds_read_b64_tr_b16 v[50:51], v18 offset:576
    ds_read_b64_tr_b16 v[52:53], v18 offset:32
    ds_read_b64_tr_b16 v[54:55], v18 offset:608
    s_waitcnt lgkmcnt(0)
    v_mfma_f32_16x16x32_bf16 v[64:67], v[48:51], v[32:35], v[64:67]
    v_mfma_f32_16x16x32_bf16 v[68:71], v[48:51], v[36:39], v[68:71]
    v_mfma_f32_16x16x32_bf16 v[72:75], v[52:55], v[32:35], v[72:75]
    v_mfma_f32_16x16x32_bf16 v[76:79], v[52:55], v[36:39], v[76:79]
    ds_read_b128 v[32:35], v17 offset:64
    ds_read_b128 v[36:39], v17 offset:2368
    ds_read_b64_tr_b16 v[48:49], v18 offset:4608
    ds_read_b64_tr_b16 v[50:51], v18 offset:5184
    ds_read_b64_tr_b16 v[52:53], v18 offset:4640
    ds_read_b64_tr_b16 v[54:55], v18 offset:5216
    s_waitcnt lgkmcnt(0)
    v_mfma_f32_16x16x32_bf16 v[64:67], v[48:51], v[32:35], v[64:67]
    v_mfma_f32_16x16x32_bf16 v[68:71], v[48:51], v[36:39], v[68:71]
    v_mfma_f32_16x16x32_bf16 v[72:75], v[52:55], v[32:35], v[72:75]
    v_mfma_f32_16x16x32_bf16 v[76:79], v[52:55], v[36:39], v[76:79]
    s_waitcnt vmcnt(0)
    ds_write_b128 v5, v[128:131] offset:18432
    ds_write_b128 v5, v[132:135] offset:23040
    ds_write_b128 v10, v[144:147] offset:18432
    ds_write_b128 v10, v[148:151] offset:23040
    s_waitcnt lgkmcnt(0)
    s_barrier
    s_add_u32 s72, s72, 1
    s_cmp_ge_u32 s72, s8
    s_cbranch_scc1 gkdone_59
    s_add_u32 s73, s72, 1
    s_cmp_ge_u32 s73, s8
    s_cbranch_scc1 noload_61
    buffer_load_dwordx4 v[128:131], v3, s[48:51], s60 offen
    buffer_load_dwordx4 v[132:135], v3, s[48:51], s61 offen
    buffer_load_dwordx4 v[144:147], v9, s[52:55], s68 offen
    buffer_load_dwordx4 v[148:151], v9, s[52:55], s69 offen
    v_add_u32 v3, 128, v3
    v_add_u32 v9, s67, v9
noload_61:
    ds_read_b128 v[32:35], v17 offset:18432
    ds_read_b128 v[36:39], v17 offset:20736
    ds_read_b64_tr_b16 v[48:49], v18 offset:18432
    ds_read_b64_tr_b16 v[50:51], v18 offset:19008
    ds_read_b64_tr_b16 v[52:53], v18 offset:18464
    ds_read_b64_tr_b16 v[54:55], v18 offset:19040
    s_waitcnt lgkmcnt(0)
    v_mfma_f32_16x16x32_bf16 v[64:67], v[48:51], v[32:35], v[64:67]
    v_mfma_f32_16x16x32_bf16 v[68:71], v[48:51], v[36:39], v[68:71]
    v_mfma_f32_16x16x32_bf16 v[72:75], v[52:55], v[32:35], v[72:75]
    v_mfma_f32_16x16x32_bf16 v[76:79], v[52:55], v[36:39], v[76:79]
    ds_read_b128 v[32:35], v17 offset:18496
    ds_read_b128 v[36:39], v17 offset:20800
    ds_read_b64_tr_b16 v[48:49], v18 offset:23040
    ds_read_b64_tr_b16 v[50:51], v18 offset:23616
    ds_read_b64_tr_b16 v[52:53], v18 offset:23072
    ds_read_b64_tr_b16 v[54:55], v18 offset:23648
    s_waitcnt lgkmcnt(0)
    v_mfma_f32_16x16x32_bf16 v[64:67], v[48:51], v[32:35], v[64:67]
    v_mfma_f32_16x16x32_bf16 v[68:71], v[48:51], v[36:39], v[68:71]
    v_mfma_f32_16x16x32_bf16 v[72:75], v[52:55], v[32:35], v[72:75]
    v_mfma_f32_16x16x32_bf16 v[76:79], v[52:55], v[36:39], v[76:79]
    s_waitcnt vmcnt(0)
    ds_write_b128 v5, v[128:131] offset:0
    ds_write_b128 v5, v[132:135] offset:4608
    ds_write_b128 v10, v[144:147] offset:0
    ds_write_b128 v10, v[148:151] offset:4608
    s_waitcnt lgkmcnt(0)
    s_barrier
    s_add_u32 s72, s72, 1
    s_cmp_ge_u32 s72, s8
    s_cbranch_scc1 gkdone_59
    s_branch gk_58
gkdone_59:
    s_nop 7
    s_nop 7
    v_mul_u32_u24 v20, 32, v15
    v_add_u32 v20, v20, v13
    v_mul_lo_u32 v20, v20, s13
    v_mul_u32_u24 v21, 64, v16
    v_lshlrev_b32 v22, 3, v14
    v_add3_u32 v20, v20, v21, v22
    s_mul_i32 s74, s10, s13
    s_add_u32 s74, s74, s66
    s_lshl_b32 s76, s13, 4
    v_cvt_pk_bf16_f32 v24, v64, v65
    v_cvt_pk_bf16_f32 v25, v66, v67
    buffer_store_dwordx2 v[24:25], v20, s[56:59], s74 offen offset:0
    v_cvt_pk_bf16_f32 v24, v72, v73
    v_cvt_pk_bf16_f32 v25, v74, v75
    buffer_store_dwordx2 v[24:25], v20, s[56:59], s74 offen offset:32
    s_add_u32 s74, s74, s76
    v_cvt_pk_bf16_f32 v24, v68, v69
    v_cvt_pk_bf16_f32 v25, v70, v71
    buffer_store_dwordx2 v[24:25], v20, s[56:59], s74 offen offset:0
    v_cvt_pk_bf16_f32 v24, v76, v77
    v_cvt_pk_bf16_f32 v25, v78, v79
    buffer_store_dwordx2 v[24:25], v20, s[56:59], s74 offen offset:32
    s_barrier
    s_add_u32 s83, s83, 212
    s_branch L_k2_o
L_k2_end:
L_k2_end2:
    s_endpgm
    .globl k3_kmvm_kernel
    .p2align 8
    .type k3_kmvm_kernel,@function
k3_kmvm_kernel:
    s_load_dwordx16 s[16:31], s[0:1], 0
    s_load_dwordx16 s[32:47], s[0:1], 64
    s_waitcnt lgkmcnt(0)
    s_cmp_ge_u32 s2, 256
    s_cbranch_scc1 L_k3_end
    s_lshr_b32 s3, s2, 7
    s_and_b32 s4, s2, 127
    s_lshr_b32 s5, s4, 5
    s_lshl_b32 s5, s5, 7
    s_and_b32 s6, s4, 31
    s_lshl_b32 s6, s6, 7
    s_add_u32 s48, s46, 142606336
    s_addc_u32 s49, s47, 0
    s_cmp_eq_u32 s3, 0
    s_cselect_b32 s52, s22, s24
    s_cselect_b32 s53, s23, s25
    s_mov_b32 s13, 147849216
    s_cselect_b32 s12, 143654912, s13
    s_add_u32 s56, s46, s12
    s_addc_u32 s57, s47, 0
    s_mov_b32 s50, 0x7fffffff
    s_mov_b32 s51, 0x00020000
    s_mov_b32 s54, 0x7fffffff
    s_mov_b32 s55, 0x00020000
    s_mov_b32 s58, 0x7fffffff
    s_mov_b32 s59, 0x00020000
    s_mov_b32 s7, 896
    s_mov_b32 s8, 7
    s_mov_b32 s9, 8192
    v_lshrrev_b32 v1, 3, v0
    v_and_b32 v2, 7, v0
    v_mul_lo_u32 v3, v1, s7
    v_lshlrev_b32 v4, 4, v2
    v_add_u32 v3, v3, v4
    v_mul_u32_u24 v5, 144, v1
    v_add_u32 v5, v5, v4
    v_add_u32 v5, 0, v5
    v_lshrrev_b32 v6, 4, v0
    v_and_b32 v7, 15, v0
    v_lshlrev_b32 v8, 4, v7
    v_mul_lo_u32 v9, v6, s9
    v_add_u32 v9, v9, v8
    v_mul_u32_u24 v10, 272, v6
    v_add_u32 v10, v10, v8
    v_add_u32 v10, 18432, v10
    s_mul_i32 s60, s5, s7
    s_lshl_b32 s65, s7, 5
    s_add_u32 s61, s60, s65
    s_add_u32 s62, s61, s65
    s_add_u32 s63, s62, s65
    s_lshl_b32 s66, s6, 1
    s_mov_b32 s68, s66
    s_mul_i32 s65, s9, 16
    s_add_u32 s69, s68, s65
    s_add_u32 s70, s69, s65
    s_add_u32 s71, s70, s65
    s_lshl_b32 s67, s9, 6
    v_and_b32 v11, 63, v0
    v_lshrrev_b32 v12, 6, v0
    v_and_b32 v13, 15, v11
    v_lshrrev_b32 v14, 4, v11
    v_and_b32 v15, 1, v12
    v_lshrrev_b32 v16, 1, v12
    v_mul_u32_u24 v17, 64, v15
    v_add_u32 v17, v17, v13
    v_mul_u32_u24 v17, 144, v17
    v_lshlrev_b32 v18, 4, v14
    v_add_u32 v17, v17, v18
    v_add_u32 v17, 0, v17
    v_lshrrev_b32 v18, 2, v13
    v_lshlrev_b32 v19, 3, v14
    v_add_u32 v18, v18, v19
    v_mul_u32_u24 v18, 272, v18
    v_and_b32 v19, 3, v13
    v_lshlrev_b32 v19, 3, v19
    v_add_u32 v18, v18, v19
    v_mul_u32_u24 v19, 128, v16
    v_add_u32 v18, v18, v19
    v_add_u32 v18, 18432, v18
    v_mov_b32 v64, 0
    v_mov_b32 v65, 0
    v_mov_b32 v66, 0
    v_mov_b32 v67, 0
    v_mov_b32 v68, 0
    v_mov_b32 v69, 0
    v_mov_b32 v70, 0
    v_mov_b32 v71, 0
    v_mov_b32 v72, 0
    v_mov_b32 v73, 0
    v_mov_b32 v74, 0
    v_mov_b32 v75, 0
    v_mov_b32 v76, 0
    v_mov_b32 v77, 0
    v_mov_b32 v78, 0
    v_mov_b32 v79, 0
    v_mov_b32 v80, 0
    v_mov_b32 v81, 0
    v_mov_b32 v82, 0
    v_mov_b32 v83, 0
    v_mov_b32 v84, 0
    v_mov_b32 v85, 0
    v_mov_b32 v86, 0
    v_mov_b32 v87, 0
    v_mov_b32 v88, 0
    v_mov_b32 v89, 0
    v_mov_b32 v90, 0
    v_mov_b32 v91, 0
    v_mov_b32 v92, 0
    v_mov_b32 v93, 0
    v_mov_b32 v94, 0
    v_mov_b32 v95, 0
    v_mov_b32 v96, 0
    v_mov_b32 v97, 0
    v_mov_b32 v98, 0
    v_mov_b32 v99, 0
    v_mov_b32 v100, 0
    v_mov_b32 v101, 0
    v_mov_b32 v102, 0
    v_mov_b32 v103, 0
    v_mov_b32 v104, 0
    v_mov_b32 v105, 0
    v_mov_b32 v106, 0
    v_mov_b32 v107, 0
    v_mov_b32 v108, 0
    v_mov_b32 v109, 0
    v_mov_b32 v110, 0
    v_mov_b32 v111, 0
    v_mov_b32 v112, 0
    v_mov_b32 v113, 0
    v_mov_b32 v114, 0
    v_mov_b32 v115, 0
    v_mov_b32 v116, 0
    v_mov_b32 v117, 0
    v_mov_b32 v118, 0
    v_mov_b32 v119, 0
    v_mov_b32 v120, 0
    v_mov_b32 v121, 0
    v_mov_b32 v122, 0
    v_mov_b32 v123, 0
    v_mov_b32 v124, 0
    v_mov_b32 v125, 0
    v_mov_b32 v126, 0
    v_mov_b32 v127, 0
    buffer_load_dwordx4 v[128:131], v3, s[48:51], s60 offen
    buffer_load_dwordx4 v[132:135], v3, s[48:51], s61 offen
    buffer_load_dwordx4 v[136:139], v3, s[48:51], s62 offen
    buffer_load_dwordx4 v[140:143], v3, s[48:51], s63 offen
    buffer_load_dwordx4 v[144:147], v9, s[52:55], s68 offen
    buffer_load_dwordx4 v[148:151], v9, s[52:55], s69 offen
    buffer_load_dwordx4 v[152:155], v9, s[52:55], s70 offen
    buffer_load_dwordx4 v[156:159], v9, s[52:55], s71 offen
    v_add_u32 v3, 128, v3
    v_add_u32 v9, s67, v9
    s_waitcnt vmcnt(0)
    ds_write_b128 v5, v[128:131] offset:0
    ds_write_b128 v5, v[132:135] offset:4608
    ds_write_b128 v5, v[136:139] offset:9216
    ds_write_b128 v5, v[140:143] offset:13824
    ds_write_b128 v10, v[144:147] offset:0
    ds_write_b128 v10, v[148:151] offset:4352
    ds_write_b128 v10, v[152:155] offset:8704
    ds_write_b128 v10, v[156:159] offset:13056
    s_waitcnt lgkmcnt(0)
    s_barrier
    s_mov_b32 s72, 0
gk_62:
    s_add_u32 s73, s72, 1
    s_cmp_ge_u32 s73, s8
    s_cbranch_scc1 noload_64
    buffer_load_dwordx4 v[128:131], v3, s[48:51], s60 offen
    buffer_load_dwordx4 v[132:135], v3, s[48:51], s61 offen
    buffer_load_dwordx4 v[136:139], v3, s[48:51], s62 offen
    buffer_load_dwordx4 v[140:143], v3, s[48:51], s63 offen
    buffer_load_dwordx4 v[144:147], v9, s[52:55], s68 offen
    buffer_load_dwordx4 v[148:151], v9, s[52:55], s69 offen
    buffer_load_dwordx4 v[152:155], v9, s[52:55], s70 offen
    buffer_load_dwordx4 v[156:159], v9, s[52:55], s71 offen
    v_add_u32 v3, 128, v3
    v_add_u32 v9, s67, v9
noload_64:
    ds_read_b128 v[32:35], v17 offset:0
    ds_read_b128 v[36:39], v17 offset:2304
    ds_read_b128 v[40:43], v17 offset:4608
    ds_read_b128 v[44:47], v17 offset:6912
    ds_read_b64_tr_b16 v[48:49], v18 offset:0
    ds_read_b64_tr_b16 v[50:51], v18 offset:1088
    ds_read_b64_tr_b16 v[52:53], v18 offset:32
    ds_read_b64_tr_b16 v[54:55], v18 offset:1120
    ds_read_b64_tr_b16 v[56:57], v18 offset:64
    ds_read_b64_tr_b16 v[58:59], v18 offset:1152
    ds_read_b64_tr_b16 v[60:61], v18 offset:96
    ds_read_b64_tr_b16 v[62:63], v18 offset:1184
    s_waitcnt lgkmcnt(0)
    v_mfma_f32_16x16x32_bf16 v[64:67], v[48:51], v[32:35], v[64:67]
    v_mfma_f32_16x16x32_bf16 v[68:71], v[48:51], v[36:39], v[68:71]
    v_mfma_f32_16x16x32_bf16 v[72:75], v[48:51], v[40:43], v[72:75]
    v_mfma_f32_16x16x32_bf16 v[76:79], v[48:51], v[44:47], v[76:79]
    v_mfma_f32_16x16x32_bf16 v[80:83], v[52:55], v[32:35], v[80:83]
    v_mfma_f32_16x16x32_bf16 v[84:87], v[52:55], v[36:39], v[84:87]
    v_mfma_f32_16x16x32_bf16 v[88:91], v[52:55], v[40:43], v[88:91]
    v_mfma_f32_16x16x32_bf16 v[92:95], v[52:55], v[44:47], v[92:95]
    v_mfma_f32_16x16x32_bf16 v[96:99], v[56:59], v[32:35], v[96:99]
    v_mfma_f32_16x16x32_bf16 v[100:103], v[56:59], v[36:39], v[100:103]
    v_mfma_f32_16x16x32_bf16 v[104:107], v[56:59], v[40:43], v[104:107]
    v_mfma_f32_16x16x32_bf16 v[108:111], v[56:59], v[44:47], v[108:111]
    v_mfma_f32_16x16x32_bf16 v[112:115], v[60:63], v[32:35], v[112:115]
    v_mfma_f32_16x16x32_bf16 v[116:119], v[60:63], v[36:39], v[116:119]
    v_mfma_f32_16x16x32_bf16 v[120:123], v[60:63], v[40:43], v[120:123]
    v_mfma_f32_16x16x32_bf16 v[124:127], v[60:63], v[44:47], v[124:127]
    ds_read_b128 v[32:35], v17 offset:64
    ds_read_b128 v[36:39], v17 offset:2368
    ds_read_b128 v[40:43], v17 offset:4672
    ds_read_b128 v[44:47], v17 offset:6976
    ds_read_b64_tr_b16 v[48:49], v18 offset:8704
    ds_read_b64_tr_b16 v[50:51], v18 offset:9792
    ds_read_b64_tr_b16 v[52:53], v18 offset:8736
    ds_read_b64_tr_b16 v[54:55], v18 offset:9824
    ds_read_b64_tr_b16 v[56:57], v18 offset:8768
    ds_read_b64_tr_b16 v[58:59], v18 offset:9856
    ds_read_b64_tr_b16 v[60:61], v18 offset:8800
    ds_read_b64_tr_b16 v[62:63], v18 offset:9888
    s_waitcnt lgkmcnt(0)
    v_mfma_f32_16x16x32_bf16 v[64:67], v[48:51], v[32:35], v[64:67]
    v_mfma_f32_16x16x32_bf16 v[68:71], v[48:51], v[36:39], v[68:71]
    v_mfma_f32_16x16x32_bf16 v[72:75], v[48:51], v[40:43], v[72:75]
    v_mfma_f32_16x16x32_bf16 v[76:79], v[48:51], v[44:47], v[76:79]
    v_mfma_f32_16x16x32_bf16 v[80:83], v[52:55], v[32:35], v[80:83]
    v_mfma_f32_16x16x32_bf16 v[84:87], v[52:55], v[36:39], v[84:87]
    v_mfma_f32_16x16x32_bf16 v[88:91], v[52:55], v[40:43], v[88:91]
    v_mfma_f32_16x16x32_bf16 v[92:95], v[52:55], v[44:47], v[92:95]
    v_mfma_f32_16x16x32_bf16 v[96:99], v[56:59], v[32:35], v[96:99]
    v_mfma_f32_16x16x32_bf16 v[100:103], v[56:59], v[36:39], v[100:103]
    v_mfma_f32_16x16x32_bf16 v[104:107], v[56:59], v[40:43], v[104:107]
    v_mfma_f32_16x16x32_bf16 v[108:111], v[56:59], v[44:47], v[108:111]
    v_mfma_f32_16x16x32_bf16 v[112:115], v[60:63], v[32:35], v[112:115]
    v_mfma_f32_16x16x32_bf16 v[116:119], v[60:63], v[36:39], v[116:119]
    v_mfma_f32_16x16x32_bf16 v[120:123], v[60:63], v[40:43], v[120:123]
    v_mfma_f32_16x16x32_bf16 v[124:127], v[60:63], v[44:47], v[124:127]
    s_waitcnt vmcnt(0)
    ds_write_b128 v5, v[128:131] offset:35840
    ds_write_b128 v5, v[132:135] offset:40448
    ds_write_b128 v5, v[136:139] offset:45056
    ds_write_b128 v5, v[140:143] offset:49664
    ds_write_b128 v10, v[144:147] offset:35840
    ds_write_b128 v10, v[148:151] offset:40192
    ds_write_b128 v10, v[152:155] offset:44544
    ds_write_b128 v10, v[156:159] offset:48896
    s_waitcnt lgkmcnt(0)
    s_barrier
    s_add_u32 s72, s72, 1
    s_cmp_ge_u32 s72, s8
    s_cbranch_scc1 gkdone_63
    s_add_u32 s73, s72, 1
    s_cmp_ge_u32 s73, s8
    s_cbranch_scc1 noload_65
    buffer_load_dwordx4 v[128:131], v3, s[48:51], s60 offen
    buffer_load_dwordx4 v[132:135], v3, s[48:51], s61 offen
    buffer_load_dwordx4 v[136:139], v3, s[48:51], s62 offen
    buffer_load_dwordx4 v[140:143], v3, s[48:51], s63 offen
    buffer_load_dwordx4 v[144:147], v9, s[52:55], s68 offen
    buffer_load_dwordx4 v[148:151], v9, s[52:55], s69 offen
    buffer_load_dwordx4 v[152:155], v9, s[52:55], s70 offen
    buffer_load_dwordx4 v[156:159], v9, s[52:55], s71 offen
    v_add_u32 v3, 128, v3
    v_add_u32 v9, s67, v9
noload_65:
    ds_read_b128 v[32:35], v17 offset:35840
    ds_read_b128 v[36:39], v17 offset:38144
    ds_read_b128 v[40:43], v17 offset:40448
    ds_read_b128 v[44:47], v17 offset:42752
    ds_read_b64_tr_b16 v[48:49], v18 offset:35840
    ds_read_b64_tr_b16 v[50:51], v18 offset:36928
    ds_read_b64_tr_b16 v[52:53], v18 offset:35872
    ds_read_b64_tr_b16 v[54:55], v18 offset:36960
    ds_read_b64_tr_b16 v[56:57], v18 offset:35904
    ds_read_b64_tr_b16 v[58:59], v18 offset:36992
    ds_read_b64_tr_b16 v[60:61], v18 offset:35936
    ds_read_b64_tr_b16 v[62:63], v18 offset:37024
    s_waitcnt lgkmcnt(0)
    v_mfma_f32_16x16x32_bf16 v[64:67], v[48:51], v[32:35], v[64:67]
    v_mfma_f32_16x16x32_bf16 v[68:71], v[48:51], v[36:39], v[68:71]
    v_mfma_f32_16x16x32_bf16 v[72:75], v[48:51], v[40:43], v[72:75]
    v_mfma_f32_16x16x32_bf16 v[76:79], v[48:51], v[44:47], v[76:79]
    v_mfma_f32_16x16x32_bf16 v[80:83], v[52:55], v[32:35], v[80:83]
    v_mfma_f32_16x16x32_bf16 v[84:87], v[52:55], v[36:39], v[84:87]
    v_mfma_f32_16x16x32_bf16 v[88:91], v[52:55], v[40:43], v[88:91]
    v_mfma_f32_16x16x32_bf16 v[92:95], v[52:55], v[44:47], v[92:95]
    v_mfma_f32_16x16x32_bf16 v[96:99], v[56:59], v[32:35], v[96:99]
    v_mfma_f32_16x16x32_bf16 v[100:103], v[56:59], v[36:39], v[100:103]
    v_mfma_f32_16x16x32_bf16 v[104:107], v[56:59], v[40:43], v[104:107]
    v_mfma_f32_16x16x32_bf16 v[108:111], v[56:59], v[44:47], v[108:111]
    v_mfma_f32_16x16x32_bf16 v[112:115], v[60:63], v[32:35], v[112:115]
    v_mfma_f32_16x16x32_bf16 v[116:119], v[60:63], v[36:39], v[116:119]
    v_mfma_f32_16x16x32_bf16 v[120:123], v[60:63], v[40:43], v[120:123]
    v_mfma_f32_16x16x32_bf16 v[124:127], v[60:63], v[44:47], v[124:127]
    ds_read_b128 v[32:35], v17 offset:35904
    ds_read_b128 v[36:39], v17 offset:38208
    ds_read_b128 v[40:43], v17 offset:40512
    ds_read_b128 v[44:47], v17 offset:42816
    ds_read_b64_tr_b16 v[48:49], v18 offset:44544
    ds_read_b64_tr_b16 v[50:51], v18 offset:45632
    ds_read_b64_tr_b16 v[52:53], v18 offset:44576
    ds_read_b64_tr_b16 v[54:55], v18 offset:45664
    ds_read_b64_tr_b16 v[56:57], v18 offset:44608
    ds_read_b64_tr_b16 v[58:59], v18 offset:45696
    ds_read_b64_tr_b16 v[60:61], v18 offset:44640
    ds_read_b64_tr_b16 v[62:63], v18 offset:45728
    s_waitcnt lgkmcnt(0)
    v_mfma_f32_16x16x32_bf16 v[64:67], v[48:51], v[32:35], v[64:67]
    v_mfma_f32_16x16x32_bf16 v[68:71], v[48:51], v[36:39], v[68:71]
    v_mfma_f32_16x16x32_bf16 v[72:75], v[48:51], v[40:43], v[72:75]
    v_mfma_f32_16x16x32_bf16 v[76:79], v[48:51], v[44:47], v[76:79]
    v_mfma_f32_16x16x32_bf16 v[80:83], v[52:55], v[32:35], v[80:83]
    v_mfma_f32_16x16x32_bf16 v[84:87], v[52:55], v[36:39], v[84:87]
    v_mfma_f32_16x16x32_bf16 v[88:91], v[52:55], v[40:43], v[88:91]
    v_mfma_f32_16x16x32_bf16 v[92:95], v[52:55], v[44:47], v[92:95]
    v_mfma_f32_16x16x32_bf16 v[96:99], v[56:59], v[32:35], v[96:99]
    v_mfma_f32_16x16x32_bf16 v[100:103], v[56:59], v[36:39], v[100:103]
    v_mfma_f32_16x16x32_bf16 v[104:107], v[56:59], v[40:43], v[104:107]
    v_mfma_f32_16x16x32_bf16 v[108:111], v[56:59], v[44:47], v[108:111]
    v_mfma_f32_16x16x32_bf16 v[112:115], v[60:63], v[32:35], v[112:115]
    v_mfma_f32_16x16x32_bf16 v[116:119], v[60:63], v[36:39], v[116:119]
    v_mfma_f32_16x16x32_bf16 v[120:123], v[60:63], v[40:43], v[120:123]
    v_mfma_f32_16x16x32_bf16 v[124:127], v[60:63], v[44:47], v[124:127]
    s_waitcnt vmcnt(0)
    ds_write_b128 v5, v[128:131] offset:0
    ds_write_b128 v5, v[132:135] offset:4608
    ds_write_b128 v5, v[136:139] offset:9216
    ds_write_b128 v5, v[140:143] offset:13824
    ds_write_b128 v10, v[144:147] offset:0
    ds_write_b128 v10, v[148:151] offset:4352
    ds_write_b128 v10, v[152:155] offset:8704
    ds_write_b128 v10, v[156:159] offset:13056
    s_waitcnt lgkmcnt(0)
    s_barrier
    s_add_u32 s72, s72, 1
    s_cmp_ge_u32 s72, s8
    s_cbranch_scc1 gkdone_63
    s_branch gk_62
gkdone_63:
    s_nop 7
    s_nop 7
    v_mul_u32_u24 v20, 64, v15
    v_add_u32 v20, v20, v13
    v_mul_lo_u32 v20, v20, s9
    v_mul_u32_u24 v21, 128, v16
    v_lshlrev_b32 v22, 3, v14
    v_add3_u32 v20, v20, v21, v22
    s_mul_i32 s74, s5, s9
    s_add_u32 s74, s74, s66
    s_lshl_b32 s76, s9, 4
    v_cvt_pk_bf16_f32 v24, v64, v65
    v_cvt_pk_bf16_f32 v25, v66, v67
    buffer_store_dwordx2 v[24:25], v20, s[56:59], s74 offen offset:0
    v_cvt_pk_bf16_f32 v24, v80, v81
    v_cvt_pk_bf16_f32 v25, v82, v83
    buffer_store_dwordx2 v[24:25], v20, s[56:59], s74 offen offset:32
    v_cvt_pk_bf16_f32 v24, v96, v97
    v_cvt_pk_bf16_f32 v25, v98, v99
    buffer_store_dwordx2 v[24:25], v20, s[56:59], s74 offen offset:64
    v_cvt_pk_bf16_f32 v24, v112, v113
    v_cvt_pk_bf16_f32 v25, v114, v115
    buffer_store_dwordx2 v[24:25], v20, s[56:59], s74 offen offset:96
    s_add_u32 s74, s74, s76
    v_cvt_pk_bf16_f32 v24, v68, v69
    v_cvt_pk_bf16_f32 v25, v70, v71
    buffer_store_dwordx2 v[24:25], v20, s[56:59], s74 offen offset:0
    v_cvt_pk_bf16_f32 v24, v84, v85
    v_cvt_pk_bf16_f32 v25, v86, v87
    buffer_store_dwordx2 v[24:25], v20, s[56:59], s74 offen offset:32
    v_cvt_pk_bf16_f32 v24, v100, v101
    v_cvt_pk_bf16_f32 v25, v102, v103
    buffer_store_dwordx2 v[24:25], v20, s[56:59], s74 offen offset:64
    v_cvt_pk_bf16_f32 v24, v116, v117
    v_cvt_pk_bf16_f32 v25, v118, v119
    buffer_store_dwordx2 v[24:25], v20, s[56:59], s74 offen offset:96
    s_add_u32 s74, s74, s76
    v_cvt_pk_bf16_f32 v24, v72, v73
    v_cvt_pk_bf16_f32 v25, v74, v75
    buffer_store_dwordx2 v[24:25], v20, s[56:59], s74 offen offset:0
    v_cvt_pk_bf16_f32 v24, v88, v89
    v_cvt_pk_bf16_f32 v25, v90, v91
    buffer_store_dwordx2 v[24:25], v20, s[56:59], s74 offen offset:32
    v_cvt_pk_bf16_f32 v24, v104, v105
    v_cvt_pk_bf16_f32 v25, v106, v107
    buffer_store_dwordx2 v[24:25], v20, s[56:59], s74 offen offset:64
    v_cvt_pk_bf16_f32 v24, v120, v121
    v_cvt_pk_bf16_f32 v25, v122, v123
    buffer_store_dwordx2 v[24:25], v20, s[56:59], s74 offen offset:96
    s_add_u32 s74, s74, s76
    v_cvt_pk_bf16_f32 v24, v76, v77
    v_cvt_pk_bf16_f32 v25, v78, v79
    buffer_store_dwordx2 v[24:25], v20, s[56:59], s74 offen offset:0
    v_cvt_pk_bf16_f32 v24, v92, v93
    v_cvt_pk_bf16_f32 v25, v94, v95
    buffer_store_dwordx2 v[24:25], v20, s[56:59], s74 offen offset:32
    v_cvt_pk_bf16_f32 v24, v108, v109
    v_cvt_pk_bf16_f32 v25, v110, v111
    buffer_store_dwordx2 v[24:25], v20, s[56:59], s74 offen offset:64
    v_cvt_pk_bf16_f32 v24, v124, v125
    v_cvt_pk_bf16_f32 v25, v126, v127
    buffer_store_dwordx2 v[24:25], v20, s[56:59], s74 offen offset:96
L_k3_end:
    s_endpgm
    .globl k4_xattn_kernel
    .p2align 8
    .type k4_xattn_kernel,@function
k4_xattn_kernel:
    s_load_dwordx16 s[16:31], s[0:1], 0
    s_load_dwordx16 s[32:47], s[0:1], 64
    s_waitcnt lgkmcnt(0)
    s_cmp_ge_u32 s2, 256
    s_cbranch_scc1 L_k4_end
    s_mov_b32 s48, s46
    s_mov_b32 s49, s47
    s_mov_b32 s50, 0x7fffffff
    s_mov_b32 s51, 0x00020000
    v_and_b32 v1, 63, v0
    v_lshrrev_b32 v2, 6, v0
    s_nop 1
    v_readfirstlane_b32 s3, v2
    v_and_b32 v3, 15, v1
    v_lshrrev_b32 v4, 4, v1
    s_lshl_b32 s4, s2, 2
    s_add_u32 s4, s4, s3
    s_lshr_b32 s5, s4, 4
    s_and_b32 s6, s4, 15
    s_lshl_b32 s7, s6, 9
    v_xor_b32 v5, 16, v1
    v_lshlrev_b32 v5, 2, v5
    v_xor_b32 v6, 32, v1
    v_lshlrev_b32 v6, 2, v6
    v_lshlrev_b32 v7, 13, v3
    v_lshlrev_b32 v8, 4, v4
    v_add_u32 v7, v7, v8
    s_lshl_b32 s8, s5, 18
    s_add_u32 s8, s8, s7
    s_lshl_b32 s9, s5, 16
    s_add_u32 s9, s9, s7
    s_add_u32 s9, s9, 143654912
    v_lshlrev_b32 v9, 13, v3
    v_add_u32 v10, s9, v9
    s_add_u32 s10, s8, 16777216
    v_add_u32 v11, s10, v9
    v_subrev_u32 v11, 65536, v11
    v_cmp_gt_u32 vcc, 8, v3
    s_nop 1
    v_cndmask_b32 v10, v11, v10, vcc
    v_add_u32 v10, v10, v8
    v_add_u32 v11, s10, v9
    v_add_u32 v11, 65536, v11
    v_add_u32 v11, v11, v8
    v_and_b32 v12, 7, v3
    v_lshlrev_b32 v12, 13, v12
    v_add_u32 v12, s10, v12
    v_add_u32 v12, 196608, v12
    v_add_u32 v12, v12, v8
    s_add_u32 s11, s8, 0
    buffer_load_dwordx4 v[64:67], v7, s[48:51], s11 offen offset:0
    buffer_load_dwordx4 v[68:71], v7, s[48:51], s11 offen offset:64
    buffer_load_dwordx4 v[72:75], v7, s[48:51], s11 offen offset:128
    buffer_load_dwordx4 v[76:79], v7, s[48:51], s11 offen offset:192
    buffer_load_dwordx4 v[80:83], v7, s[48:51], s11 offen offset:256
    buffer_load_dwordx4 v[84:87], v7, s[48:51], s11 offen offset:320
    buffer_load_dwordx4 v[88:91], v7, s[48:51], s11 offen offset:384
    buffer_load_dwordx4 v[92:95], v7, s[48:51], s11 offen offset:448
    s_add_u32 s11, s8, 131072
    buffer_load_dwordx4 v[96:99], v7, s[48:51], s11 offen offset:0
    buffer_load_dwordx4 v[100:103], v7, s[48:51], s11 offen offset:64
    buffer_load_dwordx4 v[104:107], v7, s[48:51], s11 offen offset:128
    buffer_load_dwordx4 v[108:111], v7, s[48:51], s11 offen offset:192
    buffer_load_dwordx4 v[112:115], v7, s[48:51], s11 offen offset:256
    buffer_load_dwordx4 v[116:119], v7, s[48:51], s11 offen offset:320
    buffer_load_dwordx4 v[120:123], v7, s[48:51], s11 offen offset:384
    buffer_load_dwordx4 v[124:127], v7, s[48:51], s11 offen offset:448
    s_mul_i32 s12, s3, 25344
    v_lshrrev_b32 v13, 5, v1
    v_and_b32 v14, 31, v1
    v_lshlrev_b32 v14, 4, v14
    v_mul_u32_u24 v15, 528, v13
    v_add_u32 v15, v15, v14
    v_add_u32 v15, s12, v15
    v_lshlrev_b32 v16, 13, v13
    v_add_u32 v16, v16, v14
    s_lshl_b32 s13, s5, 16
    s_add_u32 s13, s13, s7
    s_add_u32 s13, s13, 147849216
    s_add_u32 s14, s8, 33554432
    s_add_u32 s15, s13, 0
    buffer_load_dwordx4 v[32:35], v16, s[48:51], s15 offen
    s_add_u32 s15, s13, 16384
    buffer_load_dwordx4 v[36:39], v16, s[48:51], s15 offen
    s_add_u32 s15, s13, 32768
    buffer_load_dwordx4 v[40:43], v16, s[48:51], s15 offen
    s_add_u32 s15, s13, 49152
    buffer_load_dwordx4 v[44:47], v16, s[48:51], s15 offen
    s_waitcnt vmcnt(0)
    ds_write_b128 v15, v[32:35] offset:0
    ds_write_b128 v15, v[36:39] offset:1056
    ds_write_b128 v15, v[40:43] offset:2112
    ds_write_b128 v15, v[44:47] offset:3168
    s_add_u32 s15, s14, 0
    buffer_load_dwordx4 v[32:35], v16, s[48:51], s15 offen
    s_add_u32 s15, s14, 16384
    buffer_load_dwordx4 v[36:39], v16, s[48:51], s15 offen
    s_add_u32 s15, s14, 32768
    buffer_load_dwordx4 v[40:43], v16, s[48:51], s15 offen
    s_add_u32 s15, s14, 49152
    buffer_load_dwordx4 v[44:47], v16, s[48:51], s15 offen
    s_waitcnt vmcnt(0)
    ds_write_b128 v15, v[32:35] offset:4224
    ds_write_b128 v15, v[36:39] offset:5280
    ds_write_b128 v15, v[40:43] offset:6336
    ds_write_b128 v15, v[44:47] offset:7392
    s_add_u32 s15, s14, 65536
    buffer_load_dwordx4 v[32:35], v16, s[48:51], s15 offen
    s_add_u32 s15, s14, 81920
    buffer_load_dwordx4 v[36:39], v16, s[48:51], s15 offen
    s_add_u32 s15, s14, 98304
    buffer_load_dwordx4 v[40:43], v16, s[48:51], s15 offen
    s_add_u32 s15, s14, 114688
    buffer_load_dwordx4 v[44:47], v16, s[48:51], s15 offen
    s_waitcnt vmcnt(0)
    ds_write_b128 v15, v[32:35] offset:8448
    ds_write_b128 v15, v[36:39] offset:9504
    ds_write_b128 v15, v[40:43] offset:10560
    ds_write_b128 v15, v[44:47] offset:11616
    s_add_u32 s15, s14, 131072
    buffer_load_dwordx4 v[32:35], v16, s[48:51], s15 offen
    s_add_u32 s15, s14, 147456
    buffer_load_dwordx4 v[36:39], v16, s[48:51], s15 offen
    s_add_u32 s15, s14, 163840
    buffer_load_dwordx4 v[40:43], v16, s[48:51], s15 offen
    s_add_u32 s15, s14, 180224
    buffer_load_dwordx4 v[44:47], v16, s[48:51], s15 offen
    s_waitcnt vmcnt(0)
    ds_write_b128 v15, v[32:35] offset:12672
    ds_write_b128 v15, v[36:39] offset:13728
    ds_write_b128 v15, v[40:43] offset:14784
    ds_write_b128 v15, v[44:47] offset:15840
    s_add_u32 s15, s14, 196608
    buffer_load_dwordx4 v[32:35], v16, s[48:51], s15 offen
    s_add_u32 s15, s14, 212992
    buffer_load_dwordx4 v[36:39], v16, s[48:51], s15 offen
    s_add_u32 s15, s14, 229376
    buffer_load_dwordx4 v[40:43], v16, s[48:51], s15 offen
    s_add_u32 s15, s14, 245760
    buffer_load_dwordx4 v[44:47], v16, s[48:51], s15 offen
    s_waitcnt vmcnt(0)
    ds_write_b128 v15, v[32:35] offset:16896
    ds_write_b128 v15, v[36:39] offset:17952
    ds_write_b128 v15, v[40:43] offset:19008
    ds_write_b128 v15, v[44:47] offset:20064
    v_mov_b32 v32, 0
    v_mov_b32 v33, 0
    v_mov_b32 v34, 0
    v_mov_b32 v35, 0
    ds_write_b128 v15, v[32:35] offset:21120
    ds_write_b128 v15, v[32:35] offset:22176
    ds_write_b128 v15, v[32:35] offset:23232
    ds_write_b128 v15, v[32:35] offset:24288
    v_mov_b32 v128, 0
    v_mov_b32 v129, 0
    v_mov_b32 v130, 0
    v_mov_b32 v131, 0
    v_mov_b32 v132, 0
    v_mov_b32 v133, 0
    v_mov_b32 v134, 0
    v_mov_b32 v135, 0
    v_mov_b32 v136, 0
    v_mov_b32 v137, 0
    v_mov_b32 v138, 0
    v_mov_b32 v139, 0
    v_mov_b32 v140, 0
    v_mov_b32 v141, 0
    v_mov_b32 v142, 0
    v_mov_b32 v143, 0
    v_mov_b32 v144, 0
    v_mov_b32 v145, 0
    v_mov_b32 v146, 0
    v_mov_b32 v147, 0
    v_mov_b32 v148, 0
    v_mov_b32 v149, 0
    v_mov_b32 v150, 0
    v_mov_b32 v151, 0
    buffer_load_dwordx4 v[32:35], v10, s[48:51], 0 offen offset:0
    buffer_load_dwordx4 v[36:39], v11, s[48:51], 0 offen offset:0
    buffer_load_dwordx4 v[40:43], v12, s[48:51], 0 offen offset:0
    s_waitcnt vmcnt(0)
    v_mfma_f32_16x16x32_bf16 v[128:131], v[32:35], v[64:67], v[128:131]
    v_mfma_f32_16x16x32_bf16 v[132:135], v[32:35], v[96:99], v[132:135]
    v_mfma_f32_16x16x32_bf16 v[136:139], v[36:39], v[64:67], v[136:139]
    v_mfma_f32_16x16x32_bf16 v[140:143], v[36:39], v[96:99], v[140:143]
    v_mfma_f32_16x16x32_bf16 v[144:147], v[40:43], v[64:67], v[144:147]
    v_mfma_f32_16x16x32_bf16 v[148:151], v[40:43], v[96:99], v[148:151]
    buffer_load_dwordx4 v[32:35], v10, s[48:51], 0 offen offset:64
    buffer_load_dwordx4 v[36:39], v11, s[48:51], 0 offen offset:64
    buffer_load_dwordx4 v[40:43], v12, s[48:51], 0 offen offset:64
    s_waitcnt vmcnt(0)
    v_mfma_f32_16x16x32_bf16 v[128:131], v[32:35], v[68:71], v[128:131]
    v_mfma_f32_16x16x32_bf16 v[132:135], v[32:35], v[100:103], v[132:135]
    v_mfma_f32_16x16x32_bf16 v[136:139], v[36:39], v[68:71], v[136:139]
    v_mfma_f32_16x16x32_bf16 v[140:143], v[36:39], v[100:103], v[140:143]
    v_mfma_f32_16x16x32_bf16 v[144:147], v[40:43], v[68:71], v[144:147]
    v_mfma_f32_16x16x32_bf16 v[148:151], v[40:43], v[100:103], v[148:151]
    buffer_load_dwordx4 v[32:35], v10, s[48:51], 0 offen offset:128
    buffer_load_dwordx4 v[36:39], v11, s[48:51], 0 offen offset:128
    buffer_load_dwordx4 v[40:43], v12, s[48:51], 0 offen offset:128
    s_waitcnt vmcnt(0)
    v_mfma_f32_16x16x32_bf16 v[128:131], v[32:35], v[72:75], v[128:131]
    v_mfma_f32_16x16x32_bf16 v[132:135], v[32:35], v[104:107], v[132:135]
    v_mfma_f32_16x16x32_bf16 v[136:139], v[36:39], v[72:75], v[136:139]
    v_mfma_f32_16x16x32_bf16 v[140:143], v[36:39], v[104:107], v[140:143]
    v_mfma_f32_16x16x32_bf16 v[144:147], v[40:43], v[72:75], v[144:147]
    v_mfma_f32_16x16x32_bf16 v[148:151], v[40:43], v[104:107], v[148:151]
    buffer_load_dwordx4 v[32:35], v10, s[48:51], 0 offen offset:192
    buffer_load_dwordx4 v[36:39], v11, s[48:51], 0 offen offset:192
    buffer_load_dwordx4 v[40:43], v12, s[48:51], 0 offen offset:192
    s_waitcnt vmcnt(0)
    v_mfma_f32_16x16x32_bf16 v[128:131], v[32:35], v[76:79], v[128:131]
    v_mfma_f32_16x16x32_bf16 v[132:135], v[32:35], v[108:111], v[132:135]
    v_mfma_f32_16x16x32_bf16 v[136:139], v[36:39], v[76:79], v[136:139]
    v_mfma_f32_16x16x32_bf16 v[140:143], v[36:39], v[108:111], v[140:143]
    v_mfma_f32_16x16x32_bf16 v[144:147], v[40:43], v[76:79], v[144:147]
    v_mfma_f32_16x16x32_bf16 v[148:151], v[40:43], v[108:111], v[148:151]
    buffer_load_dwordx4 v[32:35], v10, s[48:51], 0 offen offset:256
    buffer_load_dwordx4 v[36:39], v11, s[48:51], 0 offen offset:256
    buffer_load_dwordx4 v[40:43], v12, s[48:51], 0 offen offset:256
    s_waitcnt vmcnt(0)
    v_mfma_f32_16x16x32_bf16 v[128:131], v[32:35], v[80:83], v[128:131]
    v_mfma_f32_16x16x32_bf16 v[132:135], v[32:35], v[112:115], v[132:135]
    v_mfma_f32_16x16x32_bf16 v[136:139], v[36:39], v[80:83], v[136:139]
    v_mfma_f32_16x16x32_bf16 v[140:143], v[36:39], v[112:115], v[140:143]
    v_mfma_f32_16x16x32_bf16 v[144:147], v[40:43], v[80:83], v[144:147]
    v_mfma_f32_16x16x32_bf16 v[148:151], v[40:43], v[112:115], v[148:151]
    buffer_load_dwordx4 v[32:35], v10, s[48:51], 0 offen offset:320
    buffer_load_dwordx4 v[36:39], v11, s[48:51], 0 offen offset:320
    buffer_load_dwordx4 v[40:43], v12, s[48:51], 0 offen offset:320
    s_waitcnt vmcnt(0)
    v_mfma_f32_16x16x32_bf16 v[128:131], v[32:35], v[84:87], v[128:131]
    v_mfma_f32_16x16x32_bf16 v[132:135], v[32:35], v[116:119], v[132:135]
    v_mfma_f32_16x16x32_bf16 v[136:139], v[36:39], v[84:87], v[136:139]
    v_mfma_f32_16x16x32_bf16 v[140:143], v[36:39], v[116:119], v[140:143]
    v_mfma_f32_16x16x32_bf16 v[144:147], v[40:43], v[84:87], v[144:147]
    v_mfma_f32_16x16x32_bf16 v[148:151], v[40:43], v[116:119], v[148:151]
    buffer_load_dwordx4 v[32:35], v10, s[48:51], 0 offen offset:384
    buffer_load_dwordx4 v[36:39], v11, s[48:51], 0 offen offset:384
    buffer_load_dwordx4 v[40:43], v12, s[48:51], 0 offen offset:384
    s_waitcnt vmcnt(0)
    v_mfma_f32_16x16x32_bf16 v[128:131], v[32:35], v[88:91], v[128:131]
    v_mfma_f32_16x16x32_bf16 v[132:135], v[32:35], v[120:123], v[132:135]
    v_mfma_f32_16x16x32_bf16 v[136:139], v[36:39], v[88:91], v[136:139]
    v_mfma_f32_16x16x32_bf16 v[140:143], v[36:39], v[120:123], v[140:143]
    v_mfma_f32_16x16x32_bf16 v[144:147], v[40:43], v[88:91], v[144:147]
    v_mfma_f32_16x16x32_bf16 v[148:151], v[40:43], v[120:123], v[148:151]
    buffer_load_dwordx4 v[32:35], v10, s[48:51], 0 offen offset:448
    buffer_load_dwordx4 v[36:39], v11, s[48:51], 0 offen offset:448
    buffer_load_dwordx4 v[40:43], v12, s[48:51], 0 offen offset:448
    s_waitcnt vmcnt(0)
    v_mfma_f32_16x16x32_bf16 v[128:131], v[32:35], v[92:95], v[128:131]
    v_mfma_f32_16x16x32_bf16 v[132:135], v[32:35], v[124:127], v[132:135]
    v_mfma_f32_16x16x32_bf16 v[136:139], v[36:39], v[92:95], v[136:139]
    v_mfma_f32_16x16x32_bf16 v[140:143], v[36:39], v[124:127], v[140:143]
    v_mfma_f32_16x16x32_bf16 v[144:147], v[40:43], v[92:95], v[144:147]
    v_mfma_f32_16x16x32_bf16 v[148:151], v[40:43], v[124:127], v[148:151]
    s_nop 7
    s_nop 1
    s_mov_b32 s15, 0xff800000
    v_lshlrev_b32 v17, 2, v4
    v_cvt_pk_bf16_f32 v32, v128, v129
    v_lshlrev_b32 v128, 16, v32
    v_and_b32 v129, 0xffff0000, v32
    v_cvt_pk_bf16_f32 v32, v130, v131
    v_lshlrev_b32 v130, 16, v32
    v_and_b32 v131, 0xffff0000, v32
    v_mul_f32 v128, 0x3d800000, v128
    v_add_u32 v33, -8, v17
    v_cmp_le_i32 vcc, v33, v3
    s_nop 1
    v_mov_b32 v34, s15
    v_cndmask_b32 v128, v34, v128, vcc
    v_mul_f32 v129, 0x3d800000, v129
    v_add_u32 v33, -7, v17
    v_cmp_le_i32 vcc, v33, v3
    s_nop 1
    v_mov_b32 v34, s15
    v_cndmask_b32 v129, v34, v129, vcc
    v_mul_f32 v130, 0x3d800000, v130
    v_add_u32 v33, -6, v17
    v_cmp_le_i32 vcc, v33, v3
    s_nop 1
    v_mov_b32 v34, s15
    v_cndmask_b32 v130, v34, v130, vcc
    v_mul_f32 v131, 0x3d800000, v131
    v_add_u32 v33, -5, v17
    v_cmp_le_i32 vcc, v33, v3
    s_nop 1
    v_mov_b32 v34, s15
    v_cndmask_b32 v131, v34, v131, vcc
    v_cvt_pk_bf16_f32 v32, v136, v137
    v_lshlrev_b32 v136, 16, v32
    v_and_b32 v137, 0xffff0000, v32
    v_cvt_pk_bf16_f32 v32, v138, v139
    v_lshlrev_b32 v138, 16, v32
    v_and_b32 v139, 0xffff0000, v32
    v_mul_f32 v136, 0x3d800000, v136
    v_add_u32 v33, 8, v17
    v_cmp_le_i32 vcc, v33, v3
    s_nop 1
    v_mov_b32 v34, s15
    v_cndmask_b32 v136, v34, v136, vcc
    v_mul_f32 v137, 0x3d800000, v137
    v_add_u32 v33, 9, v17
    v_cmp_le_i32 vcc, v33, v3
    s_nop 1
    v_mov_b32 v34, s15
    v_cndmask_b32 v137, v34, v137, vcc
    v_mul_f32 v138, 0x3d800000, v138
    v_add_u32 v33, 10, v17
    v_cmp_le_i32 vcc, v33, v3
    s_nop 1
    v_mov_b32 v34, s15
    v_cndmask_b32 v138, v34, v138, vcc
    v_mul_f32 v139, 0x3d800000, v139
    v_add_u32 v33, 11, v17
    v_cmp_le_i32 vcc, v33, v3
    s_nop 1
    v_mov_b32 v34, s15
    v_cndmask_b32 v139, v34, v139, vcc
    v_cvt_pk_bf16_f32 v32, v144, v145
    v_lshlrev_b32 v144, 16, v32
    v_and_b32 v145, 0xffff0000, v32
    v_cvt_pk_bf16_f32 v32, v146, v147
    v_lshlrev_b32 v146, 16, v32
    v_and_b32 v147, 0xffff0000, v32
    v_mul_f32 v144, 0x3d800000, v144
    v_add_u32 v33, 24, v17
    v_cmp_le_i32 vcc, v33, v3
    s_nop 1
    v_mov_b32 v34, s15
    v_cndmask_b32 v144, v34, v144, vcc
    v_mul_f32 v145, 0x3d800000, v145
    v_add_u32 v33, 25, v17
    v_cmp_le_i32 vcc, v33, v3
    s_nop 1
    v_mov_b32 v34, s15
    v_cndmask_b32 v145, v34, v145, vcc
    v_mul_f32 v146, 0x3d800000, v146
    v_add_u32 v33, 26, v17
    v_cmp_le_i32 vcc, v33, v3
    s_nop 1
    v_mov_b32 v34, s15
    v_cndmask_b32 v146, v34, v146, vcc
    v_mul_f32 v147, 0x3d800000, v147
    v_add_u32 v33, 27, v17
    v_cmp_le_i32 vcc, v33, v3
    s_nop 1
    v_mov_b32 v34, s15
    v_cndmask_b32 v147, v34, v147, vcc
    v_max3_f32 v35, v128, v129, v130
    v_max3_f32 v35, v35, v131, v136
    v_max3_f32 v35, v35, v137, v138
    v_max3_f32 v35, v35, v139, v144
    v_max3_f32 v35, v35, v145, v146
    v_max_f32 v35, v35, v147
    ds_bpermute_b32 v36, v5, v35
    s_waitcnt lgkmcnt(0)
    v_max_f32 v35, v35, v36
    ds_bpermute_b32 v36, v6, v35
    s_waitcnt lgkmcnt(0)
    v_max_f32 v35, v35, v36
    s_mov_b32 s16, 0x3fb8aa3b
    v_sub_f32 v128, v128, v35
    v_mul_f32 v128, s16, v128
    v_exp_f32 v128, v128
    v_sub_f32 v129, v129, v35
    v_mul_f32 v129, s16, v129
    v_exp_f32 v129, v129
    v_sub_f32 v130, v130, v35
    v_mul_f32 v130, s16, v130
    v_exp_f32 v130, v130
    v_sub_f32 v131, v131, v35
    v_mul_f32 v131, s16, v131
    v_exp_f32 v131, v131
    v_sub_f32 v136, v136, v35
    v_mul_f32 v136, s16, v136
    v_exp_f32 v136, v136
    v_sub_f32 v137, v137, v35
    v_mul_f32 v137, s16, v137
    v_exp_f32 v137, v137
    v_sub_f32 v138, v138, v35
    v_mul_f32 v138, s16, v138
    v_exp_f32 v138, v138
    v_sub_f32 v139, v139, v35
    v_mul_f32 v139, s16, v139
    v_exp_f32 v139, v139
    v_sub_f32 v144, v144, v35
    v_mul_f32 v144, s16, v144
    v_exp_f32 v144, v144
    v_sub_f32 v145, v145, v35
    v_mul_f32 v145, s16, v145
    v_exp_f32 v145, v145
    v_sub_f32 v146, v146, v35
    v_mul_f32 v146, s16, v146
    v_exp_f32 v146, v146
    v_sub_f32 v147, v147, v35
    v_mul_f32 v147, s16, v147
    v_exp_f32 v147, v147
    s_nop 0
    v_add_f32 v36, v128, v129
    v_add_f32 v36, v36, v130
    v_add_f32 v36, v36, v131
    v_add_f32 v36, v36, v136
    v_add_f32 v36, v36, v137
    v_add_f32 v36, v36, v138
    v_add_f32 v36, v36, v139
    v_add_f32 v36, v36, v144
    v_add_f32 v36, v36, v145
    v_add_f32 v36, v36, v146
    v_add_f32 v36, v36, v147
    ds_bpermute_b32 v37, v5, v36
    s_waitcnt lgkmcnt(0)
    v_add_f32 v36, v36, v37
    ds_bpermute_b32 v37, v6, v36
    s_waitcnt lgkmcnt(0)
    v_add_f32 v36, v36, v37
    v_rcp_f32 v36, v36
    s_nop 0
    v_mul_f32 v128, v128, v36
    v_mul_f32 v129, v129, v36
    v_mul_f32 v130, v130, v36
    v_mul_f32 v131, v131, v36
    v_mul_f32 v136, v136, v36
    v_mul_f32 v137, v137, v36
    v_mul_f32 v138, v138, v36
    v_mul_f32 v139, v139, v36
    v_mul_f32 v144, v144, v36
    v_mul_f32 v145, v145, v36
    v_mul_f32 v146, v146, v36
    v_mul_f32 v147, v147, v36
    v_cvt_pk_bf16_f32 v152, v128, v129
    v_cvt_pk_bf16_f32 v153, v130, v131
    v_cvt_pk_bf16_f32 v154, v136, v137
    v_cvt_pk_bf16_f32 v155, v138, v139
    v_cvt_pk_bf16_f32 v156, v144, v145
    v_cvt_pk_bf16_f32 v157, v146, v147
    v_mov_b32 v158, 0
    v_mov_b32 v159, 0
    v_cvt_pk_bf16_f32 v32, v132, v133
    v_lshlrev_b32 v132, 16, v32
    v_and_b32 v133, 0xffff0000, v32
    v_cvt_pk_bf16_f32 v32, v134, v135
    v_lshlrev_b32 v134, 16, v32
    v_and_b32 v135, 0xffff0000, v32
    v_mul_f32 v132, 0x3d800000, v132
    v_add_u32 v33, -24, v17
    v_cmp_le_i32 vcc, v33, v3
    s_nop 1
    v_mov_b32 v34, s15
    v_cndmask_b32 v132, v34, v132, vcc
    v_mul_f32 v133, 0x3d800000, v133
    v_add_u32 v33, -23, v17
    v_cmp_le_i32 vcc, v33, v3
    s_nop 1
    v_mov_b32 v34, s15
    v_cndmask_b32 v133, v34, v133, vcc
    v_mul_f32 v134, 0x3d800000, v134
    v_add_u32 v33, -22, v17
    v_cmp_le_i32 vcc, v33, v3
    s_nop 1
    v_mov_b32 v34, s15
    v_cndmask_b32 v134, v34, v134, vcc
    v_mul_f32 v135, 0x3d800000, v135
    v_add_u32 v33, -21, v17
    v_cmp_le_i32 vcc, v33, v3
    s_nop 1
    v_mov_b32 v34, s15
    v_cndmask_b32 v135, v34, v135, vcc
    v_cvt_pk_bf16_f32 v32, v140, v141
    v_lshlrev_b32 v140, 16, v32
    v_and_b32 v141, 0xffff0000, v32
    v_cvt_pk_bf16_f32 v32, v142, v143
    v_lshlrev_b32 v142, 16, v32
    v_and_b32 v143, 0xffff0000, v32
    v_mul_f32 v140, 0x3d800000, v140
    v_add_u32 v33, -8, v17
    v_cmp_le_i32 vcc, v33, v3
    s_nop 1
    v_mov_b32 v34, s15
    v_cndmask_b32 v140, v34, v140, vcc
    v_mul_f32 v141, 0x3d800000, v141
    v_add_u32 v33, -7, v17
    v_cmp_le_i32 vcc, v33, v3
    s_nop 1
    v_mov_b32 v34, s15
    v_cndmask_b32 v141, v34, v141, vcc
    v_mul_f32 v142, 0x3d800000, v142
    v_add_u32 v33, -6, v17
    v_cmp_le_i32 vcc, v33, v3
    s_nop 1
    v_mov_b32 v34, s15
    v_cndmask_b32 v142, v34, v142, vcc
    v_mul_f32 v143, 0x3d800000, v143
    v_add_u32 v33, -5, v17
    v_cmp_le_i32 vcc, v33, v3
    s_nop 1
    v_mov_b32 v34, s15
    v_cndmask_b32 v143, v34, v143, vcc
    v_cvt_pk_bf16_f32 v32, v148, v149
    v_lshlrev_b32 v148, 16, v32
    v_and_b32 v149, 0xffff0000, v32
    v_cvt_pk_bf16_f32 v32, v150, v151
    v_lshlrev_b32 v150, 16, v32
    v_and_b32 v151, 0xffff0000, v32
    v_mul_f32 v148, 0x3d800000, v148
    v_add_u32 v33, 8, v17
    v_cmp_le_i32 vcc, v33, v3
    s_nop 1
    v_mov_b32 v34, s15
    v_cndmask_b32 v148, v34, v148, vcc
    v_mul_f32 v149, 0x3d800000, v149
    v_add_u32 v33, 9, v17
    v_cmp_le_i32 vcc, v33, v3
    s_nop 1
    v_mov_b32 v34, s15
    v_cndmask_b32 v149, v34, v149, vcc
    v_mul_f32 v150, 0x3d800000, v150
    v_add_u32 v33, 10, v17
    v_cmp_le_i32 vcc, v33, v3
    s_nop 1
    v_mov_b32 v34, s15
    v_cndmask_b32 v150, v34, v150, vcc
    v_mul_f32 v151, 0x3d800000, v151
    v_add_u32 v33, 11, v17
    v_cmp_le_i32 vcc, v33, v3
    s_nop 1
    v_mov_b32 v34, s15
    v_cndmask_b32 v151, v34, v151, vcc
    v_max3_f32 v35, v132, v133, v134
    v_max3_f32 v35, v35, v135, v140
    v_max3_f32 v35, v35, v141, v142
    v_max3_f32 v35, v35, v143, v148
    v_max3_f32 v35, v35, v149, v150
    v_max_f32 v35, v35, v151
    ds_bpermute_b32 v36, v5, v35
    s_waitcnt lgkmcnt(0)
    v_max_f32 v35, v35, v36
    ds_bpermute_b32 v36, v6, v35
    s_waitcnt lgkmcnt(0)
    v_max_f32 v35, v35, v36
    s_mov_b32 s16, 0x3fb8aa3b
    v_sub_f32 v132, v132, v35
    v_mul_f32 v132, s16, v132
    v_exp_f32 v132, v132
    v_sub_f32 v133, v133, v35
    v_mul_f32 v133, s16, v133
    v_exp_f32 v133, v133
    v_sub_f32 v134, v134, v35
    v_mul_f32 v134, s16, v134
    v_exp_f32 v134, v134
    v_sub_f32 v135, v135, v35
    v_mul_f32 v135, s16, v135
    v_exp_f32 v135, v135
    v_sub_f32 v140, v140, v35
    v_mul_f32 v140, s16, v140
    v_exp_f32 v140, v140
    v_sub_f32 v141, v141, v35
    v_mul_f32 v141, s16, v141
    v_exp_f32 v141, v141
    v_sub_f32 v142, v142, v35
    v_mul_f32 v142, s16, v142
    v_exp_f32 v142, v142
    v_sub_f32 v143, v143, v35
    v_mul_f32 v143, s16, v143
    v_exp_f32 v143, v143
    v_sub_f32 v148, v148, v35
    v_mul_f32 v148, s16, v148
    v_exp_f32 v148, v148
    v_sub_f32 v149, v149, v35
    v_mul_f32 v149, s16, v149
    v_exp_f32 v149, v149
    v_sub_f32 v150, v150, v35
    v_mul_f32 v150, s16, v150
    v_exp_f32 v150, v150
    v_sub_f32 v151, v151, v35
    v_mul_f32 v151, s16, v151
    v_exp_f32 v151, v151
    s_nop 0
    v_add_f32 v36, v132, v133
    v_add_f32 v36, v36, v134
    v_add_f32 v36, v36, v135
    v_add_f32 v36, v36, v140
    v_add_f32 v36, v36, v141
    v_add_f32 v36, v36, v142
    v_add_f32 v36, v36, v143
    v_add_f32 v36, v36, v148
    v_add_f32 v36, v36, v149
    v_add_f32 v36, v36, v150
    v_add_f32 v36, v36, v151
    ds_bpermute_b32 v37, v5, v36
    s_waitcnt lgkmcnt(0)
    v_add_f32 v36, v36, v37
    ds_bpermute_b32 v37, v6, v36
    s_waitcnt lgkmcnt(0)
    v_add_f32 v36, v36, v37
    v_rcp_f32 v36, v36
    s_nop 0
    v_mul_f32 v132, v132, v36
    v_mul_f32 v133, v133, v36
    v_mul_f32 v134, v134, v36
    v_mul_f32 v135, v135, v36
    v_mul_f32 v140, v140, v36
    v_mul_f32 v141, v141, v36
    v_mul_f32 v142, v142, v36
    v_mul_f32 v143, v143, v36
    v_mul_f32 v148, v148, v36
    v_mul_f32 v149, v149, v36
    v_mul_f32 v150, v150, v36
    v_mul_f32 v151, v151, v36
    v_cvt_pk_bf16_f32 v160, v132, v133
    v_cvt_pk_bf16_f32 v161, v134, v135
    v_cvt_pk_bf16_f32 v162, v140, v141
    v_cvt_pk_bf16_f32 v163, v142, v143
    v_cvt_pk_bf16_f32 v164, v148, v149
    v_cvt_pk_bf16_f32 v165, v150, v151
    v_mov_b32 v166, 0
    v_mov_b32 v167, 0
    v_lshrrev_b32 v18, 2, v3
    v_add_u32 v18, v18, v17
    v_mul_u32_u24 v18, 528, v18
    v_and_b32 v19, 3, v3
    v_lshlrev_b32 v19, 3, v19
    v_add_u32 v18, v18, v19
    v_add_u32 v18, s12, v18
    v_lshlrev_b32 v19, 13, v3
    v_lshlrev_b32 v20, 3, v4
    v_add_u32 v19, v19, v20
    s_add_u32 s17, s8, 100663296
    v_mov_b32 v46, 0
    v_mov_b32 v47, 0
    s_waitcnt lgkmcnt(0)
    ds_read_b64_tr_b16 v[40:41], v18 offset:0
    ds_read_b64_tr_b16 v[42:43], v18 offset:8448
    ds_read_b64_tr_b16 v[44:45], v18 offset:16896
    v_mov_b32 v48, 0
    v_mov_b32 v49, 0
    v_mov_b32 v50, 0
    v_mov_b32 v51, 0
    v_mov_b32 v52, 0
    v_mov_b32 v53, 0
    v_mov_b32 v54, 0
    v_mov_b32 v55, 0
    s_waitcnt lgkmcnt(0)
    v_mfma_f32_16x16x32_bf16 v[48:51], v[40:43], v[152:155], v[48:51]
    v_mfma_f32_16x16x32_bf16 v[48:51], v[44:47], v[156:159], v[48:51]
    v_mfma_f32_16x16x32_bf16 v[52:55], v[40:43], v[160:163], v[52:55]
    v_mfma_f32_16x16x32_bf16 v[52:55], v[44:47], v[164:167], v[52:55]
    s_nop 7
    s_nop 1
    v_cvt_pk_bf16_f32 v56, v48, v49
    v_cvt_pk_bf16_f32 v57, v50, v51
    s_add_u32 s18, s17, 0
    buffer_store_dwordx2 v[56:57], v19, s[48:51], s18 offen offset:0
    s_nop 0
    v_cvt_pk_bf16_f32 v56, v52, v53
    v_cvt_pk_bf16_f32 v57, v54, v55
    s_add_u32 s18, s17, 131072
    buffer_store_dwordx2 v[56:57], v19, s[48:51], s18 offen offset:0
    s_nop 0
    ds_read_b64_tr_b16 v[40:41], v18 offset:32
    ds_read_b64_tr_b16 v[42:43], v18 offset:8480
    ds_read_b64_tr_b16 v[44:45], v18 offset:16928
    v_mov_b32 v48, 0
    v_mov_b32 v49, 0
    v_mov_b32 v50, 0
    v_mov_b32 v51, 0
    v_mov_b32 v52, 0
    v_mov_b32 v53, 0
    v_mov_b32 v54, 0
    v_mov_b32 v55, 0
    s_waitcnt lgkmcnt(0)
    v_mfma_f32_16x16x32_bf16 v[48:51], v[40:43], v[152:155], v[48:51]
    v_mfma_f32_16x16x32_bf16 v[48:51], v[44:47], v[156:159], v[48:51]
    v_mfma_f32_16x16x32_bf16 v[52:55], v[40:43], v[160:163], v[52:55]
    v_mfma_f32_16x16x32_bf16 v[52:55], v[44:47], v[164:167], v[52:55]
    s_nop 7
    s_nop 1
    v_cvt_pk_bf16_f32 v56, v48, v49
    v_cvt_pk_bf16_f32 v57, v50, v51
    s_add_u32 s18, s17, 0
    buffer_store_dwordx2 v[56:57], v19, s[48:51], s18 offen offset:32
    s_nop 0
    v_cvt_pk_bf16_f32 v56, v52, v53
    v_cvt_pk_bf16_f32 v57, v54, v55
    s_add_u32 s18, s17, 131072
    buffer_store_dwordx2 v[56:57], v19, s[48:51], s18 offen offset:32
    s_nop 0
    ds_read_b64_tr_b16 v[40:41], v18 offset:64
    ds_read_b64_tr_b16 v[42:43], v18 offset:8512
    ds_read_b64_tr_b16 v[44:45], v18 offset:16960
    v_mov_b32 v48, 0
    v_mov_b32 v49, 0
    v_mov_b32 v50, 0
    v_mov_b32 v51, 0
    v_mov_b32 v52, 0
    v_mov_b32 v53, 0
    v_mov_b32 v54, 0
    v_mov_b32 v55, 0
    s_waitcnt lgkmcnt(0)
    v_mfma_f32_16x16x32_bf16 v[48:51], v[40:43], v[152:155], v[48:51]
    v_mfma_f32_16x16x32_bf16 v[48:51], v[44:47], v[156:159], v[48:51]
    v_mfma_f32_16x16x32_bf16 v[52:55], v[40:43], v[160:163], v[52:55]
    v_mfma_f32_16x16x32_bf16 v[52:55], v[44:47], v[164:167], v[52:55]
    s_nop 7
    s_nop 1
    v_cvt_pk_bf16_f32 v56, v48, v49
    v_cvt_pk_bf16_f32 v57, v50, v51
    s_add_u32 s18, s17, 0
    buffer_store_dwordx2 v[56:57], v19, s[48:51], s18 offen offset:64
    s_nop 0
    v_cvt_pk_bf16_f32 v56, v52, v53
    v_cvt_pk_bf16_f32 v57, v54, v55
    s_add_u32 s18, s17, 131072
    buffer_store_dwordx2 v[56:57], v19, s[48:51], s18 offen offset:64
    s_nop 0
    ds_read_b64_tr_b16 v[40:41], v18 offset:96
    ds_read_b64_tr_b16 v[42:43], v18 offset:8544
    ds_read_b64_tr_b16 v[44:45], v18 offset:16992
    v_mov_b32 v48, 0
    v_mov_b32 v49, 0
    v_mov_b32 v50, 0
    v_mov_b32 v51, 0
    v_mov_b32 v52, 0
    v_mov_b32 v53, 0
    v_mov_b32 v54, 0
    v_mov_b32 v55, 0
    s_waitcnt lgkmcnt(0)
    v_mfma_f32_16x16x32_bf16 v[48:51], v[40:43], v[152:155], v[48:51]
    v_mfma_f32_16x16x32_bf16 v[48:51], v[44:47], v[156:159], v[48:51]
    v_mfma_f32_16x16x32_bf16 v[52:55], v[40:43], v[160:163], v[52:55]
    v_mfma_f32_16x16x32_bf16 v[52:55], v[44:47], v[164:167], v[52:55]
    s_nop 7
    s_nop 1
    v_cvt_pk_bf16_f32 v56, v48, v49
    v_cvt_pk_bf16_f32 v57, v50, v51
    s_add_u32 s18, s17, 0
    buffer_store_dwordx2 v[56:57], v19, s[48:51], s18 offen offset:96
    s_nop 0
    v_cvt_pk_bf16_f32 v56, v52, v53
    v_cvt_pk_bf16_f32 v57, v54, v55
    s_add_u32 s18, s17, 131072
    buffer_store_dwordx2 v[56:57], v19, s[48:51], s18 offen offset:96
    s_nop 0
    ds_read_b64_tr_b16 v[40:41], v18 offset:128
    ds_read_b64_tr_b16 v[42:43], v18 offset:8576
    ds_read_b64_tr_b16 v[44:45], v18 offset:17024
    v_mov_b32 v48, 0
    v_mov_b32 v49, 0
    v_mov_b32 v50, 0
    v_mov_b32 v51, 0
    v_mov_b32 v52, 0
    v_mov_b32 v53, 0
    v_mov_b32 v54, 0
    v_mov_b32 v55, 0
    s_waitcnt lgkmcnt(0)
    v_mfma_f32_16x16x32_bf16 v[48:51], v[40:43], v[152:155], v[48:51]
    v_mfma_f32_16x16x32_bf16 v[48:51], v[44:47], v[156:159], v[48:51]
    v_mfma_f32_16x16x32_bf16 v[52:55], v[40:43], v[160:163], v[52:55]
    v_mfma_f32_16x16x32_bf16 v[52:55], v[44:47], v[164:167], v[52:55]
    s_nop 7
    s_nop 1
    v_cvt_pk_bf16_f32 v56, v48, v49
    v_cvt_pk_bf16_f32 v57, v50, v51
    s_add_u32 s18, s17, 0
    buffer_store_dwordx2 v[56:57], v19, s[48:51], s18 offen offset:128
    s_nop 0
    v_cvt_pk_bf16_f32 v56, v52, v53
    v_cvt_pk_bf16_f32 v57, v54, v55
    s_add_u32 s18, s17, 131072
    buffer_store_dwordx2 v[56:57], v19, s[48:51], s18 offen offset:128
    s_nop 0
    ds_read_b64_tr_b16 v[40:41], v18 offset:160
    ds_read_b64_tr_b16 v[42:43], v18 offset:8608
    ds_read_b64_tr_b16 v[44:45], v18 offset:17056
    v_mov_b32 v48, 0
    v_mov_b32 v49, 0
    v_mov_b32 v50, 0
    v_mov_b32 v51, 0
    v_mov_b32 v52, 0
    v_mov_b32 v53, 0
    v_mov_b32 v54, 0
    v_mov_b32 v55, 0
    s_waitcnt lgkmcnt(0)
    v_mfma_f32_16x16x32_bf16 v[48:51], v[40:43], v[152:155], v[48:51]
    v_mfma_f32_16x16x32_bf16 v[48:51], v[44:47], v[156:159], v[48:51]
    v_mfma_f32_16x16x32_bf16 v[52:55], v[40:43], v[160:163], v[52:55]
    v_mfma_f32_16x16x32_bf16 v[52:55], v[44:47], v[164:167], v[52:55]
    s_nop 7
    s_nop 1
    v_cvt_pk_bf16_f32 v56, v48, v49
    v_cvt_pk_bf16_f32 v57, v50, v51
    s_add_u32 s18, s17, 0
    buffer_store_dwordx2 v[56:57], v19, s[48:51], s18 offen offset:160
    s_nop 0
    v_cvt_pk_bf16_f32 v56, v52, v53
    v_cvt_pk_bf16_f32 v57, v54, v55
    s_add_u32 s18, s17, 131072
    buffer_store_dwordx2 v[56:57], v19, s[48:51], s18 offen offset:160
    s_nop 0
    ds_read_b64_tr_b16 v[40:41], v18 offset:192
    ds_read_b64_tr_b16 v[42:43], v18 offset:8640
    ds_read_b64_tr_b16 v[44:45], v18 offset:17088
    v_mov_b32 v48, 0
    v_mov_b32 v49, 0
    v_mov_b32 v50, 0
    v_mov_b32 v51, 0
    v_mov_b32 v52, 0
    v_mov_b32 v53, 0
    v_mov_b32 v54, 0
    v_mov_b32 v55, 0
    s_waitcnt lgkmcnt(0)
    v_mfma_f32_16x16x32_bf16 v[48:51], v[40:43], v[152:155], v[48:51]
    v_mfma_f32_16x16x32_bf16 v[48:51], v[44:47], v[156:159], v[48:51]
    v_mfma_f32_16x16x32_bf16 v[52:55], v[40:43], v[160:163], v[52:55]
    v_mfma_f32_16x16x32_bf16 v[52:55], v[44:47], v[164:167], v[52:55]
    s_nop 7
    s_nop 1
    v_cvt_pk_bf16_f32 v56, v48, v49
    v_cvt_pk_bf16_f32 v57, v50, v51
    s_add_u32 s18, s17, 0
    buffer_store_dwordx2 v[56:57], v19, s[48:51], s18 offen offset:192
    s_nop 0
    v_cvt_pk_bf16_f32 v56, v52, v53
    v_cvt_pk_bf16_f32 v57, v54, v55
    s_add_u32 s18, s17, 131072
    buffer_store_dwordx2 v[56:57], v19, s[48:51], s18 offen offset:192
    s_nop 0
    ds_read_b64_tr_b16 v[40:41], v18 offset:224
    ds_read_b64_tr_b16 v[42:43], v18 offset:8672
    ds_read_b64_tr_b16 v[44:45], v18 offset:17120
    v_mov_b32 v48, 0
    v_mov_b32 v49, 0
    v_mov_b32 v50, 0
    v_mov_b32 v51, 0
    v_mov_b32 v52, 0
    v_mov_b32 v53, 0
    v_mov_b32 v54, 0
    v_mov_b32 v55, 0
    s_waitcnt lgkmcnt(0)
    v_mfma_f32_16x16x32_bf16 v[48:51], v[40:43], v[152:155], v[48:51]
    v_mfma_f32_16x16x32_bf16 v[48:51], v[44:47], v[156:159], v[48:51]
    v_mfma_f32_16x16x32_bf16 v[52:55], v[40:43], v[160:163], v[52:55]
    v_mfma_f32_16x16x32_bf16 v[52:55], v[44:47], v[164:167], v[52:55]
    s_nop 7
    s_nop 1
    v_cvt_pk_bf16_f32 v56, v48, v49
    v_cvt_pk_bf16_f32 v57, v50, v51
    s_add_u32 s18, s17, 0
    buffer_store_dwordx2 v[56:57], v19, s[48:51], s18 offen offset:224
    s_nop 0
    v_cvt_pk_bf16_f32 v56, v52, v53
    v_cvt_pk_bf16_f32 v57, v54, v55
    s_add_u32 s18, s17, 131072
    buffer_store_dwordx2 v[56:57], v19, s[48:51], s18 offen offset:224
    s_nop 0
    ds_read_b64_tr_b16 v[40:41], v18 offset:256
    ds_read_b64_tr_b16 v[42:43], v18 offset:8704
    ds_read_b64_tr_b16 v[44:45], v18 offset:17152
    v_mov_b32 v48, 0
    v_mov_b32 v49, 0
    v_mov_b32 v50, 0
    v_mov_b32 v51, 0
    v_mov_b32 v52, 0
    v_mov_b32 v53, 0
    v_mov_b32 v54, 0
    v_mov_b32 v55, 0
    s_waitcnt lgkmcnt(0)
    v_mfma_f32_16x16x32_bf16 v[48:51], v[40:43], v[152:155], v[48:51]
    v_mfma_f32_16x16x32_bf16 v[48:51], v[44:47], v[156:159], v[48:51]
    v_mfma_f32_16x16x32_bf16 v[52:55], v[40:43], v[160:163], v[52:55]
    v_mfma_f32_16x16x32_bf16 v[52:55], v[44:47], v[164:167], v[52:55]
    s_nop 7
    s_nop 1
    v_cvt_pk_bf16_f32 v56, v48, v49
    v_cvt_pk_bf16_f32 v57, v50, v51
    s_add_u32 s18, s17, 0
    buffer_store_dwordx2 v[56:57], v19, s[48:51], s18 offen offset:256
    s_nop 0
    v_cvt_pk_bf16_f32 v56, v52, v53
    v_cvt_pk_bf16_f32 v57, v54, v55
    s_add_u32 s18, s17, 131072
    buffer_store_dwordx2 v[56:57], v19, s[48:51], s18 offen offset:256
    s_nop 0
    ds_read_b64_tr_b16 v[40:41], v18 offset:288
    ds_read_b64_tr_b16 v[42:43], v18 offset:8736
    ds_read_b64_tr_b16 v[44:45], v18 offset:17184
    v_mov_b32 v48, 0
    v_mov_b32 v49, 0
    v_mov_b32 v50, 0
    v_mov_b32 v51, 0
    v_mov_b32 v52, 0
    v_mov_b32 v53, 0
    v_mov_b32 v54, 0
    v_mov_b32 v55, 0
    s_waitcnt lgkmcnt(0)
    v_mfma_f32_16x16x32_bf16 v[48:51], v[40:43], v[152:155], v[48:51]
    v_mfma_f32_16x16x32_bf16 v[48:51], v[44:47], v[156:159], v[48:51]
    v_mfma_f32_16x16x32_bf16 v[52:55], v[40:43], v[160:163], v[52:55]
    v_mfma_f32_16x16x32_bf16 v[52:55], v[44:47], v[164:167], v[52:55]
    s_nop 7
    s_nop 1
    v_cvt_pk_bf16_f32 v56, v48, v49
    v_cvt_pk_bf16_f32 v57, v50, v51
    s_add_u32 s18, s17, 0
    buffer_store_dwordx2 v[56:57], v19, s[48:51], s18 offen offset:288
    s_nop 0
    v_cvt_pk_bf16_f32 v56, v52, v53
    v_cvt_pk_bf16_f32 v57, v54, v55
    s_add_u32 s18, s17, 131072
    buffer_store_dwordx2 v[56:57], v19, s[48:51], s18 offen offset:288
    s_nop 0
    ds_read_b64_tr_b16 v[40:41], v18 offset:320
    ds_read_b64_tr_b16 v[42:43], v18 offset:8768
    ds_read_b64_tr_b16 v[44:45], v18 offset:17216
    v_mov_b32 v48, 0
    v_mov_b32 v49, 0
    v_mov_b32 v50, 0
    v_mov_b32 v51, 0
    v_mov_b32 v52, 0
    v_mov_b32 v53, 0
    v_mov_b32 v54, 0
    v_mov_b32 v55, 0
    s_waitcnt lgkmcnt(0)
    v_mfma_f32_16x16x32_bf16 v[48:51], v[40:43], v[152:155], v[48:51]
    v_mfma_f32_16x16x32_bf16 v[48:51], v[44:47], v[156:159], v[48:51]
    v_mfma_f32_16x16x32_bf16 v[52:55], v[40:43], v[160:163], v[52:55]
    v_mfma_f32_16x16x32_bf16 v[52:55], v[44:47], v[164:167], v[52:55]
    s_nop 7
    s_nop 1
    v_cvt_pk_bf16_f32 v56, v48, v49
    v_cvt_pk_bf16_f32 v57, v50, v51
    s_add_u32 s18, s17, 0
    buffer_store_dwordx2 v[56:57], v19, s[48:51], s18 offen offset:320
    s_nop 0
    v_cvt_pk_bf16_f32 v56, v52, v53
    v_cvt_pk_bf16_f32 v57, v54, v55
    s_add_u32 s18, s17, 131072
    buffer_store_dwordx2 v[56:57], v19, s[48:51], s18 offen offset:320
    s_nop 0
    ds_read_b64_tr_b16 v[40:41], v18 offset:352
    ds_read_b64_tr_b16 v[42:43], v18 offset:8800
    ds_read_b64_tr_b16 v[44:45], v18 offset:17248
    v_mov_b32 v48, 0
    v_mov_b32 v49, 0
    v_mov_b32 v50, 0
    v_mov_b32 v51, 0
    v_mov_b32 v52, 0
    v_mov_b32 v53, 0
    v_mov_b32 v54, 0
    v_mov_b32 v55, 0
    s_waitcnt lgkmcnt(0)
    v_mfma_f32_16x16x32_bf16 v[48:51], v[40:43], v[152:155], v[48:51]
    v_mfma_f32_16x16x32_bf16 v[48:51], v[44:47], v[156:159], v[48:51]
    v_mfma_f32_16x16x32_bf16 v[52:55], v[40:43], v[160:163], v[52:55]
    v_mfma_f32_16x16x32_bf16 v[52:55], v[44:47], v[164:167], v[52:55]
    s_nop 7
    s_nop 1
    v_cvt_pk_bf16_f32 v56, v48, v49
    v_cvt_pk_bf16_f32 v57, v50, v51
    s_add_u32 s18, s17, 0
    buffer_store_dwordx2 v[56:57], v19, s[48:51], s18 offen offset:352
    s_nop 0
    v_cvt_pk_bf16_f32 v56, v52, v53
    v_cvt_pk_bf16_f32 v57, v54, v55
    s_add_u32 s18, s17, 131072
    buffer_store_dwordx2 v[56:57], v19, s[48:51], s18 offen offset:352
    s_nop 0
    ds_read_b64_tr_b16 v[40:41], v18 offset:384
    ds_read_b64_tr_b16 v[42:43], v18 offset:8832
    ds_read_b64_tr_b16 v[44:45], v18 offset:17280
    v_mov_b32 v48, 0
    v_mov_b32 v49, 0
    v_mov_b32 v50, 0
    v_mov_b32 v51, 0
    v_mov_b32 v52, 0
    v_mov_b32 v53, 0
    v_mov_b32 v54, 0
    v_mov_b32 v55, 0
    s_waitcnt lgkmcnt(0)
    v_mfma_f32_16x16x32_bf16 v[48:51], v[40:43], v[152:155], v[48:51]
    v_mfma_f32_16x16x32_bf16 v[48:51], v[44:47], v[156:159], v[48:51]
    v_mfma_f32_16x16x32_bf16 v[52:55], v[40:43], v[160:163], v[52:55]
    v_mfma_f32_16x16x32_bf16 v[52:55], v[44:47], v[164:167], v[52:55]
    s_nop 7
    s_nop 1
    v_cvt_pk_bf16_f32 v56, v48, v49
    v_cvt_pk_bf16_f32 v57, v50, v51
    s_add_u32 s18, s17, 0
    buffer_store_dwordx2 v[56:57], v19, s[48:51], s18 offen offset:384
    s_nop 0
    v_cvt_pk_bf16_f32 v56, v52, v53
    v_cvt_pk_bf16_f32 v57, v54, v55
    s_add_u32 s18, s17, 131072
    buffer_store_dwordx2 v[56:57], v19, s[48:51], s18 offen offset:384
    s_nop 0
    ds_read_b64_tr_b16 v[40:41], v18 offset:416
    ds_read_b64_tr_b16 v[42:43], v18 offset:8864
    ds_read_b64_tr_b16 v[44:45], v18 offset:17312
    v_mov_b32 v48, 0
    v_mov_b32 v49, 0
    v_mov_b32 v50, 0
    v_mov_b32 v51, 0
    v_mov_b32 v52, 0
    v_mov_b32 v53, 0
    v_mov_b32 v54, 0
    v_mov_b32 v55, 0
    s_waitcnt lgkmcnt(0)
    v_mfma_f32_16x16x32_bf16 v[48:51], v[40:43], v[152:155], v[48:51]
    v_mfma_f32_16x16x32_bf16 v[48:51], v[44:47], v[156:159], v[48:51]
    v_mfma_f32_16x16x32_bf16 v[52:55], v[40:43], v[160:163], v[52:55]
    v_mfma_f32_16x16x32_bf16 v[52:55], v[44:47], v[164:167], v[52:55]
    s_nop 7
    s_nop 1
    v_cvt_pk_bf16_f32 v56, v48, v49
    v_cvt_pk_bf16_f32 v57, v50, v51
    s_add_u32 s18, s17, 0
    buffer_store_dwordx2 v[56:57], v19, s[48:51], s18 offen offset:416
    s_nop 0
    v_cvt_pk_bf16_f32 v56, v52, v53
    v_cvt_pk_bf16_f32 v57, v54, v55
    s_add_u32 s18, s17, 131072
    buffer_store_dwordx2 v[56:57], v19, s[48:51], s18 offen offset:416
    s_nop 0
    ds_read_b64_tr_b16 v[40:41], v18 offset:448
    ds_read_b64_tr_b16 v[42:43], v18 offset:8896
    ds_read_b64_tr_b16 v[44:45], v18 offset:17344
    v_mov_b32 v48, 0
    v_mov_b32 v49, 0
    v_mov_b32 v50, 0
    v_mov_b32 v51, 0
    v_mov_b32 v52, 0
    v_mov_b32 v53, 0
    v_mov_b32 v54, 0
    v_mov_b32 v55, 0
    s_waitcnt lgkmcnt(0)
    v_mfma_f32_16x16x32_bf16 v[48:51], v[40:43], v[152:155], v[48:51]
    v_mfma_f32_16x16x32_bf16 v[48:51], v[44:47], v[156:159], v[48:51]
    v_mfma_f32_16x16x32_bf16 v[52:55], v[40:43], v[160:163], v[52:55]
    v_mfma_f32_16x16x32_bf16 v[52:55], v[44:47], v[164:167], v[52:55]
    s_nop 7
    s_nop 1
    v_cvt_pk_bf16_f32 v56, v48, v49
    v_cvt_pk_bf16_f32 v57, v50, v51
    s_add_u32 s18, s17, 0
    buffer_store_dwordx2 v[56:57], v19, s[48:51], s18 offen offset:448
    s_nop 0
    v_cvt_pk_bf16_f32 v56, v52, v53
    v_cvt_pk_bf16_f32 v57, v54, v55
    s_add_u32 s18, s17, 131072
    buffer_store_dwordx2 v[56:57], v19, s[48:51], s18 offen offset:448
    s_nop 0
    ds_read_b64_tr_b16 v[40:41], v18 offset:480
    ds_read_b64_tr_b16 v[42:43], v18 offset:8928
    ds_read_b64_tr_b16 v[44:45], v18 offset:17376
    v_mov_b32 v48, 0
    v_mov_b32 v49, 0
    v_mov_b32 v50, 0
    v_mov_b32 v51, 0
    v_mov_b32 v52, 0
    v_mov_b32 v53, 0
    v_mov_b32 v54, 0
    v_mov_b32 v55, 0
    s_waitcnt lgkmcnt(0)
    v_mfma_f32_16x16x32_bf16 v[48:51], v[40:43], v[152:155], v[48:51]
    v_mfma_f32_16x16x32_bf16 v[48:51], v[44:47], v[156:159], v[48:51]
    v_mfma_f32_16x16x32_bf16 v[52:55], v[40:43], v[160:163], v[52:55]
    v_mfma_f32_16x16x32_bf16 v[52:55], v[44:47], v[164:167], v[52:55]
    s_nop 7
    s_nop 1
    v_cvt_pk_bf16_f32 v56, v48, v49
    v_cvt_pk_bf16_f32 v57, v50, v51
    s_add_u32 s18, s17, 0
    buffer_store_dwordx2 v[56:57], v19, s[48:51], s18 offen offset:480
    s_nop 0
    v_cvt_pk_bf16_f32 v56, v52, v53
    v_cvt_pk_bf16_f32 v57, v54, v55
    s_add_u32 s18, s17, 131072
    buffer_store_dwordx2 v[56:57], v19, s[48:51], s18 offen offset:480
    s_nop 0
L_k4_end:
    s_endpgm
    .globl k6_out_kernel
    .p2align 8
    .type k6_out_kernel,@function
k6_out_kernel:
    s_load_dwordx16 s[16:31], s[0:1], 0
    s_load_dwordx16 s[32:47], s[0:1], 64
    s_waitcnt lgkmcnt(0)
    s_cmp_ge_u32 s2, 224
    s_cbranch_scc1 L_k6_end
    s_mul_hi_u32 s3, s2, 0x124924a
    s_mul_i32 s4, s3, 224
    s_sub_u32 s4, s2, s4
    s_mul_hi_u32 s5, s4, 0x24924925
    s_mul_i32 s6, s5, 7
    s_sub_u32 s6, s4, s6
    s_lshl_b32 s10, s5, 6
    s_lshl_b32 s11, s6, 6
    s_cmp_eq_u32 s3, 0
    s_mov_b32 s13, 117440512
    s_cselect_b32 s12, 100663296, s13
    s_cselect_b32 s52, s26, s40
    s_cselect_b32 s53, s27, s41
    s_cselect_b32 s14, 0, 896
    s_add_u32 s48, s46, s12
    s_addc_u32 s49, s47, 0
    s_add_u32 s56, s42, s14
    s_addc_u32 s57, s43, 0
    s_mov_b32 s50, 0x7fffffff
    s_mov_b32 s51, 0x00020000
    s_mov_b32 s54, 0x7fffffff
    s_mov_b32 s55, 0x00020000
    s_mov_b32 s58, 0x7fffffff
    s_mov_b32 s59, 0x00020000
    s_mov_b32 s7, 8192
    s_mov_b32 s9, 896
    s_mov_b32 s13, 1792
    s_mov_b32 s8, 64
    v_lshrrev_b32 v1, 3, v0
    v_and_b32 v2, 7, v0
    v_mul_lo_u32 v3, v1, s7
    v_lshlrev_b32 v4, 4, v2
    v_add_u32 v3, v3, v4
    v_mul_u32_u24 v5, 144, v1
    v_add_u32 v5, v5, v4
    v_add_u32 v5, 0, v5
    v_lshrrev_b32 v6, 3, v0
    v_and_b32 v7, 7, v0
    v_lshlrev_b32 v8, 4, v7
    v_mul_lo_u32 v9, v6, s9
    v_add_u32 v9, v9, v8
    v_mul_u32_u24 v10, 144, v6
    v_add_u32 v10, v10, v8
    v_add_u32 v10, 9216, v10
    s_mul_i32 s60, s10, s7
    s_lshl_b32 s65, s7, 5
    s_add_u32 s61, s60, s65
    s_lshl_b32 s66, s11, 1
    s_mov_b32 s68, s66
    s_mul_i32 s65, s9, 32
    s_add_u32 s69, s68, s65
    s_lshl_b32 s67, s9, 6
    v_and_b32 v11, 63, v0
    v_lshrrev_b32 v12, 6, v0
    v_and_b32 v13, 15, v11
    v_lshrrev_b32 v14, 4, v11
    v_and_b32 v15, 1, v12
    v_lshrrev_b32 v16, 1, v12
    v_mul_u32_u24 v17, 32, v15
    v_add_u32 v17, v17, v13
    v_mul_u32_u24 v17, 144, v17
    v_lshlrev_b32 v18, 4, v14
    v_add_u32 v17, v17, v18
    v_add_u32 v17, 0, v17
    v_lshrrev_b32 v18, 2, v13
    v_lshlrev_b32 v19, 3, v14
    v_add_u32 v18, v18, v19
    v_mul_u32_u24 v18, 144, v18
    v_and_b32 v19, 3, v13
    v_lshlrev_b32 v19, 3, v19
    v_add_u32 v18, v18, v19
    v_mul_u32_u24 v19, 64, v16
    v_add_u32 v18, v18, v19
    v_add_u32 v18, 9216, v18
    v_mov_b32 v64, 0
    v_mov_b32 v65, 0
    v_mov_b32 v66, 0
    v_mov_b32 v67, 0
    v_mov_b32 v68, 0
    v_mov_b32 v69, 0
    v_mov_b32 v70, 0
    v_mov_b32 v71, 0
    v_mov_b32 v72, 0
    v_mov_b32 v73, 0
    v_mov_b32 v74, 0
    v_mov_b32 v75, 0
    v_mov_b32 v76, 0
    v_mov_b32 v77, 0
    v_mov_b32 v78, 0
    v_mov_b32 v79, 0
    buffer_load_dwordx4 v[128:131], v3, s[48:51], s60 offen
    buffer_load_dwordx4 v[132:135], v3, s[48:51], s61 offen
    buffer_load_dwordx4 v[144:147], v9, s[52:55], s68 offen
    buffer_load_dwordx4 v[148:151], v9, s[52:55], s69 offen
    v_add_u32 v3, 128, v3
    v_add_u32 v9, s67, v9
    s_waitcnt vmcnt(0)
    ds_write_b128 v5, v[128:131] offset:0
    ds_write_b128 v5, v[132:135] offset:4608
    ds_write_b128 v10, v[144:147] offset:0
    ds_write_b128 v10, v[148:151] offset:4608
    s_waitcnt lgkmcnt(0)
    s_barrier
    s_mov_b32 s72, 0
gk_66:
    s_add_u32 s73, s72, 1
    s_cmp_ge_u32 s73, s8
    s_cbranch_scc1 noload_68
    buffer_load_dwordx4 v[128:131], v3, s[48:51], s60 offen
    buffer_load_dwordx4 v[132:135], v3, s[48:51], s61 offen
    buffer_load_dwordx4 v[144:147], v9, s[52:55], s68 offen
    buffer_load_dwordx4 v[148:151], v9, s[52:55], s69 offen
    v_add_u32 v3, 128, v3
    v_add_u32 v9, s67, v9
noload_68:
    ds_read_b128 v[32:35], v17 offset:0
    ds_read_b128 v[36:39], v17 offset:2304
    ds_read_b64_tr_b16 v[48:49], v18 offset:0
    ds_read_b64_tr_b16 v[50:51], v18 offset:576
    ds_read_b64_tr_b16 v[52:53], v18 offset:32
    ds_read_b64_tr_b16 v[54:55], v18 offset:608
    s_waitcnt lgkmcnt(0)
    v_mfma_f32_16x16x32_bf16 v[64:67], v[48:51], v[32:35], v[64:67]
    v_mfma_f32_16x16x32_bf16 v[68:71], v[48:51], v[36:39], v[68:71]
    v_mfma_f32_16x16x32_bf16 v[72:75], v[52:55], v[32:35], v[72:75]
    v_mfma_f32_16x16x32_bf16 v[76:79], v[52:55], v[36:39], v[76:79]
    ds_read_b128 v[32:35], v17 offset:64
    ds_read_b128 v[36:39], v17 offset:2368
    ds_read_b64_tr_b16 v[48:49], v18 offset:4608
    ds_read_b64_tr_b16 v[50:51], v18 offset:5184
    ds_read_b64_tr_b16 v[52:53], v18 offset:4640
    ds_read_b64_tr_b16 v[54:55], v18 offset:5216
    s_waitcnt lgkmcnt(0)
    v_mfma_f32_16x16x32_bf16 v[64:67], v[48:51], v[32:35], v[64:67]
    v_mfma_f32_16x16x32_bf16 v[68:71], v[48:51], v[36:39], v[68:71]
    v_mfma_f32_16x16x32_bf16 v[72:75], v[52:55], v[32:35], v[72:75]
    v_mfma_f32_16x16x32_bf16 v[76:79], v[52:55], v[36:39], v[76:79]
    s_waitcnt vmcnt(0)
    ds_write_b128 v5, v[128:131] offset:18432
    ds_write_b128 v5, v[132:135] offset:23040
    ds_write_b128 v10, v[144:147] offset:18432
    ds_write_b128 v10, v[148:151] offset:23040
    s_waitcnt lgkmcnt(0)
    s_barrier
    s_add_u32 s72, s72, 1
    s_cmp_ge_u32 s72, s8
    s_cbranch_scc1 gkdone_67
    s_add_u32 s73, s72, 1
    s_cmp_ge_u32 s73, s8
    s_cbranch_scc1 noload_69
    buffer_load_dwordx4 v[128:131], v3, s[48:51], s60 offen
    buffer_load_dwordx4 v[132:135], v3, s[48:51], s61 offen
    buffer_load_dwordx4 v[144:147], v9, s[52:55], s68 offen
    buffer_load_dwordx4 v[148:151], v9, s[52:55], s69 offen
    v_add_u32 v3, 128, v3
    v_add_u32 v9, s67, v9
noload_69:
    ds_read_b128 v[32:35], v17 offset:18432
    ds_read_b128 v[36:39], v17 offset:20736
    ds_read_b64_tr_b16 v[48:49], v18 offset:18432
    ds_read_b64_tr_b16 v[50:51], v18 offset:19008
    ds_read_b64_tr_b16 v[52:53], v18 offset:18464
    ds_read_b64_tr_b16 v[54:55], v18 offset:19040
    s_waitcnt lgkmcnt(0)
    v_mfma_f32_16x16x32_bf16 v[64:67], v[48:51], v[32:35], v[64:67]
    v_mfma_f32_16x16x32_bf16 v[68:71], v[48:51], v[36:39], v[68:71]
    v_mfma_f32_16x16x32_bf16 v[72:75], v[52:55], v[32:35], v[72:75]
    v_mfma_f32_16x16x32_bf16 v[76:79], v[52:55], v[36:39], v[76:79]
    ds_read_b128 v[32:35], v17 offset:18496
    ds_read_b128 v[36:39], v17 offset:20800
    ds_read_b64_tr_b16 v[48:49], v18 offset:23040
    ds_read_b64_tr_b16 v[50:51], v18 offset:23616
    ds_read_b64_tr_b16 v[52:53], v18 offset:23072
    ds_read_b64_tr_b16 v[54:55], v18 offset:23648
    s_waitcnt lgkmcnt(0)
    v_mfma_f32_16x16x32_bf16 v[64:67], v[48:51], v[32:35], v[64:67]
    v_mfma_f32_16x16x32_bf16 v[68:71], v[48:51], v[36:39], v[68:71]
    v_mfma_f32_16x16x32_bf16 v[72:75], v[52:55], v[32:35], v[72:75]
    v_mfma_f32_16x16x32_bf16 v[76:79], v[52:55], v[36:39], v[76:79]
    s_waitcnt vmcnt(0)
    ds_write_b128 v5, v[128:131] offset:0
    ds_write_b128 v5, v[132:135] offset:4608
    ds_write_b128 v10, v[144:147] offset:0
    ds_write_b128 v10, v[148:151] offset:4608
    s_waitcnt lgkmcnt(0)
    s_barrier
    s_add_u32 s72, s72, 1
    s_cmp_ge_u32 s72, s8
    s_cbranch_scc1 gkdone_67
    s_branch gk_66
gkdone_67:
    s_nop 7
    s_nop 7
    v_mul_u32_u24 v20, 32, v15
    v_add_u32 v20, v20, v13
    v_mul_lo_u32 v20, v20, s13
    v_mul_u32_u24 v21, 64, v16
    v_lshlrev_b32 v22, 3, v14
    v_add3_u32 v20, v20, v21, v22
    s_mul_i32 s74, s10, s13
    s_add_u32 s74, s74, s66
    s_lshl_b32 s76, s13, 4
    v_cvt_pk_bf16_f32 v24, v64, v65
    v_cvt_pk_bf16_f32 v25, v66, v67
    buffer_store_dwordx2 v[24:25], v20, s[56:59], s74 offen offset:0
    v_cvt_pk_bf16_f32 v24, v72, v73
    v_cvt_pk_bf16_f32 v25, v74, v75
    buffer_store_dwordx2 v[24:25], v20, s[56:59], s74 offen offset:32
    s_add_u32 s74, s74, s76
    v_cvt_pk_bf16_f32 v24, v68, v69
    v_cvt_pk_bf16_f32 v25, v70, v71
    buffer_store_dwordx2 v[24:25], v20, s[56:59], s74 offen offset:0
    v_cvt_pk_bf16_f32 v24, v76, v77
    v_cvt_pk_bf16_f32 v25, v78, v79
    buffer_store_dwordx2 v[24:25], v20, s[56:59], s74 offen offset:32
L_k6_end:
    s_endpgm
.section .rodata,"a"
.p2align 6
.amdhsa_kernel k1_prep_kernel
  .amdhsa_next_free_vgpr 160
  .amdhsa_next_free_sgpr 102
  .amdhsa_accum_offset 160
  .amdhsa_group_segment_fixed_size 0
  .amdhsa_kernarg_size 128
  .amdhsa_user_sgpr_count 2
  .amdhsa_user_sgpr_kernarg_segment_ptr 1
  .amdhsa_system_sgpr_workgroup_id_x 1
.end_amdhsa_kernel
.amdhsa_kernel k2_main_kernel
  .amdhsa_next_free_vgpr 512
  .amdhsa_next_free_sgpr 102
  .amdhsa_accum_offset 256
  .amdhsa_group_segment_fixed_size 0
  .amdhsa_kernarg_size 128
  .amdhsa_user_sgpr_count 2
  .amdhsa_user_sgpr_kernarg_segment_ptr 1
  .amdhsa_system_sgpr_workgroup_id_x 1
.end_amdhsa_kernel
.amdhsa_kernel k3_kmvm_kernel
  .amdhsa_next_free_vgpr 160
  .amdhsa_next_free_sgpr 102
  .amdhsa_accum_offset 160
  .amdhsa_group_segment_fixed_size 0
  .amdhsa_kernarg_size 128
  .amdhsa_user_sgpr_count 2
  .amdhsa_user_sgpr_kernarg_segment_ptr 1
  .amdhsa_system_sgpr_workgroup_id_x 1
.end_amdhsa_kernel
.amdhsa_kernel k4_xattn_kernel
  .amdhsa_next_free_vgpr 168
  .amdhsa_next_free_sgpr 102
  .amdhsa_accum_offset 168
  .amdhsa_group_segment_fixed_size 0
  .amdhsa_kernarg_size 128
  .amdhsa_user_sgpr_count 2
  .amdhsa_user_sgpr_kernarg_segment_ptr 1
  .amdhsa_system_sgpr_workgroup_id_x 1
.end_amdhsa_kernel
.amdhsa_kernel k6_out_kernel
  .amdhsa_next_free_vgpr 160
  .amdhsa_next_free_sgpr 102
  .amdhsa_accum_offset 160
  .amdhsa_group_segment_fixed_size 0
  .amdhsa_kernarg_size 128
  .amdhsa_user_sgpr_count 2
  .amdhsa_user_sgpr_kernarg_segment_ptr 1
  .amdhsa_system_sgpr_workgroup_id_x 1
.end_amdhsa_kernel
```
